```python
import torch

def _softmax(x, axis=-1):
    return torch.softmax(x, dim=axis)

def _gelu(x):
    return torch.nn.functional.gelu(x, approximate='tanh')

def _silu(x):
    return torch.nn.functional.silu(x)

def _sigmoid(x):
    return torch.sigmoid(x)

def _layernorm(x, axis=-1, eps=1e-05):
    m = x.mean(dim=axis, keepdim=True)
    v = x.var(dim=axis, keepdim=True, unbiased=False)
    return (x - m) / torch.sqrt(v + eps)

def _scatter_add(tgt, idx, src, axis=0):
    return tgt.clone().index_add_(axis, idx, src)

def _segment_sum(src, seg, n):
    out = torch.zeros((n,) + src.shape[1:], dtype=src.dtype)
    return out.index_add_(0, seg, src)

def _pad(x, pw):
    flat = tuple((v for pair in reversed(pw) for v in pair))
    return torch.nn.functional.pad(x, flat)
kernel_name = 'adaLN_cond__mha_block_cached__glu_gated_geglu__prompt'

def setup_inputs():

    _w = lambda a: (lambda t: t.to(torch.bfloat16) if t.is_floating_point() else t)(torch.as_tensor(a))

    def _A_setup():
        B, Sq, D = (1, 2048, 448)
        H, Sk, Dh = (16, 2048, 256)
        return {'x': _w((lambda *s: torch.randn(*s, dtype=torch.bfloat16) * 0.05)(B, Sq, D)), 'k_cache': _w((lambda *s: torch.randn(*s, dtype=torch.bfloat16) * 0.8)(B, H, Sk, Dh)), 'v_cache': _w((lambda *s: torch.randn(*s, dtype=torch.bfloat16) * 3.2)(B, H, Sk, Dh)), 'wq': _w((lambda *s: torch.randn(*s, dtype=torch.bfloat16) * 0.8)(D, H * Dh) * D ** (-0.5)), 'wo': _w((lambda *s: torch.randn(*s, dtype=torch.bfloat16) * 3.2)(H * Dh, D) * (H * Dh) ** (-0.5))}
    _A_in = _A_setup()

    def _B_setup():
        B, S, Dm, Df = (1, 2048, 448, 1792)
        return {'x': _w((lambda *s: torch.randn(*s, dtype=torch.bfloat16) * 0.05)(B, S, Dm)), 'w_gate': _w((lambda *s: torch.randn(*s, dtype=torch.bfloat16) * 3.2)(Dm, Df) * Dm ** (-0.5)), 'w_up': _w((lambda *s: torch.randn(*s, dtype=torch.bfloat16) * 3.2)(Dm, Df) * Dm ** (-0.5)), 'w_down': _w((lambda *s: torch.randn(*s, dtype=torch.bfloat16) * 3.2)(Df, Dm) * Df ** (-0.5))}
    _B_in = _B_setup()
    return {'A_x': _A_in['x'], 'A_k_cache': _A_in['k_cache'], 'A_v_cache': _A_in['v_cache'], 'A_wq': _A_in['wq'], 'A_wo': _A_in['wo'], 'B_x': _B_in['x'], 'B_w_gate': _B_in['w_gate'], 'B_w_up': _B_in['w_up'], 'B_w_down': _B_in['w_down'], 'c': _w((lambda *s: torch.randn(*s, dtype=torch.bfloat16) * 0.4)(1, 448) * 8.0), 'w_mod': _w((lambda *s: torch.randn(*s, dtype=torch.bfloat16) * 0.4)(448, 6 * 448) * 448 ** (-0.5) * 8.0)}

def reference(A_x, A_k_cache, A_v_cache, A_wq, A_wo, B_x, B_w_gate, B_w_up, B_w_down, c, w_mod):

    def _A_ref(x, k_cache, v_cache, wq, wo):
        B, Sq, D = x.shape
        H, Dh = (16, 256)
        q = (lambda x, *d: x.permute(*d))((x @ wq).reshape(B, Sq, H, Dh), 0, 2, 1, 3)
        scores = torch.einsum('bhqd,bhkd->bhqk', q, k_cache) * Dh ** (-0.5)
        p = _softmax(scores, axis=-1)
        o = torch.einsum('bhqk,bhkd->bhqd', p, v_cache)
        return (lambda x, *d: x.permute(*d))(o, 0, 2, 1, 3).reshape(B, Sq, H * Dh) @ wo

    def _B_ref(x, w_gate, w_up, w_down):
        g = torch.einsum('bsd,df->bsf', x, w_gate)
        u = torch.einsum('bsd,df->bsf', x, w_up)
        h = _gelu(g) * u
        return torch.einsum('bsf,fd->bsd', h, w_down)
    x = A_x
    mod = (_silu(c) @ w_mod).reshape(c.shape[0], 6, 1, -1)
    sa, ca, ga, sb, cb, gb = (mod[:, 0].clone(), mod[:, 1].clone(), mod[:, 2].clone(), mod[:, 3].clone(), mod[:, 4].clone(), mod[:, 5].clone())
    h = _layernorm(x, axis=-1) * (1 + ca) + sa
    x = x + ga * _A_ref(h, A_k_cache, A_v_cache, A_wq, A_wo)
    h = _layernorm(x, axis=-1) * (1 + cb) + sb
    x = x + gb * _B_ref(h, B_w_gate, B_w_up, B_w_down)
    return x
```

```asm
; @launch kernel=k2_kernel grid=(256,1,1) block=(256,1,1) lds=163840
.amdgcn_target "amdgcn-amd-amdhsa--gfx950"
.text
.globl k2_kernel
.p2align 8
.type k2_kernel,@function
k2_kernel:
  s_cmp_ge_u32 s2, 256
  s_cbranch_scc1 L_k2_end
  s_getpc_b64 s[20:21]
L_k2_pc0:
  s_mov_b32 s22, L_tail-L_k2_pc0
  s_mov_b32 s23, 0x20000
  s_lshr_b32 s36, s2, 3
  s_lshl_b32 s36, s36, 11
  v_lshl_add_u32 v251, v0, 3, s36
  buffer_load_dword v251, v251, s[20:23], 0 offen
  v_mov_b64 v[6:7], 0
  s_mov_b32 s88, s2
  s_mov_b32 s92, s2
  s_mov_b32 s89, 0
  s_mov_b32 s90, 0
  s_mov_b32 s37, 0
L_k2_restart:
  s_load_dwordx4 s[16:19], s[0:1], 72
  s_load_dwordx2 s[48:49], s[0:1], 104
  s_load_dwordx2 s[28:29], s[0:1], 0
  s_load_dwordx4 s[44:47], s[0:1], 24
  s_load_dwordx4 s[40:43], s[0:1], 8
  s_load_dwordx4 s[4:7], s[0:1], 48
  s_load_dwordx2 s[62:63], s[0:1], 64
  v_lshrrev_b32 v48, 6, v0
  v_and_b32 v24, 63, v0
  v_readfirstlane_b32 s32, v48
  s_or_b32 s91, s37, s89
  s_cmp_eq_u32 s91, 0
  s_cselect_b32 s91, -1, 0
  s_and_b32 s61, s2, 7
  s_lshl_b32 s61, s61, 1
  s_bfe_u32 s60, s2, 0x10003
  s_add_u32 s61, s61, s60
  s_and_b32 s60, s2, 0xf0
  s_add_u32 s61, s61, s60
  s_cmp_eq_u32 s89, 0
  s_cselect_b32 s61, s61, s2
  s_lshl_b32 s36, s37, 8
  s_add_u32 s36, s36, s61
  s_cmp_gt_u32 s89, 84
  s_cselect_b32 s36, 256, s36
  v_lshrrev_b32 v144, 2, v0
  v_and_b32 v145, 3, v0
  v_lshlrev_b32 v146, 1, v144
  v_mul_u32_u24 v147, 5376, v144
  v_lshl_add_u32 v147, v145, 4, v147
  v_and_b32 v148, 31, v0
  v_lshlrev_b32 v148, 2, v148
  s_lshl_b32 s38, s61, 6
  s_mul_i32 s94, s61, 4682
  s_lshr_b32 s94, s94, 16
  s_mul_i32 s95, s94, 14
  s_sub_u32 s95, s61, s95
  s_lshl_b32 s96, s95, 1
  s_andn2_b32 s97, 1, s94
  s_add_u32 s96, s96, s97
  s_lshl_b32 s96, s96, 7
  s_add_u32 s96, s96, 1966080
  v_lshrrev_b32 v151, 5, v0
  v_mul_u32_u24 v151, 4352, v151
  v_add3_u32 v151, v151, v148, s96
  v_lshlrev_b32 v249, 4, v0
  s_and_b32 s50, s2, 7
  s_lshl_b32 s50, s50, 1
  s_bfe_u32 s51, s2, 0x10003
  s_add_u32 s50, s50, s51
  s_lshr_b32 s51, s2, 4
  s_lshl_b32 s33, s32, 13
  s_and_b32 s52, s32, 1
  s_lshr_b32 s53, s32, 1
  v_lshlrev_b32 v20, 4, v24
  s_lshl_b32 s54, s51, 2
  s_lshl_b32 s55, s52, 1
  s_add_u32 s54, s54, s55
  s_add_u32 s54, s54, s53
  s_lshl_b32 s39, s54, 1
  s_mul_i32 s54, s39, 14336
  s_add_u32 s55, s54, 14336
  v_and_b32 v48, 15, v24
  v_mul_u32_u24 v57, 896, v48
  v_lshlrev_b32 v162, 4, v48
  v_and_b32 v48, 48, v24
  v_add_u32 v57, v57, v48
  s_lshl_b32 s60, s39, 8
  s_add_u32 s60, s60, 1900544
  s_lshl_b32 s61, s92, 2
  s_add_u32 s61, s61, s32
  s_and_b32 s61, s61, 511
  s_lshl_b32 s3, s61, 6
  s_add_u32 s3, s3, 1900544
  s_mul_i32 s61, s61, 3584
  v_bfe_u32 v49, v24, 2, 2
  v_mul_u32_u24 v160, 896, v49
  v_lshl_add_u32 v160, v145, 4, v160
  v_lshl_add_u32 v160, v48, 2, v160
  v_lshl_add_u32 v56, v24, 2, s3
  s_cmp_eq_u32 s32, 0
  s_cselect_b32 s56, s91, 0
  s_and_b32 s58, s56, 1
  s_and_b32 s56, s56, 7
  s_mov_b32 s57, 0
  s_mov_b32 s59, 0
  v_bfrev_b32 v48, 1
  v_lshlrev_b32 v252, 15, v24
  v_cndmask_b32 v252, v48, v252, s[56:57]
  v_cndmask_b32 v23, v48, 0, s[58:59]
  v_mov_b32 v253, 0
  s_cmp_ge_u32 s92, 128
  s_cselect_b32 s56, 0xffff, 0
  s_mov_b32 s58, -1
  v_cndmask_b32 v56, v48, v56, s[56:57]
  v_cndmask_b32 v161, v48, v160, s[58:59]
  s_lshl_b32 s34, s2, 7
  s_add_u32 s34, s34, 2113536
  s_lshl_b32 s97, s2, 2
  s_add_u32 s97, s97, 2109440
  s_mov_b32 s35, 2109440
  s_and_b32 s93, s2, 7
  s_mul_i32 s93, s93, 4352
  s_add_u32 s93, s93, 1966080
  s_lshl_b32 s58, s50, 9
  s_sub_u32 s59, 3670016, s58
  s_waitcnt lgkmcnt(0)
  s_mov_b32 s12, s18
  s_mov_b32 s13, s19
  s_mov_b32 s14, 2408448
  s_mov_b32 s15, 0x20000
  s_movk_i32 s18, 896
  s_mov_b32 s19, 0x20000
  s_mov_b32 s24, s48
  s_mov_b32 s25, s49
  s_mov_b32 s26, 268435456
  s_mov_b32 s27, 0x20000
  s_cmp_ge_u32 s36, 84
  s_cbranch_scc1 L_k2_np
  buffer_load_ushort v112, v146, s[16:19], 0 offen offset:0
  buffer_load_ushort v113, v146, s[16:19], 0 offen offset:128
  buffer_load_ushort v114, v146, s[16:19], 0 offen offset:256
  buffer_load_ushort v115, v146, s[16:19], 0 offen offset:384
  buffer_load_ushort v116, v146, s[16:19], 0 offen offset:512
  buffer_load_ushort v117, v146, s[16:19], 0 offen offset:640
  buffer_load_ushort v118, v146, s[16:19], 0 offen offset:768
  buffer_load_dwordx4 v[84:87], v147, s[12:15], s38 offen
  s_add_u32 s38, s38, 344064
  buffer_load_dwordx4 v[88:91], v147, s[12:15], s38 offen
  s_add_u32 s38, s38, 344064
  buffer_load_dwordx4 v[92:95], v147, s[12:15], s38 offen
  s_add_u32 s38, s38, 344064
  buffer_load_dwordx4 v[96:99], v147, s[12:15], s38 offen
  s_add_u32 s38, s38, 344064
  buffer_load_dwordx4 v[100:103], v147, s[12:15], s38 offen
  s_add_u32 s38, s38, 344064
  buffer_load_dwordx4 v[104:107], v147, s[12:15], s38 offen
  s_add_u32 s38, s38, 344064
  buffer_load_dwordx4 v[108:111], v147, s[12:15], s38 offen
  buffer_load_dword v248, v151, s[24:27], 0 offen sc1
L_k2_np:
  s_mov_b32 s30, 1835008
  s_mov_b32 s31, 0x20000
  s_cmp_lt_u32 s92, 128
  s_cbranch_scc1 L_k2_ns
  buffer_load_dwordx4 v[200:203], v160, s[28:31], s61 offen offset:0
  buffer_load_dwordx4 v[204:207], v160, s[28:31], s61 offen offset:256
  buffer_load_dwordx4 v[208:211], v160, s[28:31], s61 offen offset:512
  buffer_load_dwordx4 v[212:215], v161, s[28:31], s61 offen offset:768
  buffer_load_dword v58, v56, s[24:27], 0 offen sc1
L_k2_ns:
  s_barrier
  s_add_u32 s8, s44, s58
  s_addc_u32 s9, s45, 0
  s_mov_b32 s10, s59
  s_mov_b32 s11, 0x20000
  buffer_load_dwordx4 v[240:243], v249, s[24:27], s93 offen sc1
  buffer_load_dwordx4 v[128:131], v162, s[24:27], s60 offen offset:0 sc1
  buffer_load_dwordx4 v[132:135], v162, s[24:27], s60 offen offset:256 sc1
  buffer_load_dwordx4 a[0:3], v57, s[28:31], s54 offen offset:0
  buffer_load_dwordx4 a[8:11], v57, s[28:31], s54 offen offset:64
  buffer_load_dwordx4 a[4:7], v57, s[28:31], s55 offen offset:0
  buffer_load_dwordx4 a[12:15], v57, s[28:31], s55 offen offset:64
  buffer_store_dword v253, v252, s[24:27], s34 offen sc1
L_k2_n2:
  v_lshrrev_b32 v48, 5, v24
  v_and_b32 v49, 31, v24
  s_lshl_b32 s56, s32, 17
  v_add_u32 v50, 0, v48
  v_lshlrev_b32 v51, 1, v50
  v_xor_b32 v51, v51, v49
  v_lshlrev_b32 v51, 4, v51
  v_lshl_add_u32 v40, v50, 13, v51
  v_add_u32 v40, s56, v40
  v_xor_b32 v44, 128, v40
  v_lshl_add_u32 v12, v48, 9, v51
  v_add_u32 v12, s33, v12
  v_add_u32 v50, 2, v48
  v_lshlrev_b32 v51, 1, v50
  v_xor_b32 v51, v51, v49
  v_lshlrev_b32 v51, 4, v51
  v_lshl_add_u32 v41, v50, 13, v51
  v_add_u32 v41, s56, v41
  v_subrev_u32 v41, 1024, v41
  v_xor_b32 v45, 128, v41
  v_lshl_add_u32 v13, v48, 9, v51
  v_add_u32 v13, s33, v13
  v_add_u32 v50, 4, v48
  v_lshlrev_b32 v51, 1, v50
  v_xor_b32 v51, v51, v49
  v_lshlrev_b32 v51, 4, v51
  v_lshl_add_u32 v46, v50, 13, v51
  v_add_u32 v46, s56, v46
  v_subrev_u32 v46, 2048, v46
  v_xor_b32 v42, 128, v46
  v_lshl_add_u32 v14, v48, 9, v51
  v_add_u32 v14, s33, v14
  v_add_u32 v50, 6, v48
  v_lshlrev_b32 v51, 1, v50
  v_xor_b32 v51, v51, v49
  v_lshlrev_b32 v51, 4, v51
  v_lshl_add_u32 v47, v50, 13, v51
  v_add_u32 v47, s56, v47
  v_subrev_u32 v47, 3072, v47
  v_xor_b32 v43, 128, v47
  v_lshl_add_u32 v15, v48, 9, v51
  v_add_u32 v15, s33, v15
  v_lshrrev_b32 v149, 4, v0
  v_lshlrev_b32 v149, 7, v149
  v_add_u32 v149, 131072, v149
  v_bfe_u32 v48, v0, 1, 2
  v_lshl_add_u32 v250, v48, 5, v149
  v_bfe_u32 v48, v0, 3, 1
  v_lshl_add_u32 v250, v48, 4, v250
  v_and_b32 v48, 1, v0
  v_lshl_add_u32 v250, v48, 3, v250
  s_cmp_lt_u32 s92, 128
  s_cbranch_scc1 L_k2_nt
  s_mov_b32 s56, 0x3f803f80
  v_and_b32 v52, 1, v0
  v_lshlrev_b32 v52, 4, v52
  v_and_b32 v53, 48, v24
  v_lshl_add_u32 v160, v53, 6, v162
  v_and_b32 v161, 0x80000000, v161
  v_or_b32 v161, v161, v160
  s_and_b32 s61, s92, 127
  s_mul_i32 s61, s61, 14336
  s_lshl_b32 s3, s32, 8
  s_add_u32 s61, s61, s3
  s_waitcnt vmcnt(12)
  v_dot2_f32_bf16 v48, v200, s56, 0
  v_dot2_f32_bf16 v49, v200, v200, 0
  v_dot2_f32_bf16 v48, v201, s56, v48
  v_dot2_f32_bf16 v49, v201, v201, v49
  v_dot2_f32_bf16 v48, v202, s56, v48
  v_dot2_f32_bf16 v49, v202, v202, v49
  v_dot2_f32_bf16 v48, v203, s56, v48
  v_dot2_f32_bf16 v49, v203, v203, v49
  s_waitcnt vmcnt(11)
  v_dot2_f32_bf16 v48, v204, s56, v48
  v_dot2_f32_bf16 v49, v204, v204, v49
  v_dot2_f32_bf16 v48, v205, s56, v48
  v_dot2_f32_bf16 v49, v205, v205, v49
  v_dot2_f32_bf16 v48, v206, s56, v48
  v_dot2_f32_bf16 v49, v206, v206, v49
  v_dot2_f32_bf16 v48, v207, s56, v48
  v_dot2_f32_bf16 v49, v207, v207, v49
  s_waitcnt vmcnt(10)
  v_dot2_f32_bf16 v48, v208, s56, v48
  v_dot2_f32_bf16 v49, v208, v208, v49
  v_dot2_f32_bf16 v48, v209, s56, v48
  v_dot2_f32_bf16 v49, v209, v209, v49
  v_dot2_f32_bf16 v48, v210, s56, v48
  v_dot2_f32_bf16 v49, v210, v210, v49
  v_dot2_f32_bf16 v48, v211, s56, v48
  v_dot2_f32_bf16 v49, v211, v211, v49
  s_waitcnt vmcnt(9)
  v_dot2_f32_bf16 v48, v212, s56, v48
  v_dot2_f32_bf16 v49, v212, v212, v49
  v_dot2_f32_bf16 v48, v213, s56, v48
  v_dot2_f32_bf16 v49, v213, v213, v49
  v_dot2_f32_bf16 v48, v214, s56, v48
  v_dot2_f32_bf16 v49, v214, v214, v49
  v_dot2_f32_bf16 v48, v215, s56, v48
  v_dot2_f32_bf16 v49, v215, v215, v49
  s_mov_b32 s56, 0xcccccccc
  s_mov_b32 s57, s56
  s_mov_b32 s3, 0xffff
  s_nop 1
  v_add_f32_dpp v48, v48, v48 quad_perm:[1,0,3,2] row_mask:0xf bank_mask:0xf
  v_add_f32_dpp v49, v49, v49 quad_perm:[1,0,3,2] row_mask:0xf bank_mask:0xf
  s_nop 0
  v_add_f32_dpp v48, v48, v48 quad_perm:[2,3,0,1] row_mask:0xf bank_mask:0xf
  v_add_f32_dpp v49, v49, v49 quad_perm:[2,3,0,1] row_mask:0xf bank_mask:0xf
  v_mov_b32 v50, v48
  v_mov_b32 v51, v49
  s_nop 0
  v_permlane16_swap_b32 v48, v50
  v_permlane16_swap_b32 v49, v51
  v_add_f32 v48, v48, v50
  v_add_f32 v49, v49, v51
  v_mov_b32 v50, v48
  v_mov_b32 v51, v49
  s_nop 0
  v_permlane32_swap_b32 v48, v50
  v_permlane32_swap_b32 v49, v51
  v_add_f32 v48, v48, v50
  v_add_f32 v49, v49, v51
  v_mul_f32 v48, 0xbb124925, v48
  v_mul_f32 v49, 0x3b124925, v49
  v_fma_f32 v49, -v48, v48, v49
  v_max_f32 v49, 0, v49
  v_add_f32 v49, 0x3727c5ac, v49
  v_rsq_f32 v49, v49
  s_waitcnt vmcnt(8)
  v_add_u32 v58, 0x10000, v58
  v_mul_f32 v48, v48, v49
  v_mov_b32 v60, v49
  v_mov_b32 v61, v49
  v_mov_b32 v62, v48
  v_mov_b32 v63, v48
  v_lshlrev_b32 v168, 16, v204
  v_and_b32 v169, 0xffff0000, v204
  v_lshlrev_b32 v170, 16, v205
  v_and_b32 v171, 0xffff0000, v205
  v_lshlrev_b32 v172, 16, v206
  v_and_b32 v173, 0xffff0000, v206
  v_lshlrev_b32 v174, 16, v207
  v_and_b32 v175, 0xffff0000, v207
  s_add_u32 s61, s61, 4096
  v_pk_fma_f32 v[168:169], v[168:169], v[60:61], v[62:63]
  v_pk_fma_f32 v[170:171], v[170:171], v[60:61], v[62:63]
  v_pk_fma_f32 v[172:173], v[172:173], v[60:61], v[62:63]
  v_pk_fma_f32 v[174:175], v[174:175], v[60:61], v[62:63]
  v_cvt_pk_f16_f32 v204, v168, v169
  v_cvt_pk_f16_f32 v205, v170, v171
  v_cvt_pk_f16_f32 v206, v172, v173
  v_cvt_pk_f16_f32 v207, v174, v175
  buffer_store_dwordx4 v[204:207], v160, s[24:27], s61 offen sc1
  v_lshlrev_b32 v168, 16, v208
  v_and_b32 v169, 0xffff0000, v208
  v_lshlrev_b32 v170, 16, v209
  v_and_b32 v171, 0xffff0000, v209
  v_lshlrev_b32 v172, 16, v210
  v_and_b32 v173, 0xffff0000, v210
  v_lshlrev_b32 v174, 16, v211
  v_and_b32 v175, 0xffff0000, v211
  s_add_u32 s61, s61, 4096
  v_pk_fma_f32 v[168:169], v[168:169], v[60:61], v[62:63]
  v_pk_fma_f32 v[170:171], v[170:171], v[60:61], v[62:63]
  v_pk_fma_f32 v[172:173], v[172:173], v[60:61], v[62:63]
  v_pk_fma_f32 v[174:175], v[174:175], v[60:61], v[62:63]
  v_cvt_pk_f16_f32 v208, v168, v169
  v_cvt_pk_f16_f32 v209, v170, v171
  v_cvt_pk_f16_f32 v210, v172, v173
  v_cvt_pk_f16_f32 v211, v174, v175
  buffer_store_dwordx4 v[208:211], v160, s[24:27], s61 offen sc1
  v_lshlrev_b32 v168, 16, v212
  v_and_b32 v169, 0xffff0000, v212
  v_lshlrev_b32 v170, 16, v213
  v_and_b32 v171, 0xffff0000, v213
  v_lshlrev_b32 v172, 16, v214
  v_and_b32 v173, 0xffff0000, v214
  v_lshlrev_b32 v174, 16, v215
  v_and_b32 v175, 0xffff0000, v215
  s_add_u32 s61, s61, 4096
  v_pk_fma_f32 v[168:169], v[168:169], v[60:61], v[62:63]
  v_pk_fma_f32 v[170:171], v[170:171], v[60:61], v[62:63]
  v_pk_fma_f32 v[172:173], v[172:173], v[60:61], v[62:63]
  v_pk_fma_f32 v[174:175], v[174:175], v[60:61], v[62:63]
  v_cvt_pk_f16_f32 v212, v168, v169
  v_cvt_pk_f16_f32 v213, v170, v171
  v_cvt_pk_f16_f32 v214, v172, v173
  v_cvt_pk_f16_f32 v215, v174, v175
  buffer_store_dwordx4 v[212:215], v161, s[24:27], s61 offen sc1
  v_cndmask_b32 v48, v49, v48, s[56:57]
  v_lshrrev_b32 v48, v52, v48
  v_bfi_b32 v58, s3, v48, v58
  s_cmp_eq_u32 s89, 0
  s_cbranch_scc1 L_k2_nt
  s_waitcnt vmcnt(0)
  buffer_store_dword v58, v56, s[24:27], 0 offen sc1
L_k2_nt:
  s_cmp_ge_u32 s36, 84
  s_cbranch_scc1 L_k2_ng
  v_lshl_add_u32 v149, v145, 5, v149
  v_add_u32 v150, 131072, v148
  s_waitcnt vmcnt(16)
  v_lshlrev_b32 v112, 16, v112
  v_lshlrev_b32 v113, 16, v113
  v_lshlrev_b32 v114, 16, v114
  v_lshlrev_b32 v115, 16, v115
  v_lshlrev_b32 v116, 16, v116
  v_lshlrev_b32 v117, 16, v117
  v_lshlrev_b32 v118, 16, v118
  v_mul_f32 v48, 0xbfb8aa3b, v112
  v_mul_f32 v49, 0xbfb8aa3b, v113
  v_mul_f32 v50, 0xbfb8aa3b, v114
  v_mul_f32 v51, 0xbfb8aa3b, v115
  v_mul_f32 v52, 0xbfb8aa3b, v116
  v_mul_f32 v53, 0xbfb8aa3b, v117
  v_mul_f32 v54, 0xbfb8aa3b, v118
  v_exp_f32 v48, v48
  v_exp_f32 v49, v49
  v_exp_f32 v50, v50
  v_exp_f32 v51, v51
  v_exp_f32 v52, v52
  v_exp_f32 v53, v53
  v_exp_f32 v54, v54
  v_add_f32 v48, 1.0, v48
  v_add_f32 v49, 1.0, v49
  v_add_f32 v50, 1.0, v50
  v_add_f32 v51, 1.0, v51
  v_add_f32 v52, 1.0, v52
  v_add_f32 v53, 1.0, v53
  v_add_f32 v54, 1.0, v54
  v_rcp_f32 v48, v48
  v_rcp_f32 v49, v49
  v_rcp_f32 v50, v50
  v_rcp_f32 v51, v51
  v_rcp_f32 v52, v52
  v_rcp_f32 v53, v53
  v_rcp_f32 v54, v54
  v_mul_f32 v112, v112, v48
  v_mul_f32 v113, v113, v49
  v_mul_f32 v114, v114, v50
  v_mul_f32 v115, v115, v51
  v_mul_f32 v116, v116, v52
  v_mul_f32 v117, v117, v53
  v_mul_f32 v118, v118, v54
  v_cvt_pk_bf16_f32 v112, v112, v112
  v_cvt_pk_bf16_f32 v113, v113, v113
  v_cvt_pk_bf16_f32 v114, v114, v114
  v_cvt_pk_bf16_f32 v115, v115, v115
  v_cvt_pk_bf16_f32 v116, v116, v116
  v_cvt_pk_bf16_f32 v117, v117, v117
  v_cvt_pk_bf16_f32 v118, v118, v118
  v_lshlrev_b32 v112, 16, v112
  v_lshlrev_b32 v113, 16, v113
  v_lshlrev_b32 v114, 16, v114
  v_lshlrev_b32 v115, 16, v115
  v_lshlrev_b32 v116, 16, v116
  v_lshlrev_b32 v117, 16, v117
  v_lshlrev_b32 v118, 16, v118
  s_waitcnt vmcnt(15)
  v_lshlrev_b32 v48, 16, v84
  v_and_b32 v49, 0xffff0000, v84
  v_mul_f32 v120, v48, v112
  v_mul_f32 v121, v49, v112
  v_lshlrev_b32 v48, 16, v85
  v_and_b32 v49, 0xffff0000, v85
  v_mul_f32 v122, v48, v112
  v_mul_f32 v123, v49, v112
  v_lshlrev_b32 v48, 16, v86
  v_and_b32 v49, 0xffff0000, v86
  v_mul_f32 v124, v48, v112
  v_mul_f32 v125, v49, v112
  v_lshlrev_b32 v48, 16, v87
  v_and_b32 v49, 0xffff0000, v87
  v_mul_f32 v126, v48, v112
  v_mul_f32 v127, v49, v112
  s_waitcnt vmcnt(14)
  v_lshlrev_b32 v48, 16, v88
  v_and_b32 v49, 0xffff0000, v88
  v_fmac_f32 v120, v48, v113
  v_fmac_f32 v121, v49, v113
  v_lshlrev_b32 v48, 16, v89
  v_and_b32 v49, 0xffff0000, v89
  v_fmac_f32 v122, v48, v113
  v_fmac_f32 v123, v49, v113
  v_lshlrev_b32 v48, 16, v90
  v_and_b32 v49, 0xffff0000, v90
  v_fmac_f32 v124, v48, v113
  v_fmac_f32 v125, v49, v113
  v_lshlrev_b32 v48, 16, v91
  v_and_b32 v49, 0xffff0000, v91
  v_fmac_f32 v126, v48, v113
  v_fmac_f32 v127, v49, v113
  s_waitcnt vmcnt(13)
  v_lshlrev_b32 v48, 16, v92
  v_and_b32 v49, 0xffff0000, v92
  v_fmac_f32 v120, v48, v114
  v_fmac_f32 v121, v49, v114
  v_lshlrev_b32 v48, 16, v93
  v_and_b32 v49, 0xffff0000, v93
  v_fmac_f32 v122, v48, v114
  v_fmac_f32 v123, v49, v114
  v_lshlrev_b32 v48, 16, v94
  v_and_b32 v49, 0xffff0000, v94
  v_fmac_f32 v124, v48, v114
  v_fmac_f32 v125, v49, v114
  v_lshlrev_b32 v48, 16, v95
  v_and_b32 v49, 0xffff0000, v95
  v_fmac_f32 v126, v48, v114
  v_fmac_f32 v127, v49, v114
  s_waitcnt vmcnt(12)
  v_lshlrev_b32 v48, 16, v96
  v_and_b32 v49, 0xffff0000, v96
  v_fmac_f32 v120, v48, v115
  v_fmac_f32 v121, v49, v115
  v_lshlrev_b32 v48, 16, v97
  v_and_b32 v49, 0xffff0000, v97
  v_fmac_f32 v122, v48, v115
  v_fmac_f32 v123, v49, v115
  v_lshlrev_b32 v48, 16, v98
  v_and_b32 v49, 0xffff0000, v98
  v_fmac_f32 v124, v48, v115
  v_fmac_f32 v125, v49, v115
  v_lshlrev_b32 v48, 16, v99
  v_and_b32 v49, 0xffff0000, v99
  v_fmac_f32 v126, v48, v115
  v_fmac_f32 v127, v49, v115
  s_waitcnt vmcnt(11)
  v_lshlrev_b32 v48, 16, v100
  v_and_b32 v49, 0xffff0000, v100
  v_fmac_f32 v120, v48, v116
  v_fmac_f32 v121, v49, v116
  v_lshlrev_b32 v48, 16, v101
  v_and_b32 v49, 0xffff0000, v101
  v_fmac_f32 v122, v48, v116
  v_fmac_f32 v123, v49, v116
  v_lshlrev_b32 v48, 16, v102
  v_and_b32 v49, 0xffff0000, v102
  v_fmac_f32 v124, v48, v116
  v_fmac_f32 v125, v49, v116
  v_lshlrev_b32 v48, 16, v103
  v_and_b32 v49, 0xffff0000, v103
  v_fmac_f32 v126, v48, v116
  v_fmac_f32 v127, v49, v116
  s_waitcnt vmcnt(10)
  v_lshlrev_b32 v48, 16, v104
  v_and_b32 v49, 0xffff0000, v104
  v_fmac_f32 v120, v48, v117
  v_fmac_f32 v121, v49, v117
  v_lshlrev_b32 v48, 16, v105
  v_and_b32 v49, 0xffff0000, v105
  v_fmac_f32 v122, v48, v117
  v_fmac_f32 v123, v49, v117
  v_lshlrev_b32 v48, 16, v106
  v_and_b32 v49, 0xffff0000, v106
  v_fmac_f32 v124, v48, v117
  v_fmac_f32 v125, v49, v117
  v_lshlrev_b32 v48, 16, v107
  v_and_b32 v49, 0xffff0000, v107
  v_fmac_f32 v126, v48, v117
  v_fmac_f32 v127, v49, v117
  s_waitcnt vmcnt(9)
  v_lshlrev_b32 v48, 16, v108
  v_and_b32 v49, 0xffff0000, v108
  v_fmac_f32 v120, v48, v118
  v_fmac_f32 v121, v49, v118
  v_lshlrev_b32 v48, 16, v109
  v_and_b32 v49, 0xffff0000, v109
  v_fmac_f32 v122, v48, v118
  v_fmac_f32 v123, v49, v118
  v_lshlrev_b32 v48, 16, v110
  v_and_b32 v49, 0xffff0000, v110
  v_fmac_f32 v124, v48, v118
  v_fmac_f32 v125, v49, v118
  v_lshlrev_b32 v48, 16, v111
  v_and_b32 v49, 0xffff0000, v111
  v_fmac_f32 v126, v48, v118
  v_fmac_f32 v127, v49, v118
  v_add_f32_dpp v120, v120, v120 row_ror:4 row_mask:0xf bank_mask:0xf
  v_add_f32_dpp v121, v121, v121 row_ror:4 row_mask:0xf bank_mask:0xf
  v_add_f32_dpp v122, v122, v122 row_ror:4 row_mask:0xf bank_mask:0xf
  v_add_f32_dpp v123, v123, v123 row_ror:4 row_mask:0xf bank_mask:0xf
  v_add_f32_dpp v124, v124, v124 row_ror:4 row_mask:0xf bank_mask:0xf
  v_add_f32_dpp v125, v125, v125 row_ror:4 row_mask:0xf bank_mask:0xf
  v_add_f32_dpp v126, v126, v126 row_ror:4 row_mask:0xf bank_mask:0xf
  v_add_f32_dpp v127, v127, v127 row_ror:4 row_mask:0xf bank_mask:0xf
  v_add_f32_dpp v120, v120, v120 row_ror:8 row_mask:0xf bank_mask:0xf
  v_add_f32_dpp v121, v121, v121 row_ror:8 row_mask:0xf bank_mask:0xf
  v_add_f32_dpp v122, v122, v122 row_ror:8 row_mask:0xf bank_mask:0xf
  v_add_f32_dpp v123, v123, v123 row_ror:8 row_mask:0xf bank_mask:0xf
  v_add_f32_dpp v124, v124, v124 row_ror:8 row_mask:0xf bank_mask:0xf
  v_add_f32_dpp v125, v125, v125 row_ror:8 row_mask:0xf bank_mask:0xf
  v_add_f32_dpp v126, v126, v126 row_ror:8 row_mask:0xf bank_mask:0xf
  v_add_f32_dpp v127, v127, v127 row_ror:8 row_mask:0xf bank_mask:0xf
  ds_write_b128 v149, v[120:123] offset:4096
  ds_write_b128 v149, v[124:127] offset:4112
  s_waitcnt lgkmcnt(0)
  s_barrier
  ds_read_b32 v84, v150 offset:4096
  ds_read_b32 v85, v150 offset:4224
  ds_read_b32 v86, v150 offset:4352
  ds_read_b32 v87, v150 offset:4480
  ds_read_b32 v88, v150 offset:4608
  ds_read_b32 v89, v150 offset:4736
  ds_read_b32 v90, v150 offset:4864
  ds_read_b32 v91, v150 offset:4992
  ds_read_b32 v92, v150 offset:5120
  ds_read_b32 v93, v150 offset:5248
  ds_read_b32 v94, v150 offset:5376
  ds_read_b32 v95, v150 offset:5504
  ds_read_b32 v96, v150 offset:5632
  ds_read_b32 v97, v150 offset:5760
  ds_read_b32 v98, v150 offset:5888
  ds_read_b32 v99, v150 offset:6016
  s_lshl_b32 s56, 1, s94
  s_and_b32 s56, s56, 0x12
  s_cselect_b32 s56, 1.0, 0
  s_lshl_b32 s57, s94, 11
  s_lshl_b32 s95, s95, 7
  s_add_u32 s57, s57, s95
  s_add_u32 s57, s57, 2097152
  s_cmp_lt_u32 s94, 2
  s_cselect_b64 vcc, -1, 0
  v_add_u32 v148, s57, v148
  v_cndmask_b32 v148, v148, v151, vcc
  v_cndmask_b32 v56, v56, v151, vcc
  s_waitcnt vmcnt(8)
  s_mov_b32 s57, 0xffff
  v_add_u32 v248, 0x10000, v248
  s_waitcnt lgkmcnt(7)
  v_add_f32 v84, v84, v92
  s_waitcnt lgkmcnt(6)
  v_add_f32 v85, v85, v93
  s_waitcnt lgkmcnt(5)
  v_add_f32 v86, v86, v94
  s_waitcnt lgkmcnt(4)
  v_add_f32 v87, v87, v95
  s_waitcnt lgkmcnt(3)
  v_add_f32 v88, v88, v96
  s_waitcnt lgkmcnt(2)
  v_add_f32 v89, v89, v97
  s_waitcnt lgkmcnt(1)
  v_add_f32 v90, v90, v98
  s_waitcnt lgkmcnt(0)
  v_add_f32 v91, v91, v99
  v_add_f32 v84, v84, v88
  v_add_f32 v85, v85, v89
  v_add_f32 v86, v86, v90
  v_add_f32 v87, v87, v91
  v_add_f32 v84, v84, v86
  v_add_f32 v85, v85, v87
  v_add_f32 v84, v84, v85
  v_cvt_pk_bf16_f32 v84, v84, v84
  v_lshlrev_b32 v84, 16, v84
  v_add_f32 v84, s56, v84
  v_cvt_pk_bf16_f32 v84, v84, v84
  v_lshlrev_b32 v84, 16, v84
  v_mul_f32 v85, 0x3db8aa3b, v84
  v_cvt_f16_f32 v85, v85
  v_bfi_b32 v85, s57, v85, v248
  v_cndmask_b32 v58, v84, v85, vcc
  buffer_store_dword v58, v148, s[24:27], 0 offen sc1
L_k2_g2:
  s_cmp_lg_u32 s89, 0
  s_cbranch_scc1 L_next
L_k2_ng:
  s_mov_b32 s38, 0
  s_add_u32 m0, s33, 32768
  s_nop 0
  buffer_load_dwordx4 v40, s[8:11], s38 offen offset:0 lds
  buffer_load_dwordx4 v41, s[8:11], s38 offen offset:1024 lds
  buffer_load_dwordx4 v42, s[8:11], s38 offen offset:2048 lds
  buffer_load_dwordx4 v43, s[8:11], s38 offen offset:3072 lds
  s_add_u32 s38, s38, 65536
  s_add_u32 m0, s33, 36864
  s_nop 0
  buffer_load_dwordx4 v44, s[8:11], s38 offen offset:0 lds
  buffer_load_dwordx4 v45, s[8:11], s38 offen offset:1024 lds
  buffer_load_dwordx4 v46, s[8:11], s38 offen offset:2048 lds
  buffer_load_dwordx4 v47, s[8:11], s38 offen offset:3072 lds
  s_cmp_lt_u32 s92, 128
  s_cbranch_scc1 L_k2_nu
  s_waitcnt vmcnt(8)
  buffer_store_dword v58, v56, s[24:27], 0 offen sc1
L_k2_nu:
  buffer_load_dwordx4 v[26:29], v20, s[24:27], s35 offen sc1
  buffer_load_dword v31, v23, s[24:27], s97 offen sc1
  buffer_load_dwordx4 a[16:19], v57, s[28:31], s54 offen offset:128
  buffer_load_dwordx4 a[24:27], v57, s[28:31], s54 offen offset:192
  buffer_load_dwordx4 a[20:23], v57, s[28:31], s55 offen offset:128
  buffer_load_dwordx4 a[28:31], v57, s[28:31], s55 offen offset:192
  s_mov_b32 s38, 524288
  s_add_u32 m0, s33, 65536
  s_nop 0
  buffer_load_dwordx4 v40, s[8:11], s38 offen offset:0 lds
  buffer_load_dwordx4 v41, s[8:11], s38 offen offset:1024 lds
  buffer_load_dwordx4 v42, s[8:11], s38 offen offset:2048 lds
  buffer_load_dwordx4 v43, s[8:11], s38 offen offset:3072 lds
  s_add_u32 s38, s38, 65536
  s_add_u32 m0, s33, 69632
  s_nop 0
  buffer_load_dwordx4 v44, s[8:11], s38 offen offset:0 lds
  buffer_load_dwordx4 v45, s[8:11], s38 offen offset:1024 lds
  buffer_load_dwordx4 v46, s[8:11], s38 offen offset:2048 lds
  buffer_load_dwordx4 v47, s[8:11], s38 offen offset:3072 lds
  v_and_b32 v57, 48, v24
  v_lshl_add_u32 v57, v162, 2, v57
  s_mov_b32 s94, s60
  s_lshl_b32 s58, s50, 20
  s_add_u32 s12, s40, s58
  s_addc_u32 s13, s41, 0
  s_mov_b32 s14, 1048576
  s_mov_b32 s15, 0x20000
  s_add_u32 s16, s42, s58
  s_addc_u32 s17, s43, 0
  s_mov_b32 s18, 1048576
  s_mov_b32 s19, 0x20000
  s_mul_i32 s58, s50, 229376
  s_add_u32 s20, s46, s58
  s_addc_u32 s21, s47, 0
  s_mov_b32 s22, 229376
  s_mov_b32 s23, 0x20000
  s_mov_b32 s34, 0
  s_mov_b32 s35, 0
  v_lshrrev_b32 v48, 4, v24
  v_and_b32 v49, 15, v24
  v_lshlrev_b32 v50, 1, v49
  v_and_b32 v50, 14, v50
  v_xor_b32 v50, v50, v48
  v_lshlrev_b32 v50, 4, v50
  s_lshl_b32 s57, s53, 14
  v_lshl_add_u32 v51, v49, 9, s57
  v_xor_b32 v52, 0, v50
  v_add_u32 v0, v52, v51
  v_xor_b32 v52, 64, v50
  v_add_u32 v1, v52, v51
  v_xor_b32 v52, 128, v50
  v_add_u32 v2, v52, v51
  v_xor_b32 v52, 192, v50
  v_add_u32 v3, v52, v51
  s_mov_b32 s57, 131072
  v_lshl_add_u32 v30, v48, 5, s57
  v_lshlrev_b32 v49, 11, v48
  v_lshrrev_b32 v48, 2, v24
  v_lshl_add_u32 v49, v48, 9, v49
  v_and_b32 v50, 1, v24
  v_lshl_add_u32 v49, v50, 4, v49
  v_bfe_u32 v50, v24, 1, 1
  v_lshl_add_u32 v49, v50, 3, v49
  v_and_b32 v50, 7, v48
  v_xor_b32 v51, 0, v50
  v_lshl_add_u32 v4, v51, 5, v49
  v_add_u32 v32, 65536, v4
  v_xor_b32 v51, 1, v50
  v_lshl_add_u32 v5, v51, 5, v49
  v_add_u32 v33, 65536, v5
  v_xor_b32 v51, 2, v50
  v_lshl_add_u32 v6, v51, 5, v49
  v_add_u32 v34, 65536, v6
  v_xor_b32 v51, 3, v50
  v_lshl_add_u32 v7, v51, 5, v49
  v_add_u32 v35, 65536, v7
  v_xor_b32 v51, 4, v50
  v_lshl_add_u32 v8, v51, 5, v49
  v_add_u32 v36, 65536, v8
  v_xor_b32 v51, 5, v50
  v_lshl_add_u32 v9, v51, 5, v49
  v_add_u32 v37, 65536, v9
  v_xor_b32 v51, 6, v50
  v_lshl_add_u32 v10, v51, 5, v49
  v_add_u32 v38, 65536, v10
  v_xor_b32 v51, 7, v50
  v_lshl_add_u32 v11, v51, 5, v49
  v_add_u32 v39, 65536, v11
  s_add_u32 s57, s33, 98304
  v_add_u32 v21, s57, v20
  v_xor_b32 v22, 16384, v21
  s_and_b32 s56, s2, 6
  s_and_b32 s57, s50, 1
  s_add_u32 s56, s56, s57
  s_lshl_b32 s57, s57, 1
  s_cmp_ge_u32 s56, 4
  s_cselect_b32 s57, s57, 0
  s_sub_u32 s56, s56, s57
  s_mov_b32 s3, s56
  s_mov_b32 s40, s6
  s_mov_b32 s41, s7
  s_mov_b32 s42, 1605632
  s_mov_b32 s43, 0x20000
  s_mov_b32 s6, 1605632
  s_mov_b32 s7, 0x20000
  s_mul_i32 s57, s56, 229376
  s_sub_u32 s58, 1605632, s57
  s_add_u32 s44, s62, s57
  s_addc_u32 s45, s63, 0
  s_mov_b32 s46, s58
  s_mov_b32 s47, 0x20000
  s_lshl_b32 s56, s39, 5
  s_add_u32 s56, s56, s50
  s_mul_i32 s60, s56, 7168
  s_add_u32 s60, s60, 8388608
  s_add_u32 s61, s60, 229376
  v_lshrrev_b32 v49, 3, v24
  v_and_b32 v50, 6, v49
  v_and_b32 v51, 7, v24
  v_xor_b32 v50, v50, v51
  s_mul_i32 s56, s32, 57344
  v_mul_u32_u24 v49, 896, v49
  v_lshl_add_u32 v49, v50, 4, v49
  v_add_u32 v49, s56, v49
  v_mov_b32 v25, v49
  buffer_load_dwordx4 v[244:247], v249, s[24:27], s93 offen sc1
  buffer_load_dwordx4 v[136:139], v162, s[24:27], s94 offen offset:0 sc1
  buffer_load_dwordx4 v[140:143], v162, s[24:27], s94 offen offset:256 sc1
  s_waitcnt vmcnt(29)
  v_accvgpr_read_b32 v64, a0
  v_lshlrev_b32 v168, 16, v64
  v_and_b32 v169, 0xffff0000, v64
  v_accvgpr_read_b32 v65, a1
  v_lshlrev_b32 v170, 16, v65
  v_and_b32 v171, 0xffff0000, v65
  v_accvgpr_read_b32 v66, a2
  v_lshlrev_b32 v172, 16, v66
  v_and_b32 v173, 0xffff0000, v66
  v_accvgpr_read_b32 v67, a3
  v_lshlrev_b32 v174, 16, v67
  v_and_b32 v175, 0xffff0000, v67
  s_waitcnt vmcnt(27)
  v_accvgpr_read_b32 v68, a4
  v_lshlrev_b32 v176, 16, v68
  v_and_b32 v177, 0xffff0000, v68
  v_accvgpr_read_b32 v69, a5
  v_lshlrev_b32 v178, 16, v69
  v_and_b32 v179, 0xffff0000, v69
  v_accvgpr_read_b32 v70, a6
  v_lshlrev_b32 v180, 16, v70
  v_and_b32 v181, 0xffff0000, v70
  v_accvgpr_read_b32 v71, a7
  v_lshlrev_b32 v182, 16, v71
  v_and_b32 v183, 0xffff0000, v71
  v_accvgpr_read_b32 v72, a8
  v_lshlrev_b32 v184, 16, v72
  v_and_b32 v185, 0xffff0000, v72
  v_accvgpr_read_b32 v73, a9
  v_lshlrev_b32 v186, 16, v73
  v_and_b32 v187, 0xffff0000, v73
  v_accvgpr_read_b32 v74, a10
  v_lshlrev_b32 v188, 16, v74
  v_and_b32 v189, 0xffff0000, v74
  v_accvgpr_read_b32 v75, a11
  v_lshlrev_b32 v190, 16, v75
  v_and_b32 v191, 0xffff0000, v75
  s_waitcnt vmcnt(26)
  v_accvgpr_read_b32 v76, a12
  v_lshlrev_b32 v192, 16, v76
  v_and_b32 v193, 0xffff0000, v76
  v_accvgpr_read_b32 v77, a13
  v_lshlrev_b32 v194, 16, v77
  v_and_b32 v195, 0xffff0000, v77
  v_accvgpr_read_b32 v78, a14
  v_lshlrev_b32 v196, 16, v78
  v_and_b32 v197, 0xffff0000, v78
  v_accvgpr_read_b32 v79, a15
  v_lshlrev_b32 v198, 16, v79
  v_and_b32 v199, 0xffff0000, v79
  s_waitcnt vmcnt(14)
  v_accvgpr_read_b32 v80, a16
  v_lshlrev_b32 v208, 16, v80
  v_and_b32 v209, 0xffff0000, v80
  v_accvgpr_read_b32 v81, a17
  v_lshlrev_b32 v210, 16, v81
  v_and_b32 v211, 0xffff0000, v81
  v_accvgpr_read_b32 v82, a18
  v_lshlrev_b32 v212, 16, v82
  v_and_b32 v213, 0xffff0000, v82
  v_accvgpr_read_b32 v83, a19
  v_lshlrev_b32 v214, 16, v83
  v_and_b32 v215, 0xffff0000, v83
  s_waitcnt vmcnt(12)
  v_accvgpr_read_b32 v84, a20
  v_lshlrev_b32 v216, 16, v84
  v_and_b32 v217, 0xffff0000, v84
  v_accvgpr_read_b32 v85, a21
  v_lshlrev_b32 v218, 16, v85
  v_and_b32 v219, 0xffff0000, v85
  v_accvgpr_read_b32 v86, a22
  v_lshlrev_b32 v220, 16, v86
  v_and_b32 v221, 0xffff0000, v86
  v_accvgpr_read_b32 v87, a23
  v_lshlrev_b32 v222, 16, v87
  v_and_b32 v223, 0xffff0000, v87
  v_accvgpr_read_b32 v88, a24
  v_lshlrev_b32 v224, 16, v88
  v_and_b32 v225, 0xffff0000, v88
  v_accvgpr_read_b32 v89, a25
  v_lshlrev_b32 v226, 16, v89
  v_and_b32 v227, 0xffff0000, v89
  v_accvgpr_read_b32 v90, a26
  v_lshlrev_b32 v228, 16, v90
  v_and_b32 v229, 0xffff0000, v90
  v_accvgpr_read_b32 v91, a27
  v_lshlrev_b32 v230, 16, v91
  v_and_b32 v231, 0xffff0000, v91
  s_waitcnt vmcnt(11)
  v_accvgpr_read_b32 v92, a28
  v_lshlrev_b32 v232, 16, v92
  v_and_b32 v233, 0xffff0000, v92
  v_accvgpr_read_b32 v93, a29
  v_lshlrev_b32 v234, 16, v93
  v_and_b32 v235, 0xffff0000, v93
  v_accvgpr_read_b32 v94, a30
  v_lshlrev_b32 v236, 16, v94
  v_and_b32 v237, 0xffff0000, v94
  v_accvgpr_read_b32 v95, a31
  v_lshlrev_b32 v238, 16, v95
  v_and_b32 v239, 0xffff0000, v95
  s_barrier
  ds_read_b64_tr_b16 a[128:129], v4 offset:32768
  ds_read_b64_tr_b16 a[130:131], v4 offset:34816
  ds_read_b64_tr_b16 a[132:133], v4 offset:49152
  ds_read_b64_tr_b16 a[134:135], v4 offset:51200
  ds_read_b64_tr_b16 a[136:137], v5 offset:32768
  ds_read_b64_tr_b16 a[138:139], v5 offset:34816
  ds_read_b64_tr_b16 a[140:141], v5 offset:49152
  ds_read_b64_tr_b16 a[142:143], v5 offset:51200
  ds_read_b64_tr_b16 a[144:145], v6 offset:32768
  ds_read_b64_tr_b16 a[146:147], v6 offset:34816
  ds_read_b64_tr_b16 a[148:149], v6 offset:49152
  ds_read_b64_tr_b16 a[150:151], v6 offset:51200
  ds_read_b64_tr_b16 a[152:153], v7 offset:32768
  ds_read_b64_tr_b16 a[154:155], v7 offset:34816
  ds_read_b64_tr_b16 a[156:157], v7 offset:49152
  ds_read_b64_tr_b16 a[158:159], v7 offset:51200
  ds_read_b64_tr_b16 a[160:161], v8 offset:32768
  ds_read_b64_tr_b16 a[162:163], v8 offset:34816
  ds_read_b64_tr_b16 a[164:165], v8 offset:49152
  ds_read_b64_tr_b16 a[166:167], v8 offset:51200
  ds_read_b64_tr_b16 a[168:169], v9 offset:32768
  ds_read_b64_tr_b16 a[170:171], v9 offset:34816
  ds_read_b64_tr_b16 a[172:173], v9 offset:49152
  ds_read_b64_tr_b16 a[174:175], v9 offset:51200
  ds_read_b64_tr_b16 a[176:177], v10 offset:32768
  ds_read_b64_tr_b16 a[178:179], v10 offset:34816
  ds_read_b64_tr_b16 a[180:181], v10 offset:49152
  ds_read_b64_tr_b16 a[182:183], v10 offset:51200
  ds_read_b64_tr_b16 a[184:185], v11 offset:32768
  ds_read_b64_tr_b16 a[186:187], v11 offset:34816
  ds_read_b64_tr_b16 a[188:189], v11 offset:49152
  ds_read_b64_tr_b16 a[190:191], v11 offset:51200
  s_cmp_eq_u32 s32, 3
  s_cselect_b32 s57, 0, s91
  s_mov_b32 s95, 399
  s_mov_b32 s59, 0
  s_mov_b32 s58, 0x05040100
  s_lshl_b32 s56, s32, 2
  s_add_u32 s56, s56, 133120
  v_mov_b32 v52, s56
  s_waitcnt vmcnt(0)
L_mt_chk:
  v_xor_b32 v48, v244, v240
  v_xor_b32 v49, v245, v241
  v_xor_b32 v50, v246, v242
  v_xor_b32 v51, v247, v243
  v_min3_u32 v48, v48, v49, v50
  v_min_u32 v48, v48, v51
  v_cmp_gt_u32 vcc, 0x10000, v48
  v_xor_b32 v200, v136, v128
  v_xor_b32 v201, v137, v129
  v_xor_b32 v202, v138, v130
  v_xor_b32 v203, v139, v131
  v_xor_b32 v204, v140, v132
  v_xor_b32 v205, v141, v133
  v_xor_b32 v206, v142, v134
  v_xor_b32 v207, v143, v135
  s_and_b32 s96, vcc_hi, s57
  s_or_b32 s96, vcc_lo, s96
  v_min3_u32 v200, v200, v201, v202
  v_min3_u32 v203, v203, v204, v205
  v_min3_u32 v200, v200, v206, v207
  v_min_u32 v200, v200, v203
  v_cmp_gt_u32 vcc, 0x10000, v200
  s_nop 0
  s_or_b32 s96, vcc_lo, s96
  s_or_b32 s96, vcc_hi, s96
  s_and_b32 s96, s96, s91
  s_cbranch_scc0 L_mt_ok
  buffer_load_dwordx4 v[244:247], v249, s[24:27], s93 offen sc1
  buffer_load_dwordx4 v[136:139], v162, s[24:27], s94 offen offset:0 sc1
  buffer_load_dwordx4 v[140:143], v162, s[24:27], s94 offen offset:256 sc1
  s_and_b32 s96, s95, 7
  s_cbranch_scc1 L_mt_nr
  v_add_u32 v58, 0x10000, v58
  buffer_store_dword v58, v56, s[24:27], 0 offen sc1
L_mt_nr:
  s_sub_u32 s95, s95, 1
  s_cmp_gt_i32 s95, 0
  s_waitcnt vmcnt(0)
  s_cbranch_scc1 L_mt_chk
  s_mov_b32 s59, 1
L_mt_ok:
  v_add_u32 v58, 0x10000, v58
  buffer_store_dword v58, v56, s[24:27], 0 offen sc1
  v_perm_b32 v48, v245, v244, s58
  v_perm_b32 v49, v247, v246, s58
  v_mov_b32 v50, s59
  ds_write_b64 v250, v[48:49]
  ds_write_b32 v52, v50
  v_mov_b32 v52, 131072
  v_add_u32 v31, 1, v31
  v_perm_b32 v60, v137, v136, s58
  v_perm_b32 v61, v139, v138, s58
  v_perm_b32 v62, v141, v140, s58
  v_perm_b32 v63, v143, v142, s58
  s_mov_b32 s38, 1048576
  s_add_u32 m0, s33, 98304
  s_nop 0
  buffer_load_dwordx4 v40, s[8:11], s38 offen offset:0 lds
  v_pk_fma_f32 v[168:169], v[168:169], v[60:61], v[60:61] op_sel:[0,0,1] op_sel_hi:[1,0,1]
  v_pk_fma_f32 v[170:171], v[170:171], v[60:61], v[60:61] op_sel:[0,0,1] op_sel_hi:[1,0,1]
  v_pk_fma_f32 v[172:173], v[172:173], v[60:61], v[60:61] op_sel:[0,0,1] op_sel_hi:[1,0,1]
  v_pk_fma_f32 v[174:175], v[174:175], v[60:61], v[60:61] op_sel:[0,0,1] op_sel_hi:[1,0,1]
  buffer_load_dwordx4 v41, s[8:11], s38 offen offset:1024 lds
  buffer_load_dwordx4 v42, s[8:11], s38 offen offset:2048 lds
  buffer_load_dwordx4 v43, s[8:11], s38 offen offset:3072 lds
  v_pk_fma_f32 v[176:177], v[176:177], v[62:63], v[62:63] op_sel:[0,0,1] op_sel_hi:[1,0,1]
  v_pk_fma_f32 v[178:179], v[178:179], v[62:63], v[62:63] op_sel:[0,0,1] op_sel_hi:[1,0,1]
  v_pk_fma_f32 v[180:181], v[180:181], v[62:63], v[62:63] op_sel:[0,0,1] op_sel_hi:[1,0,1]
  v_pk_fma_f32 v[182:183], v[182:183], v[62:63], v[62:63] op_sel:[0,0,1] op_sel_hi:[1,0,1]
  s_add_u32 s38, s38, 65536
  s_add_u32 m0, s33, 102400
  s_nop 0
  buffer_load_dwordx4 v44, s[8:11], s38 offen offset:0 lds
  v_pk_fma_f32 v[184:185], v[184:185], v[60:61], v[60:61] op_sel:[0,0,1] op_sel_hi:[1,0,1]
  v_pk_fma_f32 v[186:187], v[186:187], v[60:61], v[60:61] op_sel:[0,0,1] op_sel_hi:[1,0,1]
  v_pk_fma_f32 v[188:189], v[188:189], v[60:61], v[60:61] op_sel:[0,0,1] op_sel_hi:[1,0,1]
  v_pk_fma_f32 v[190:191], v[190:191], v[60:61], v[60:61] op_sel:[0,0,1] op_sel_hi:[1,0,1]
  buffer_load_dwordx4 v45, s[8:11], s38 offen offset:1024 lds
  buffer_load_dwordx4 v46, s[8:11], s38 offen offset:2048 lds
  buffer_load_dwordx4 v47, s[8:11], s38 offen offset:3072 lds
  v_pk_fma_f32 v[192:193], v[192:193], v[62:63], v[62:63] op_sel:[0,0,1] op_sel_hi:[1,0,1]
  v_pk_fma_f32 v[194:195], v[194:195], v[62:63], v[62:63] op_sel:[0,0,1] op_sel_hi:[1,0,1]
  v_pk_fma_f32 v[196:197], v[196:197], v[62:63], v[62:63] op_sel:[0,0,1] op_sel_hi:[1,0,1]
  v_pk_fma_f32 v[198:199], v[198:199], v[62:63], v[62:63] op_sel:[0,0,1] op_sel_hi:[1,0,1]
  v_pk_fma_f32 v[208:209], v[208:209], v[60:61], v[60:61] op_sel:[0,0,1] op_sel_hi:[1,0,1]
  v_pk_fma_f32 v[210:211], v[210:211], v[60:61], v[60:61] op_sel:[0,0,1] op_sel_hi:[1,0,1]
  v_pk_fma_f32 v[212:213], v[212:213], v[60:61], v[60:61] op_sel:[0,0,1] op_sel_hi:[1,0,1]
  v_pk_fma_f32 v[214:215], v[214:215], v[60:61], v[60:61] op_sel:[0,0,1] op_sel_hi:[1,0,1]
  v_pk_fma_f32 v[216:217], v[216:217], v[62:63], v[62:63] op_sel:[0,0,1] op_sel_hi:[1,0,1]
  v_pk_fma_f32 v[218:219], v[218:219], v[62:63], v[62:63] op_sel:[0,0,1] op_sel_hi:[1,0,1]
  v_pk_fma_f32 v[220:221], v[220:221], v[62:63], v[62:63] op_sel:[0,0,1] op_sel_hi:[1,0,1]
  v_pk_fma_f32 v[222:223], v[222:223], v[62:63], v[62:63] op_sel:[0,0,1] op_sel_hi:[1,0,1]
  v_pk_fma_f32 v[224:225], v[224:225], v[60:61], v[60:61] op_sel:[0,0,1] op_sel_hi:[1,0,1]
  v_pk_fma_f32 v[226:227], v[226:227], v[60:61], v[60:61] op_sel:[0,0,1] op_sel_hi:[1,0,1]
  v_pk_fma_f32 v[228:229], v[228:229], v[60:61], v[60:61] op_sel:[0,0,1] op_sel_hi:[1,0,1]
  v_pk_fma_f32 v[230:231], v[230:231], v[60:61], v[60:61] op_sel:[0,0,1] op_sel_hi:[1,0,1]
  v_pk_fma_f32 v[232:233], v[232:233], v[62:63], v[62:63] op_sel:[0,0,1] op_sel_hi:[1,0,1]
  v_pk_fma_f32 v[234:235], v[234:235], v[62:63], v[62:63] op_sel:[0,0,1] op_sel_hi:[1,0,1]
  v_pk_fma_f32 v[236:237], v[236:237], v[62:63], v[62:63] op_sel:[0,0,1] op_sel_hi:[1,0,1]
  v_pk_fma_f32 v[238:239], v[238:239], v[62:63], v[62:63] op_sel:[0,0,1] op_sel_hi:[1,0,1]
  s_waitcnt lgkmcnt(0)
  s_barrier
  ds_read_b128 v[96:99], v30 offset:0
  ds_read_b128 v[100:103], v30 offset:16
  ds_read_b128 v[104:107], v30 offset:128
  ds_read_b128 v[108:111], v30 offset:144
  ds_read_b128 v[52:55], v52 offset:2048
  ds_read_b128 v[112:115], v30 offset:256
  ds_read_b128 v[116:119], v30 offset:272
  ds_read_b128 v[120:123], v30 offset:384
  ds_read_b128 v[124:127], v30 offset:400
  s_waitcnt lgkmcnt(7)
  v_fma_mix_f32 v168, v168, v96, v100 op_sel:[0,0,0] op_sel_hi:[0,1,1]
  v_fma_mix_f32 v169, v169, v96, v100 op_sel:[0,1,1] op_sel_hi:[0,1,1]
  v_cvt_pk_bf16_f32 v64, v168, v169
  v_fma_mix_f32 v170, v170, v97, v101 op_sel:[0,0,0] op_sel_hi:[0,1,1]
  v_fma_mix_f32 v171, v171, v97, v101 op_sel:[0,1,1] op_sel_hi:[0,1,1]
  v_cvt_pk_bf16_f32 v65, v170, v171
  v_fma_mix_f32 v172, v172, v98, v102 op_sel:[0,0,0] op_sel_hi:[0,1,1]
  v_fma_mix_f32 v173, v173, v98, v102 op_sel:[0,1,1] op_sel_hi:[0,1,1]
  v_cvt_pk_bf16_f32 v66, v172, v173
  v_fma_mix_f32 v174, v174, v99, v103 op_sel:[0,0,0] op_sel_hi:[0,1,1]
  v_fma_mix_f32 v175, v175, v99, v103 op_sel:[0,1,1] op_sel_hi:[0,1,1]
  v_cvt_pk_bf16_f32 v67, v174, v175
  v_fma_mix_f32 v176, v176, v96, v100 op_sel:[0,0,0] op_sel_hi:[0,1,1]
  v_fma_mix_f32 v177, v177, v96, v100 op_sel:[0,1,1] op_sel_hi:[0,1,1]
  v_cvt_pk_bf16_f32 v68, v176, v177
  v_fma_mix_f32 v178, v178, v97, v101 op_sel:[0,0,0] op_sel_hi:[0,1,1]
  v_fma_mix_f32 v179, v179, v97, v101 op_sel:[0,1,1] op_sel_hi:[0,1,1]
  v_cvt_pk_bf16_f32 v69, v178, v179
  v_fma_mix_f32 v180, v180, v98, v102 op_sel:[0,0,0] op_sel_hi:[0,1,1]
  v_fma_mix_f32 v181, v181, v98, v102 op_sel:[0,1,1] op_sel_hi:[0,1,1]
  v_cvt_pk_bf16_f32 v70, v180, v181
  v_fma_mix_f32 v182, v182, v99, v103 op_sel:[0,0,0] op_sel_hi:[0,1,1]
  v_fma_mix_f32 v183, v183, v99, v103 op_sel:[0,1,1] op_sel_hi:[0,1,1]
  v_cvt_pk_bf16_f32 v71, v182, v183
  s_waitcnt lgkmcnt(4)
  v_or3_b32 v52, v52, v53, v54
  v_or_b32 v52, v52, v55
  s_nop 0
  v_readfirstlane_b32 s31, v52
  s_nop 0
  s_cmp_lg_u32 s31, 0
  s_cbranch_scc1 L_fail
  s_mov_b32 s31, 0x20000
  v_mfma_f32_16x16x32_bf16 v[128:131], a[128:131], v[64:67], 0
  s_add_u32 s56, s54, 4096
  buffer_load_dwordx4 a[32:35], v57, s[24:27], s56 offen offset:0
  v_fma_mix_f32 v184, v184, v104, v108 op_sel:[0,0,0] op_sel_hi:[0,1,1]
  v_fma_mix_f32 v185, v185, v104, v108 op_sel:[0,1,1] op_sel_hi:[0,1,1]
  v_cvt_pk_bf16_f32 v72, v184, v185
  v_mfma_f32_16x16x32_bf16 v[132:135], a[128:131], v[68:71], 0
  v_fma_mix_f32 v186, v186, v105, v109 op_sel:[0,0,0] op_sel_hi:[0,1,1]
  v_fma_mix_f32 v187, v187, v105, v109 op_sel:[0,1,1] op_sel_hi:[0,1,1]
  v_mfma_f32_16x16x32_bf16 v[136:139], a[136:139], v[64:67], 0
  v_cvt_pk_bf16_f32 v73, v186, v187
  v_fma_mix_f32 v188, v188, v106, v110 op_sel:[0,0,0] op_sel_hi:[0,1,1]
  v_fma_mix_f32 v189, v189, v106, v110 op_sel:[0,1,1] op_sel_hi:[0,1,1]
  v_mfma_f32_16x16x32_bf16 v[140:143], a[136:139], v[68:71], 0
  v_cvt_pk_bf16_f32 v74, v188, v189
  v_fma_mix_f32 v190, v190, v107, v111 op_sel:[0,0,0] op_sel_hi:[0,1,1]
  v_mfma_f32_16x16x32_bf16 v[144:147], a[144:147], v[64:67], 0
  buffer_load_dwordx4 a[40:43], v57, s[24:27], s56 offen offset:1024
  s_add_u32 s56, s55, 4096
  v_fma_mix_f32 v191, v191, v107, v111 op_sel:[0,1,1] op_sel_hi:[0,1,1]
  v_cvt_pk_bf16_f32 v75, v190, v191
  v_mfma_f32_16x16x32_bf16 v[148:151], a[144:147], v[68:71], 0
  v_fma_mix_f32 v192, v192, v104, v108 op_sel:[0,0,0] op_sel_hi:[0,1,1]
  v_fma_mix_f32 v193, v193, v104, v108 op_sel:[0,1,1] op_sel_hi:[0,1,1]
  v_cvt_pk_bf16_f32 v76, v192, v193
  v_mfma_f32_16x16x32_bf16 v[152:155], a[152:155], v[64:67], 0
  v_fma_mix_f32 v194, v194, v105, v109 op_sel:[0,0,0] op_sel_hi:[0,1,1]
  v_fma_mix_f32 v195, v195, v105, v109 op_sel:[0,1,1] op_sel_hi:[0,1,1]
  v_mfma_f32_16x16x32_bf16 v[156:159], a[152:155], v[68:71], 0
  v_cvt_pk_bf16_f32 v77, v194, v195
  v_fma_mix_f32 v196, v196, v106, v110 op_sel:[0,0,0] op_sel_hi:[0,1,1]
  v_fma_mix_f32 v197, v197, v106, v110 op_sel:[0,1,1] op_sel_hi:[0,1,1]
  v_mfma_f32_16x16x32_bf16 v[160:163], a[160:163], v[64:67], 0
  buffer_load_dwordx4 a[36:39], v57, s[24:27], s56 offen offset:0
  v_cvt_pk_bf16_f32 v78, v196, v197
  v_fma_mix_f32 v198, v198, v107, v111 op_sel:[0,0,0] op_sel_hi:[0,1,1]
  v_mfma_f32_16x16x32_bf16 v[164:167], a[160:163], v[68:71], 0
  v_fma_mix_f32 v199, v199, v107, v111 op_sel:[0,1,1] op_sel_hi:[0,1,1]
  v_cvt_pk_bf16_f32 v79, v198, v199
  v_mfma_f32_16x16x32_bf16 v[168:171], a[168:171], v[64:67], 0
  v_mfma_f32_16x16x32_bf16 v[172:175], a[168:171], v[68:71], 0
  s_waitcnt lgkmcnt(2)
  v_fma_mix_f32 v208, v208, v112, v116 op_sel:[0,0,0] op_sel_hi:[0,1,1]
  v_fma_mix_f32 v209, v209, v112, v116 op_sel:[0,1,1] op_sel_hi:[0,1,1]
  v_mfma_f32_16x16x32_bf16 v[128:131], a[132:135], v[72:75], v[128:131]
  buffer_load_dwordx4 a[44:47], v57, s[24:27], s56 offen offset:1024
  s_add_u32 s56, s54, 6144
  v_mfma_f32_16x16x32_bf16 v[132:135], a[132:135], v[76:79], v[132:135]
  v_cvt_pk_bf16_f32 v80, v208, v209
  v_fma_mix_f32 v210, v210, v113, v117 op_sel:[0,0,0] op_sel_hi:[0,1,1]
  v_mfma_f32_16x16x32_bf16 v[136:139], a[140:143], v[72:75], v[136:139]
  ds_read_b64_tr_b16 a[128:129], v4 offset:33024
  v_fma_mix_f32 v211, v211, v113, v117 op_sel:[0,1,1] op_sel_hi:[0,1,1]
  v_mfma_f32_16x16x32_bf16 v[140:143], a[140:143], v[76:79], v[140:143]
  ds_read_b64_tr_b16 a[130:131], v4 offset:35072
  ds_read_b64_tr_b16 a[132:133], v4 offset:49408
  v_mfma_f32_16x16x32_bf16 v[144:147], a[148:151], v[72:75], v[144:147]
  buffer_load_dwordx4 a[48:51], v57, s[24:27], s56 offen offset:0
  ds_read_b64_tr_b16 a[134:135], v4 offset:51456
  v_cvt_pk_bf16_f32 v81, v210, v211
  v_fma_mix_f32 v212, v212, v114, v118 op_sel:[0,0,0] op_sel_hi:[0,1,1]
  v_mfma_f32_16x16x32_bf16 v[148:151], a[148:151], v[76:79], v[148:151]
  ds_read_b64_tr_b16 a[136:137], v5 offset:33024
  v_fma_mix_f32 v213, v213, v114, v118 op_sel:[0,1,1] op_sel_hi:[0,1,1]
  v_mfma_f32_16x16x32_bf16 v[152:155], a[156:159], v[72:75], v[152:155]
  ds_read_b64_tr_b16 a[138:139], v5 offset:35072
  ds_read_b64_tr_b16 a[140:141], v5 offset:49408
  ds_read_b64_tr_b16 a[142:143], v5 offset:51456
  v_cvt_pk_bf16_f32 v82, v212, v213
  v_mfma_f32_16x16x32_bf16 v[156:159], a[156:159], v[76:79], v[156:159]
  ds_read_b64_tr_b16 a[144:145], v6 offset:33024
  v_fma_mix_f32 v214, v214, v115, v119 op_sel:[0,0,0] op_sel_hi:[0,1,1]
  v_mfma_f32_16x16x32_bf16 v[160:163], a[164:167], v[72:75], v[160:163]
  buffer_load_dwordx4 a[56:59], v57, s[24:27], s56 offen offset:1024
  s_add_u32 s56, s55, 6144
  ds_read_b64_tr_b16 a[146:147], v6 offset:35072
  ds_read_b64_tr_b16 a[148:149], v6 offset:49408
  ds_read_b64_tr_b16 a[150:151], v6 offset:51456
  v_fma_mix_f32 v215, v215, v115, v119 op_sel:[0,1,1] op_sel_hi:[0,1,1]
  v_cvt_pk_bf16_f32 v83, v214, v215
  v_mfma_f32_16x16x32_bf16 v[164:167], a[164:167], v[76:79], v[164:167]
  ds_read_b64_tr_b16 a[152:153], v7 offset:33024
  v_fma_mix_f32 v216, v216, v112, v116 op_sel:[0,0,0] op_sel_hi:[0,1,1]
  v_mfma_f32_16x16x32_bf16 v[168:171], a[172:175], v[72:75], v[168:171]
  ds_read_b64_tr_b16 a[154:155], v7 offset:35072
  ds_read_b64_tr_b16 a[156:157], v7 offset:49408
  ds_read_b64_tr_b16 a[158:159], v7 offset:51456
  v_fma_mix_f32 v217, v217, v112, v116 op_sel:[0,1,1] op_sel_hi:[0,1,1]
  v_mfma_f32_16x16x32_bf16 v[172:175], a[172:175], v[76:79], v[172:175]
  ds_read_b64_tr_b16 a[160:161], v8 offset:33024
  v_cvt_pk_bf16_f32 v84, v216, v217
  v_mfma_f32_16x16x32_bf16 v[176:179], a[176:179], v[64:67], 0
  buffer_load_dwordx4 a[52:55], v57, s[24:27], s56 offen offset:0
  ds_read_b64_tr_b16 a[162:163], v8 offset:35072
  ds_read_b64_tr_b16 a[164:165], v8 offset:49408
  ds_read_b64_tr_b16 a[166:167], v8 offset:51456
  v_fma_mix_f32 v218, v218, v113, v117 op_sel:[0,0,0] op_sel_hi:[0,1,1]
  v_mfma_f32_16x16x32_bf16 v[176:179], a[180:183], v[72:75], v[176:179]
  v_fma_mix_f32 v219, v219, v113, v117 op_sel:[0,1,1] op_sel_hi:[0,1,1]
  v_cvt_pk_bf16_f32 v85, v218, v219
  v_mfma_f32_16x16x32_bf16 v[180:183], a[176:179], v[68:71], 0
  ds_read_b64_tr_b16 a[168:169], v9 offset:33024
  ds_read_b64_tr_b16 a[170:171], v9 offset:35072
  ds_read_b64_tr_b16 a[172:173], v9 offset:49408
  ds_read_b64_tr_b16 a[174:175], v9 offset:51456
  v_fma_mix_f32 v220, v220, v114, v118 op_sel:[0,0,0] op_sel_hi:[0,1,1]
  v_mfma_f32_16x16x32_bf16 v[180:183], a[180:183], v[76:79], v[180:183]
  v_fma_mix_f32 v221, v221, v114, v118 op_sel:[0,1,1] op_sel_hi:[0,1,1]
  v_cvt_pk_bf16_f32 v86, v220, v221
  v_mfma_f32_16x16x32_bf16 v[184:187], a[184:187], v[64:67], 0
  buffer_load_dwordx4 a[60:63], v57, s[24:27], s56 offen offset:1024
  s_mov_b32 s38, 1572864
  s_add_u32 m0, s33, 0
  v_mfma_f32_16x16x32_bf16 v[184:187], a[188:191], v[72:75], v[184:187]
  v_fma_mix_f32 v222, v222, v115, v119 op_sel:[0,0,0] op_sel_hi:[0,1,1]
  v_fma_mix_f32 v223, v223, v115, v119 op_sel:[0,1,1] op_sel_hi:[0,1,1]
  v_mfma_f32_16x16x32_bf16 v[188:191], a[184:187], v[68:71], 0
  ds_read_b64_tr_b16 a[176:177], v10 offset:33024
  ds_read_b64_tr_b16 a[178:179], v10 offset:35072
  ds_read_b64_tr_b16 a[180:181], v10 offset:49408
  ds_read_b64_tr_b16 a[182:183], v10 offset:51456
  v_cvt_pk_bf16_f32 v87, v222, v223
  v_mfma_f32_16x16x32_bf16 v[188:191], a[188:191], v[76:79], v[188:191]
  s_waitcnt lgkmcnt(12)
  v_fma_mix_f32 v224, v224, v120, v124 op_sel:[0,0,0] op_sel_hi:[0,1,1]
  v_mfma_f32_16x16x32_bf16 v[192:195], a[128:131], v[64:67], 0
  buffer_load_dwordx4 v40, s[8:11], s38 offen offset:0 lds
  v_fma_mix_f32 v225, v225, v120, v124 op_sel:[0,1,1] op_sel_hi:[0,1,1]
  v_mfma_f32_16x16x32_bf16 v[192:195], a[132:135], v[72:75], v[192:195]
  v_cvt_pk_bf16_f32 v88, v224, v225
  v_fma_mix_f32 v226, v226, v121, v125 op_sel:[0,0,0] op_sel_hi:[0,1,1]
  v_mfma_f32_16x16x32_bf16 v[196:199], a[128:131], v[68:71], 0
  ds_read_b64_tr_b16 a[184:185], v11 offset:33024
  ds_read_b64_tr_b16 a[186:187], v11 offset:35072
  ds_read_b64_tr_b16 a[188:189], v11 offset:49408
  ds_read_b64_tr_b16 a[190:191], v11 offset:51456
  v_fma_mix_f32 v227, v227, v121, v125 op_sel:[0,1,1] op_sel_hi:[0,1,1]
  v_mfma_f32_16x16x32_bf16 v[196:199], a[132:135], v[76:79], v[196:199]
  v_cvt_pk_bf16_f32 v89, v226, v227
  v_fma_mix_f32 v228, v228, v122, v126 op_sel:[0,0,0] op_sel_hi:[0,1,1]
  v_mfma_f32_16x16x32_bf16 v[200:203], a[136:139], v[64:67], 0
  buffer_load_dwordx4 v41, s[8:11], s38 offen offset:1024 lds
  v_mfma_f32_16x16x32_bf16 v[200:203], a[140:143], v[72:75], v[200:203]
  v_fma_mix_f32 v229, v229, v122, v126 op_sel:[0,1,1] op_sel_hi:[0,1,1]
  v_cvt_pk_bf16_f32 v90, v228, v229
  v_mfma_f32_16x16x32_bf16 v[204:207], a[136:139], v[68:71], 0
  v_fma_mix_f32 v230, v230, v123, v127 op_sel:[0,0,0] op_sel_hi:[0,1,1]
  v_fma_mix_f32 v231, v231, v123, v127 op_sel:[0,1,1] op_sel_hi:[0,1,1]
  v_mfma_f32_16x16x32_bf16 v[204:207], a[140:143], v[76:79], v[204:207]
  s_waitcnt  lgkmcnt(0)
  s_barrier
  v_mfma_f32_16x16x32_bf16 v[208:211], a[144:147], v[64:67], 0
  buffer_load_dwordx4 v42, s[8:11], s38 offen offset:2048 lds
  v_cvt_pk_bf16_f32 v91, v230, v231
  v_mfma_f32_16x16x32_bf16 v[208:211], a[148:151], v[72:75], v[208:211]
  v_fma_mix_f32 v232, v232, v120, v124 op_sel:[0,0,0] op_sel_hi:[0,1,1]
  v_fma_mix_f32 v233, v233, v120, v124 op_sel:[0,1,1] op_sel_hi:[0,1,1]
  v_mfma_f32_16x16x32_bf16 v[212:215], a[144:147], v[68:71], 0
  ds_read_b64_tr_b16 a[128:129], v32 offset:0
  v_cvt_pk_bf16_f32 v92, v232, v233
  v_mfma_f32_16x16x32_bf16 v[212:215], a[148:151], v[76:79], v[212:215]
  ds_read_b64_tr_b16 a[130:131], v32 offset:2048
  ds_read_b64_tr_b16 a[132:133], v32 offset:16384
  ds_read_b64_tr_b16 a[134:135], v32 offset:18432
  ds_read_b64_tr_b16 a[136:137], v33 offset:0
  ds_read_b64_tr_b16 a[138:139], v33 offset:2048
  ds_read_b64_tr_b16 a[140:141], v33 offset:16384
  ds_read_b64_tr_b16 a[142:143], v33 offset:18432
  v_fma_mix_f32 v234, v234, v121, v125 op_sel:[0,0,0] op_sel_hi:[0,1,1]
  v_mfma_f32_16x16x32_bf16 v[216:219], a[152:155], v[64:67], 0
  buffer_load_dwordx4 v43, s[8:11], s38 offen offset:3072 lds
  s_add_u32 s38, s38, 65536
  s_add_u32 m0, s33, 4096
  v_fma_mix_f32 v235, v235, v121, v125 op_sel:[0,1,1] op_sel_hi:[0,1,1]
  v_mfma_f32_16x16x32_bf16 v[216:219], a[156:159], v[72:75], v[216:219]
  ds_read_b64_tr_b16 a[144:145], v34 offset:0
  v_cvt_pk_bf16_f32 v93, v234, v235
  v_mfma_f32_16x16x32_bf16 v[220:223], a[152:155], v[68:71], 0
  ds_read_b64_tr_b16 a[146:147], v34 offset:2048
  ds_read_b64_tr_b16 a[148:149], v34 offset:16384
  ds_read_b64_tr_b16 a[150:151], v34 offset:18432
  v_fma_mix_f32 v236, v236, v122, v126 op_sel:[0,0,0] op_sel_hi:[0,1,1]
  v_fma_mix_f32 v237, v237, v122, v126 op_sel:[0,1,1] op_sel_hi:[0,1,1]
  v_mfma_f32_16x16x32_bf16 v[220:223], a[156:159], v[76:79], v[220:223]
  v_cvt_pk_bf16_f32 v94, v236, v237
  v_fma_mix_f32 v238, v238, v123, v127 op_sel:[0,0,0] op_sel_hi:[0,1,1]
  v_mfma_f32_16x16x32_bf16 v[224:227], a[160:163], v[64:67], 0
  buffer_load_dwordx4 v44, s[8:11], s38 offen offset:0 lds
  v_mfma_f32_16x16x32_bf16 v[224:227], a[164:167], v[72:75], v[224:227]
  ds_read_b64_tr_b16 a[152:153], v35 offset:0
  v_fma_mix_f32 v239, v239, v123, v127 op_sel:[0,1,1] op_sel_hi:[0,1,1]
  v_mfma_f32_16x16x32_bf16 v[228:231], a[160:163], v[68:71], 0
  ds_read_b64_tr_b16 a[154:155], v35 offset:2048
  ds_read_b64_tr_b16 a[156:157], v35 offset:16384
  ds_read_b64_tr_b16 a[158:159], v35 offset:18432
  v_cvt_pk_bf16_f32 v95, v238, v239
  ds_read_b128 v[96:99], v30 offset:512
  ds_read_b128 v[100:103], v30 offset:528
  v_mfma_f32_16x16x32_bf16 v[228:231], a[164:167], v[76:79], v[228:231]
  ds_read_b64_tr_b16 a[160:161], v36 offset:0
  ds_read_b64_tr_b16 a[162:163], v36 offset:2048
  v_mfma_f32_16x16x32_bf16 v[232:235], a[168:171], v[64:67], 0
  buffer_load_dwordx4 v45, s[8:11], s38 offen offset:1024 lds
  v_mfma_f32_16x16x32_bf16 v[232:235], a[172:175], v[72:75], v[232:235]
  ds_read_b64_tr_b16 a[164:165], v36 offset:16384
  ds_read_b64_tr_b16 a[166:167], v36 offset:18432
  v_mfma_f32_16x16x32_bf16 v[236:239], a[168:171], v[68:71], 0
  ds_read_b128 v[104:107], v30 offset:640
  v_mfma_f32_16x16x32_bf16 v[236:239], a[172:175], v[76:79], v[236:239]
  ds_read_b64_tr_b16 a[168:169], v37 offset:0
  ds_read_b64_tr_b16 a[170:171], v37 offset:2048
  v_mfma_f32_16x16x32_bf16 v[240:243], a[176:179], v[64:67], 0
  buffer_load_dwordx4 v46, s[8:11], s38 offen offset:2048 lds
  v_mfma_f32_16x16x32_bf16 v[240:243], a[180:183], v[72:75], v[240:243]
  ds_read_b64_tr_b16 a[172:173], v37 offset:16384
  ds_read_b64_tr_b16 a[174:175], v37 offset:18432
  v_mfma_f32_16x16x32_bf16 v[244:247], a[176:179], v[68:71], 0
  ds_read_b128 v[108:111], v30 offset:656
  v_mfma_f32_16x16x32_bf16 v[244:247], a[180:183], v[76:79], v[244:247]
  ds_read_b64_tr_b16 a[176:177], v38 offset:0
  ds_read_b64_tr_b16 a[178:179], v38 offset:2048
  v_mfma_f32_16x16x32_bf16 v[248:251], a[184:187], v[64:67], 0
  buffer_load_dwordx4 v47, s[8:11], s38 offen offset:3072 lds
  v_mfma_f32_16x16x32_bf16 v[248:251], a[188:191], v[72:75], v[248:251]
  ds_read_b64_tr_b16 a[180:181], v38 offset:16384
  ds_read_b64_tr_b16 a[182:183], v38 offset:18432
  v_mfma_f32_16x16x32_bf16 v[252:255], a[184:187], v[68:71], 0
  s_waitcnt lgkmcnt(15)
  v_mfma_f32_16x16x32_bf16 v[252:255], a[188:191], v[76:79], v[252:255]
  ds_read_b64_tr_b16 a[184:185], v39 offset:0
  ds_read_b64_tr_b16 a[186:187], v39 offset:2048
  v_mfma_f32_16x16x32_bf16 v[128:131], a[128:131], v[80:83], v[128:131]
  buffer_store_dword v31, v23, s[24:27], s97 offen sc1
  s_add_u32 s56, s54, 8192
  v_mfma_f32_16x16x32_bf16 v[128:131], a[132:135], v[88:91], v[128:131]
  ds_read_b64_tr_b16 a[188:189], v39 offset:16384
  ds_read_b64_tr_b16 a[190:191], v39 offset:18432
  v_mfma_f32_16x16x32_bf16 v[132:135], a[128:131], v[84:87], v[132:135]
  s_waitcnt vmcnt(16)
  v_accvgpr_read_b32 v64, a32
  s_waitcnt lgkmcnt(15)
  v_fma_mix_f32 v16, v64, v96, v100 op_sel:[0,0,0] op_sel_hi:[1,1,1]
  v_mfma_f32_16x16x32_bf16 v[132:135], a[132:135], v[92:95], v[132:135]
  v_fma_mix_f32 v17, v64, v96, v100 op_sel:[1,1,1] op_sel_hi:[1,1,1]
  v_cvt_pk_bf16_f32 v64, v16, v17
  v_mfma_f32_16x16x32_bf16 v[136:139], a[136:139], v[80:83], v[136:139]
  buffer_load_dwordx4 a[64:67], v57, s[24:27], s56 offen offset:0
  v_mfma_f32_16x16x32_bf16 v[136:139], a[140:143], v[88:91], v[136:139]
  ds_read_b64_tr_b16 a[128:129], v32 offset:256
  v_accvgpr_read_b32 v65, a33
  v_mfma_f32_16x16x32_bf16 v[140:143], a[136:139], v[84:87], v[140:143]
  ds_read_b64_tr_b16 a[130:131], v32 offset:2304
  ds_read_b64_tr_b16 a[132:133], v32 offset:16640
  ds_read_b64_tr_b16 a[134:135], v32 offset:18688
  v_fma_mix_f32 v18, v65, v97, v101 op_sel:[0,0,0] op_sel_hi:[1,1,1]
  v_mfma_f32_16x16x32_bf16 v[140:143], a[140:143], v[92:95], v[140:143]
  v_fma_mix_f32 v19, v65, v97, v101 op_sel:[1,1,1] op_sel_hi:[1,1,1]
  v_cvt_pk_bf16_f32 v65, v18, v19
  v_mfma_f32_16x16x32_bf16 v[144:147], a[144:147], v[80:83], v[144:147]
  buffer_load_dwordx4 a[72:75], v57, s[24:27], s56 offen offset:1024
  s_add_u32 s56, s55, 8192
  v_mfma_f32_16x16x32_bf16 v[144:147], a[148:151], v[88:91], v[144:147]
  v_accvgpr_read_b32 v66, a34
  v_fma_mix_f32 v16, v66, v98, v102 op_sel:[0,0,0] op_sel_hi:[1,1,1]
  v_mfma_f32_16x16x32_bf16 v[148:151], a[144:147], v[84:87], v[148:151]
  ds_read_b64_tr_b16 a[136:137], v33 offset:256
  ds_read_b64_tr_b16 a[138:139], v33 offset:2304
  ds_read_b64_tr_b16 a[140:141], v33 offset:16640
  ds_read_b64_tr_b16 a[142:143], v33 offset:18688
  v_fma_mix_f32 v17, v66, v98, v102 op_sel:[1,1,1] op_sel_hi:[1,1,1]
  v_mfma_f32_16x16x32_bf16 v[148:151], a[148:151], v[92:95], v[148:151]
  v_cvt_pk_bf16_f32 v66, v16, v17
  v_accvgpr_read_b32 v67, a35
  v_mfma_f32_16x16x32_bf16 v[152:155], a[152:155], v[80:83], v[152:155]
  buffer_load_dwordx4 a[68:71], v57, s[24:27], s56 offen offset:0
  v_mfma_f32_16x16x32_bf16 v[152:155], a[156:159], v[88:91], v[152:155]
  ds_read_b64_tr_b16 a[144:145], v34 offset:256
  v_fma_mix_f32 v18, v67, v99, v103 op_sel:[0,0,0] op_sel_hi:[1,1,1]
  v_mfma_f32_16x16x32_bf16 v[156:159], a[152:155], v[84:87], v[156:159]
  ds_read_b64_tr_b16 a[146:147], v34 offset:2304
  ds_read_b64_tr_b16 a[148:149], v34 offset:16640
  ds_read_b64_tr_b16 a[150:151], v34 offset:18688
  v_fma_mix_f32 v19, v67, v99, v103 op_sel:[1,1,1] op_sel_hi:[1,1,1]
  v_mfma_f32_16x16x32_bf16 v[156:159], a[156:159], v[92:95], v[156:159]
  s_waitcnt lgkmcnt(12)
  v_cvt_pk_bf16_f32 v67, v18, v19
  v_mfma_f32_16x16x32_bf16 v[160:163], a[160:163], v[80:83], v[160:163]
  buffer_load_dwordx4 a[76:79], v57, s[24:27], s56 offen offset:1024
  s_mov_b32 s38, 2097152
  s_add_u32 m0, s33, 32768
  s_waitcnt vmcnt(18)
  v_accvgpr_read_b32 v68, a36
  v_mfma_f32_16x16x32_bf16 v[160:163], a[164:167], v[88:91], v[160:163]
  v_fma_mix_f32 v16, v68, v96, v100 op_sel:[0,0,0] op_sel_hi:[1,1,1]
  v_fma_mix_f32 v17, v68, v96, v100 op_sel:[1,1,1] op_sel_hi:[1,1,1]
  v_mfma_f32_16x16x32_bf16 v[164:167], a[160:163], v[84:87], v[164:167]
  ds_read_b64_tr_b16 a[152:153], v35 offset:256
  ds_read_b64_tr_b16 a[154:155], v35 offset:2304
  ds_read_b64_tr_b16 a[156:157], v35 offset:16640
  ds_read_b64_tr_b16 a[158:159], v35 offset:18688
  v_cvt_pk_bf16_f32 v68, v16, v17
  v_mfma_f32_16x16x32_bf16 v[164:167], a[164:167], v[92:95], v[164:167]
  v_accvgpr_read_b32 v69, a37
  v_fma_mix_f32 v18, v69, v97, v101 op_sel:[0,0,0] op_sel_hi:[1,1,1]
  v_mfma_f32_16x16x32_bf16 v[168:171], a[168:171], v[80:83], v[168:171]
  buffer_load_dwordx4 v40, s[8:11], s38 offen offset:0 lds
  v_mfma_f32_16x16x32_bf16 v[168:171], a[172:175], v[88:91], v[168:171]
  ds_read_b64_tr_b16 a[160:161], v36 offset:256
  v_fma_mix_f32 v19, v69, v97, v101 op_sel:[1,1,1] op_sel_hi:[1,1,1]
  v_mfma_f32_16x16x32_bf16 v[172:175], a[168:171], v[84:87], v[172:175]
  ds_read_b64_tr_b16 a[162:163], v36 offset:2304
  ds_read_b64_tr_b16 a[164:165], v36 offset:16640
  ds_read_b64_tr_b16 a[166:167], v36 offset:18688
  v_cvt_pk_bf16_f32 v69, v18, v19
  v_mfma_f32_16x16x32_bf16 v[172:175], a[172:175], v[92:95], v[172:175]
  v_accvgpr_read_b32 v70, a38
  v_fma_mix_f32 v16, v70, v98, v102 op_sel:[0,0,0] op_sel_hi:[1,1,1]
  v_mfma_f32_16x16x32_bf16 v[176:179], a[176:179], v[80:83], v[176:179]
  buffer_load_dwordx4 v41, s[8:11], s38 offen offset:1024 lds
  v_fma_mix_f32 v17, v70, v98, v102 op_sel:[1,1,1] op_sel_hi:[1,1,1]
  v_mfma_f32_16x16x32_bf16 v[176:179], a[180:183], v[88:91], v[176:179]
  ds_read_b64_tr_b16 a[168:169], v37 offset:256
  v_cvt_pk_bf16_f32 v70, v16, v17
  v_mfma_f32_16x16x32_bf16 v[180:183], a[176:179], v[84:87], v[180:183]
  ds_read_b64_tr_b16 a[170:171], v37 offset:2304
  ds_read_b64_tr_b16 a[172:173], v37 offset:16640
  ds_read_b64_tr_b16 a[174:175], v37 offset:18688
  v_accvgpr_read_b32 v71, a39
  v_mfma_f32_16x16x32_bf16 v[180:183], a[180:183], v[92:95], v[180:183]
  v_fma_mix_f32 v18, v71, v99, v103 op_sel:[0,0,0] op_sel_hi:[1,1,1]
  v_fma_mix_f32 v19, v71, v99, v103 op_sel:[1,1,1] op_sel_hi:[1,1,1]
  v_mfma_f32_16x16x32_bf16 v[184:187], a[184:187], v[80:83], v[184:187]
  buffer_load_dwordx4 v42, s[8:11], s38 offen offset:2048 lds
  v_mfma_f32_16x16x32_bf16 v[184:187], a[188:191], v[88:91], v[184:187]
  ds_read_b64_tr_b16 a[176:177], v38 offset:256
  v_cvt_pk_bf16_f32 v71, v18, v19
  v_mfma_f32_16x16x32_bf16 v[188:191], a[184:187], v[84:87], v[188:191]
  ds_read_b64_tr_b16 a[178:179], v38 offset:2304
  ds_read_b64_tr_b16 a[180:181], v38 offset:16640
  ds_read_b64_tr_b16 a[182:183], v38 offset:18688
  v_accvgpr_read_b32 v72, a40
  v_mfma_f32_16x16x32_bf16 v[188:191], a[188:191], v[92:95], v[188:191]
  s_waitcnt lgkmcnt(12)
  v_fma_mix_f32 v16, v72, v104, v108 op_sel:[0,0,0] op_sel_hi:[1,1,1]
  v_mfma_f32_16x16x32_bf16 v[192:195], a[128:131], v[80:83], v[192:195]
  buffer_load_dwordx4 v43, s[8:11], s38 offen offset:3072 lds
  s_add_u32 s38, s38, 65536
  s_add_u32 m0, s33, 36864
  v_fma_mix_f32 v17, v72, v104, v108 op_sel:[1,1,1] op_sel_hi:[1,1,1]
  v_cvt_pk_bf16_f32 v72, v16, v17
  v_mfma_f32_16x16x32_bf16 v[192:195], a[132:135], v[88:91], v[192:195]
  ds_read_b64_tr_b16 a[184:185], v39 offset:256
  v_accvgpr_read_b32 v73, a41
  v_mfma_f32_16x16x32_bf16 v[196:199], a[128:131], v[84:87], v[196:199]
  ds_read_b64_tr_b16 a[186:187], v39 offset:2304
  ds_read_b64_tr_b16 a[188:189], v39 offset:16640
  ds_read_b64_tr_b16 a[190:191], v39 offset:18688
  v_fma_mix_f32 v18, v73, v105, v109 op_sel:[0,0,0] op_sel_hi:[1,1,1]
  v_mfma_f32_16x16x32_bf16 v[196:199], a[132:135], v[92:95], v[196:199]
  v_fma_mix_f32 v19, v73, v105, v109 op_sel:[1,1,1] op_sel_hi:[1,1,1]
  v_cvt_pk_bf16_f32 v73, v18, v19
  v_mfma_f32_16x16x32_bf16 v[200:203], a[136:139], v[80:83], v[200:203]
  buffer_load_dwordx4 v44, s[8:11], s38 offen offset:0 lds
  v_mfma_f32_16x16x32_bf16 v[200:203], a[140:143], v[88:91], v[200:203]
  v_accvgpr_read_b32 v74, a42
  v_fma_mix_f32 v16, v74, v106, v110 op_sel:[0,0,0] op_sel_hi:[1,1,1]
  v_mfma_f32_16x16x32_bf16 v[204:207], a[136:139], v[84:87], v[204:207]
  v_fma_mix_f32 v17, v74, v106, v110 op_sel:[1,1,1] op_sel_hi:[1,1,1]
  v_cvt_pk_bf16_f32 v74, v16, v17
  v_mfma_f32_16x16x32_bf16 v[204:207], a[140:143], v[92:95], v[204:207]
  s_waitcnt  lgkmcnt(0)
  s_barrier
  v_mfma_f32_16x16x32_bf16 v[208:211], a[144:147], v[80:83], v[208:211]
  buffer_load_dwordx4 v45, s[8:11], s38 offen offset:1024 lds
  v_accvgpr_read_b32 v75, a43
  v_mfma_f32_16x16x32_bf16 v[208:211], a[148:151], v[88:91], v[208:211]
  v_fma_mix_f32 v18, v75, v107, v111 op_sel:[0,0,0] op_sel_hi:[1,1,1]
  v_fma_mix_f32 v19, v75, v107, v111 op_sel:[1,1,1] op_sel_hi:[1,1,1]
  v_mfma_f32_16x16x32_bf16 v[212:215], a[144:147], v[84:87], v[212:215]
  ds_read_b64_tr_b16 a[128:129], v32 offset:32768
  ds_read_b64_tr_b16 a[130:131], v32 offset:34816
  v_mfma_f32_16x16x32_bf16 v[212:215], a[148:151], v[92:95], v[212:215]
  ds_read_b64_tr_b16 a[132:133], v32 offset:49152
  ds_read_b64_tr_b16 a[134:135], v32 offset:51200
  ds_read_b64_tr_b16 a[136:137], v33 offset:32768
  ds_read_b64_tr_b16 a[138:139], v33 offset:34816
  ds_read_b64_tr_b16 a[140:141], v33 offset:49152
  ds_read_b64_tr_b16 a[142:143], v33 offset:51200
  v_cvt_pk_bf16_f32 v75, v18, v19
  v_mfma_f32_16x16x32_bf16 v[216:219], a[152:155], v[80:83], v[216:219]
  buffer_load_dwordx4 v46, s[8:11], s38 offen offset:2048 lds
  s_waitcnt vmcnt(24)
  v_accvgpr_read_b32 v76, a44
  v_mfma_f32_16x16x32_bf16 v[216:219], a[156:159], v[88:91], v[216:219]
  ds_read_b64_tr_b16 a[144:145], v34 offset:32768
  v_fma_mix_f32 v16, v76, v104, v108 op_sel:[0,0,0] op_sel_hi:[1,1,1]
  v_mfma_f32_16x16x32_bf16 v[220:223], a[152:155], v[84:87], v[220:223]
  ds_read_b64_tr_b16 a[146:147], v34 offset:34816
  ds_read_b64_tr_b16 a[148:149], v34 offset:49152
  ds_read_b64_tr_b16 a[150:151], v34 offset:51200
  v_fma_mix_f32 v17, v76, v104, v108 op_sel:[1,1,1] op_sel_hi:[1,1,1]
  v_mfma_f32_16x16x32_bf16 v[220:223], a[156:159], v[92:95], v[220:223]
  v_cvt_pk_bf16_f32 v76, v16, v17
  v_accvgpr_read_b32 v77, a45
  v_mfma_f32_16x16x32_bf16 v[224:227], a[160:163], v[80:83], v[224:227]
  buffer_load_dwordx4 v47, s[8:11], s38 offen offset:3072 lds
  s_add_u32 s56, s54, 10240
  v_fma_mix_f32 v18, v77, v105, v109 op_sel:[0,0,0] op_sel_hi:[1,1,1]
  v_mfma_f32_16x16x32_bf16 v[224:227], a[164:167], v[88:91], v[224:227]
  ds_read_b64_tr_b16 a[152:153], v35 offset:32768
  v_fma_mix_f32 v19, v77, v105, v109 op_sel:[1,1,1] op_sel_hi:[1,1,1]
  v_mfma_f32_16x16x32_bf16 v[228:231], a[160:163], v[84:87], v[228:231]
  ds_read_b64_tr_b16 a[154:155], v35 offset:34816
  ds_read_b64_tr_b16 a[156:157], v35 offset:49152
  ds_read_b64_tr_b16 a[158:159], v35 offset:51200
  v_cvt_pk_bf16_f32 v77, v18, v19
  v_mfma_f32_16x16x32_bf16 v[228:231], a[164:167], v[92:95], v[228:231]
  v_accvgpr_read_b32 v78, a46
  v_fma_mix_f32 v16, v78, v106, v110 op_sel:[0,0,0] op_sel_hi:[1,1,1]
  v_mfma_f32_16x16x32_bf16 v[232:235], a[168:171], v[80:83], v[232:235]
  buffer_load_dwordx4 a[80:83], v57, s[24:27], s56 offen offset:0
  v_mfma_f32_16x16x32_bf16 v[232:235], a[172:175], v[88:91], v[232:235]
  ds_read_b64_tr_b16 a[160:161], v36 offset:32768
  v_fma_mix_f32 v17, v78, v106, v110 op_sel:[1,1,1] op_sel_hi:[1,1,1]
  v_mfma_f32_16x16x32_bf16 v[236:239], a[168:171], v[84:87], v[236:239]
  ds_read_b64_tr_b16 a[162:163], v36 offset:34816
  ds_read_b64_tr_b16 a[164:165], v36 offset:49152
  ds_read_b64_tr_b16 a[166:167], v36 offset:51200
  v_cvt_pk_bf16_f32 v78, v16, v17
  v_accvgpr_read_b32 v79, a47
  v_mfma_f32_16x16x32_bf16 v[236:239], a[172:175], v[92:95], v[236:239]
  v_fma_mix_f32 v18, v79, v107, v111 op_sel:[0,0,0] op_sel_hi:[1,1,1]
  v_fma_mix_f32 v19, v79, v107, v111 op_sel:[1,1,1] op_sel_hi:[1,1,1]
  v_mfma_f32_16x16x32_bf16 v[240:243], a[176:179], v[80:83], v[240:243]
  buffer_load_dwordx4 a[88:91], v57, s[24:27], s56 offen offset:1024
  s_add_u32 s56, s55, 10240
  v_mfma_f32_16x16x32_bf16 v[240:243], a[180:183], v[88:91], v[240:243]
  ds_read_b64_tr_b16 a[168:169], v37 offset:32768
  v_cvt_pk_bf16_f32 v79, v18, v19
  v_mfma_f32_16x16x32_bf16 v[244:247], a[176:179], v[84:87], v[244:247]
  ds_read_b64_tr_b16 a[170:171], v37 offset:34816
  ds_read_b64_tr_b16 a[172:173], v37 offset:49152
  ds_read_b64_tr_b16 a[174:175], v37 offset:51200
  ds_read_b128 v[112:115], v30 offset:768
  v_mfma_f32_16x16x32_bf16 v[244:247], a[180:183], v[92:95], v[244:247]
  ds_read_b128 v[116:119], v30 offset:784
  ds_read_b128 v[120:123], v30 offset:896
  v_mfma_f32_16x16x32_bf16 v[248:251], a[184:187], v[80:83], v[248:251]
  buffer_load_dwordx4 a[84:87], v57, s[24:27], s56 offen offset:0
  v_mfma_f32_16x16x32_bf16 v[248:251], a[188:191], v[88:91], v[248:251]
  ds_read_b128 v[124:127], v30 offset:912
  ds_read_b64_tr_b16 a[176:177], v38 offset:32768
  v_mfma_f32_16x16x32_bf16 v[252:255], a[184:187], v[84:87], v[252:255]
  ds_read_b64_tr_b16 a[178:179], v38 offset:34816
  ds_read_b64_tr_b16 a[180:181], v38 offset:49152
  ds_read_b64_tr_b16 a[182:183], v38 offset:51200
  v_mfma_f32_16x16x32_bf16 v[252:255], a[188:191], v[92:95], v[252:255]
  s_waitcnt lgkmcnt(15)
  ds_read_b64_tr_b16 a[184:185], v39 offset:32768
  v_mfma_f32_16x16x32_bf16 v[128:131], a[128:131], v[64:67], v[128:131]
  buffer_load_dwordx4 a[92:95], v57, s[24:27], s56 offen offset:1024
  s_mov_b32 s38, 2621440
  s_add_u32 m0, s33, 65536
  v_mfma_f32_16x16x32_bf16 v[128:131], a[132:135], v[72:75], v[128:131]
  ds_read_b64_tr_b16 a[186:187], v39 offset:34816
  ds_read_b64_tr_b16 a[188:189], v39 offset:49152
  v_mfma_f32_16x16x32_bf16 v[132:135], a[128:131], v[68:71], v[132:135]
  ds_read_b64_tr_b16 a[190:191], v39 offset:51200
  s_waitcnt vmcnt(28)
  v_accvgpr_read_b32 v80, a48
  s_waitcnt lgkmcnt(10)
  v_fma_mix_f32 v16, v80, v112, v116 op_sel:[0,0,0] op_sel_hi:[1,1,1]
  v_mfma_f32_16x16x32_bf16 v[132:135], a[132:135], v[76:79], v[132:135]
  v_fma_mix_f32 v17, v80, v112, v116 op_sel:[1,1,1] op_sel_hi:[1,1,1]
  v_cvt_pk_bf16_f32 v80, v16, v17
  v_mfma_f32_16x16x32_bf16 v[136:139], a[136:139], v[64:67], v[136:139]
  buffer_load_dwordx4 v40, s[8:11], s38 offen offset:0 lds
  v_mfma_f32_16x16x32_bf16 v[136:139], a[140:143], v[72:75], v[136:139]
  ds_read_b64_tr_b16 a[128:129], v32 offset:33024
  v_accvgpr_read_b32 v81, a49
  v_mfma_f32_16x16x32_bf16 v[140:143], a[136:139], v[68:71], v[140:143]
  ds_read_b64_tr_b16 a[130:131], v32 offset:35072
  ds_read_b64_tr_b16 a[132:133], v32 offset:49408
  ds_read_b64_tr_b16 a[134:135], v32 offset:51456
  v_fma_mix_f32 v18, v81, v113, v117 op_sel:[0,0,0] op_sel_hi:[1,1,1]
  v_mfma_f32_16x16x32_bf16 v[140:143], a[140:143], v[76:79], v[140:143]
  v_fma_mix_f32 v19, v81, v113, v117 op_sel:[1,1,1] op_sel_hi:[1,1,1]
  v_cvt_pk_bf16_f32 v81, v18, v19
  v_mfma_f32_16x16x32_bf16 v[144:147], a[144:147], v[64:67], v[144:147]
  buffer_load_dwordx4 v41, s[8:11], s38 offen offset:1024 lds
  v_mfma_f32_16x16x32_bf16 v[144:147], a[148:151], v[72:75], v[144:147]
  v_accvgpr_read_b32 v82, a50
  v_fma_mix_f32 v16, v82, v114, v118 op_sel:[0,0,0] op_sel_hi:[1,1,1]
  v_mfma_f32_16x16x32_bf16 v[148:151], a[144:147], v[68:71], v[148:151]
  ds_read_b64_tr_b16 a[136:137], v33 offset:33024
  ds_read_b64_tr_b16 a[138:139], v33 offset:35072
  ds_read_b64_tr_b16 a[140:141], v33 offset:49408
  ds_read_b64_tr_b16 a[142:143], v33 offset:51456
  v_fma_mix_f32 v17, v82, v114, v118 op_sel:[1,1,1] op_sel_hi:[1,1,1]
  v_mfma_f32_16x16x32_bf16 v[148:151], a[148:151], v[76:79], v[148:151]
  v_cvt_pk_bf16_f32 v82, v16, v17
  v_accvgpr_read_b32 v83, a51
  v_mfma_f32_16x16x32_bf16 v[152:155], a[152:155], v[64:67], v[152:155]
  buffer_load_dwordx4 v42, s[8:11], s38 offen offset:2048 lds
  v_mfma_f32_16x16x32_bf16 v[152:155], a[156:159], v[72:75], v[152:155]
  ds_read_b64_tr_b16 a[144:145], v34 offset:33024
  v_fma_mix_f32 v18, v83, v115, v119 op_sel:[0,0,0] op_sel_hi:[1,1,1]
  v_mfma_f32_16x16x32_bf16 v[156:159], a[152:155], v[68:71], v[156:159]
  ds_read_b64_tr_b16 a[146:147], v34 offset:35072
  ds_read_b64_tr_b16 a[148:149], v34 offset:49408
  ds_read_b64_tr_b16 a[150:151], v34 offset:51456
  v_fma_mix_f32 v19, v83, v115, v119 op_sel:[1,1,1] op_sel_hi:[1,1,1]
  v_mfma_f32_16x16x32_bf16 v[156:159], a[156:159], v[76:79], v[156:159]
  s_waitcnt lgkmcnt(12)
  v_cvt_pk_bf16_f32 v83, v18, v19
  v_mfma_f32_16x16x32_bf16 v[160:163], a[160:163], v[64:67], v[160:163]
  buffer_load_dwordx4 v43, s[8:11], s38 offen offset:3072 lds
  s_add_u32 s38, s38, 65536
  s_add_u32 m0, s33, 69632
  s_waitcnt vmcnt(30)
  v_accvgpr_read_b32 v84, a52
  v_mfma_f32_16x16x32_bf16 v[160:163], a[164:167], v[72:75], v[160:163]
  v_fma_mix_f32 v16, v84, v112, v116 op_sel:[0,0,0] op_sel_hi:[1,1,1]
  v_fma_mix_f32 v17, v84, v112, v116 op_sel:[1,1,1] op_sel_hi:[1,1,1]
  v_mfma_f32_16x16x32_bf16 v[164:167], a[160:163], v[68:71], v[164:167]
  ds_read_b64_tr_b16 a[152:153], v35 offset:33024
  ds_read_b64_tr_b16 a[154:155], v35 offset:35072
  ds_read_b64_tr_b16 a[156:157], v35 offset:49408
  ds_read_b64_tr_b16 a[158:159], v35 offset:51456
  v_cvt_pk_bf16_f32 v84, v16, v17
  v_mfma_f32_16x16x32_bf16 v[164:167], a[164:167], v[76:79], v[164:167]
  v_accvgpr_read_b32 v85, a53
  v_fma_mix_f32 v18, v85, v113, v117 op_sel:[0,0,0] op_sel_hi:[1,1,1]
  v_mfma_f32_16x16x32_bf16 v[168:171], a[168:171], v[64:67], v[168:171]
  buffer_load_dwordx4 v44, s[8:11], s38 offen offset:0 lds
  v_mfma_f32_16x16x32_bf16 v[168:171], a[172:175], v[72:75], v[168:171]
  ds_read_b64_tr_b16 a[160:161], v36 offset:33024
  v_fma_mix_f32 v19, v85, v113, v117 op_sel:[1,1,1] op_sel_hi:[1,1,1]
  v_mfma_f32_16x16x32_bf16 v[172:175], a[168:171], v[68:71], v[172:175]
  ds_read_b64_tr_b16 a[162:163], v36 offset:35072
  ds_read_b64_tr_b16 a[164:165], v36 offset:49408
  ds_read_b64_tr_b16 a[166:167], v36 offset:51456
  v_cvt_pk_bf16_f32 v85, v18, v19
  v_mfma_f32_16x16x32_bf16 v[172:175], a[172:175], v[76:79], v[172:175]
  v_accvgpr_read_b32 v86, a54
  v_fma_mix_f32 v16, v86, v114, v118 op_sel:[0,0,0] op_sel_hi:[1,1,1]
  v_mfma_f32_16x16x32_bf16 v[176:179], a[176:179], v[64:67], v[176:179]
  buffer_load_dwordx4 v45, s[8:11], s38 offen offset:1024 lds
  v_fma_mix_f32 v17, v86, v114, v118 op_sel:[1,1,1] op_sel_hi:[1,1,1]
  v_mfma_f32_16x16x32_bf16 v[176:179], a[180:183], v[72:75], v[176:179]
  ds_read_b64_tr_b16 a[168:169], v37 offset:33024
  v_cvt_pk_bf16_f32 v86, v16, v17
  v_mfma_f32_16x16x32_bf16 v[180:183], a[176:179], v[68:71], v[180:183]
  ds_read_b64_tr_b16 a[170:171], v37 offset:35072
  ds_read_b64_tr_b16 a[172:173], v37 offset:49408
  ds_read_b64_tr_b16 a[174:175], v37 offset:51456
  v_accvgpr_read_b32 v87, a55
  v_mfma_f32_16x16x32_bf16 v[180:183], a[180:183], v[76:79], v[180:183]
  v_fma_mix_f32 v18, v87, v115, v119 op_sel:[0,0,0] op_sel_hi:[1,1,1]
  v_fma_mix_f32 v19, v87, v115, v119 op_sel:[1,1,1] op_sel_hi:[1,1,1]
  v_mfma_f32_16x16x32_bf16 v[184:187], a[184:187], v[64:67], v[184:187]
  buffer_load_dwordx4 v46, s[8:11], s38 offen offset:2048 lds
  v_mfma_f32_16x16x32_bf16 v[184:187], a[188:191], v[72:75], v[184:187]
  ds_read_b64_tr_b16 a[176:177], v38 offset:33024
  v_cvt_pk_bf16_f32 v87, v18, v19
  v_mfma_f32_16x16x32_bf16 v[188:191], a[184:187], v[68:71], v[188:191]
  ds_read_b64_tr_b16 a[178:179], v38 offset:35072
  ds_read_b64_tr_b16 a[180:181], v38 offset:49408
  ds_read_b64_tr_b16 a[182:183], v38 offset:51456
  v_accvgpr_read_b32 v88, a56
  v_mfma_f32_16x16x32_bf16 v[188:191], a[188:191], v[76:79], v[188:191]
  s_waitcnt lgkmcnt(12)
  v_fma_mix_f32 v16, v88, v120, v124 op_sel:[0,0,0] op_sel_hi:[1,1,1]
  v_mfma_f32_16x16x32_bf16 v[192:195], a[128:131], v[64:67], v[192:195]
  buffer_load_dwordx4 v47, s[8:11], s38 offen offset:3072 lds
  s_add_u32 s56, s54, 12288
  v_fma_mix_f32 v17, v88, v120, v124 op_sel:[1,1,1] op_sel_hi:[1,1,1]
  v_cvt_pk_bf16_f32 v88, v16, v17
  v_mfma_f32_16x16x32_bf16 v[192:195], a[132:135], v[72:75], v[192:195]
  ds_read_b64_tr_b16 a[184:185], v39 offset:33024
  v_accvgpr_read_b32 v89, a57
  v_mfma_f32_16x16x32_bf16 v[196:199], a[128:131], v[68:71], v[196:199]
  ds_read_b64_tr_b16 a[186:187], v39 offset:35072
  ds_read_b64_tr_b16 a[188:189], v39 offset:49408
  ds_read_b64_tr_b16 a[190:191], v39 offset:51456
  v_fma_mix_f32 v18, v89, v121, v125 op_sel:[0,0,0] op_sel_hi:[1,1,1]
  v_mfma_f32_16x16x32_bf16 v[196:199], a[132:135], v[76:79], v[196:199]
  v_fma_mix_f32 v19, v89, v121, v125 op_sel:[1,1,1] op_sel_hi:[1,1,1]
  v_cvt_pk_bf16_f32 v89, v18, v19
  v_mfma_f32_16x16x32_bf16 v[200:203], a[136:139], v[64:67], v[200:203]
  buffer_load_dwordx4 a[96:99], v57, s[24:27], s56 offen offset:0
  v_mfma_f32_16x16x32_bf16 v[200:203], a[140:143], v[72:75], v[200:203]
  v_accvgpr_read_b32 v90, a58
  v_fma_mix_f32 v16, v90, v122, v126 op_sel:[0,0,0] op_sel_hi:[1,1,1]
  v_mfma_f32_16x16x32_bf16 v[204:207], a[136:139], v[68:71], v[204:207]
  v_fma_mix_f32 v17, v90, v122, v126 op_sel:[1,1,1] op_sel_hi:[1,1,1]
  v_cvt_pk_bf16_f32 v90, v16, v17
  v_mfma_f32_16x16x32_bf16 v[204:207], a[140:143], v[76:79], v[204:207]
  s_waitcnt vmcnt(26) lgkmcnt(0)
  s_barrier
  v_mfma_f32_16x16x32_bf16 v[208:211], a[144:147], v[64:67], v[208:211]
  buffer_load_dwordx4 a[104:107], v57, s[24:27], s56 offen offset:1024
  s_add_u32 s56, s55, 12288
  v_accvgpr_read_b32 v91, a59
  v_mfma_f32_16x16x32_bf16 v[208:211], a[148:151], v[72:75], v[208:211]
  v_fma_mix_f32 v18, v91, v123, v127 op_sel:[0,0,0] op_sel_hi:[1,1,1]
  v_fma_mix_f32 v19, v91, v123, v127 op_sel:[1,1,1] op_sel_hi:[1,1,1]
  v_mfma_f32_16x16x32_bf16 v[212:215], a[144:147], v[68:71], v[212:215]
  ds_read_b64_tr_b16 a[128:129], v4 offset:0
  ds_read_b64_tr_b16 a[130:131], v4 offset:2048
  v_mfma_f32_16x16x32_bf16 v[212:215], a[148:151], v[76:79], v[212:215]
  ds_read_b64_tr_b16 a[132:133], v4 offset:16384
  ds_read_b64_tr_b16 a[134:135], v4 offset:18432
  ds_read_b64_tr_b16 a[136:137], v5 offset:0
  ds_read_b64_tr_b16 a[138:139], v5 offset:2048
  ds_read_b64_tr_b16 a[140:141], v5 offset:16384
  ds_read_b64_tr_b16 a[142:143], v5 offset:18432
  v_cvt_pk_bf16_f32 v91, v18, v19
  v_mfma_f32_16x16x32_bf16 v[216:219], a[152:155], v[64:67], v[216:219]
  buffer_load_dwordx4 a[100:103], v57, s[24:27], s56 offen offset:0
  v_accvgpr_read_b32 v92, a60
  v_mfma_f32_16x16x32_bf16 v[216:219], a[156:159], v[72:75], v[216:219]
  ds_read_b64_tr_b16 a[144:145], v6 offset:0
  v_fma_mix_f32 v16, v92, v120, v124 op_sel:[0,0,0] op_sel_hi:[1,1,1]
  v_mfma_f32_16x16x32_bf16 v[220:223], a[152:155], v[68:71], v[220:223]
  ds_read_b64_tr_b16 a[146:147], v6 offset:2048
  ds_read_b64_tr_b16 a[148:149], v6 offset:16384
  ds_read_b64_tr_b16 a[150:151], v6 offset:18432
  v_fma_mix_f32 v17, v92, v120, v124 op_sel:[1,1,1] op_sel_hi:[1,1,1]
  v_mfma_f32_16x16x32_bf16 v[220:223], a[156:159], v[76:79], v[220:223]
  v_cvt_pk_bf16_f32 v92, v16, v17
  v_accvgpr_read_b32 v93, a61
  v_mfma_f32_16x16x32_bf16 v[224:227], a[160:163], v[64:67], v[224:227]
  buffer_load_dwordx4 a[108:111], v57, s[24:27], s56 offen offset:1024
  v_fma_mix_f32 v18, v93, v121, v125 op_sel:[0,0,0] op_sel_hi:[1,1,1]
  v_mfma_f32_16x16x32_bf16 v[224:227], a[164:167], v[72:75], v[224:227]
  ds_read_b64_tr_b16 a[152:153], v7 offset:0
  v_fma_mix_f32 v19, v93, v121, v125 op_sel:[1,1,1] op_sel_hi:[1,1,1]
  v_mfma_f32_16x16x32_bf16 v[228:231], a[160:163], v[68:71], v[228:231]
  ds_read_b64_tr_b16 a[154:155], v7 offset:2048
  ds_read_b64_tr_b16 a[156:157], v7 offset:16384
  ds_read_b64_tr_b16 a[158:159], v7 offset:18432
  v_cvt_pk_bf16_f32 v93, v18, v19
  v_mfma_f32_16x16x32_bf16 v[228:231], a[164:167], v[76:79], v[228:231]
  v_accvgpr_read_b32 v94, a62
  v_fma_mix_f32 v16, v94, v122, v126 op_sel:[0,0,0] op_sel_hi:[1,1,1]
  v_mfma_f32_16x16x32_bf16 v[232:235], a[168:171], v[64:67], v[232:235]
  v_add_u32 v58, 0x10000, v58
  buffer_store_dword v58, v56, s[24:27], 0 offen sc1
  s_mov_b32 s38, 3145728
  s_add_u32 m0, s33, 98304
  v_mfma_f32_16x16x32_bf16 v[232:235], a[172:175], v[72:75], v[232:235]
  ds_read_b64_tr_b16 a[160:161], v8 offset:0
  v_fma_mix_f32 v17, v94, v122, v126 op_sel:[1,1,1] op_sel_hi:[1,1,1]
  v_mfma_f32_16x16x32_bf16 v[236:239], a[168:171], v[68:71], v[236:239]
  ds_read_b64_tr_b16 a[162:163], v8 offset:2048
  ds_read_b64_tr_b16 a[164:165], v8 offset:16384
  ds_read_b64_tr_b16 a[166:167], v8 offset:18432
  v_cvt_pk_bf16_f32 v94, v16, v17
  v_accvgpr_read_b32 v95, a63
  v_mfma_f32_16x16x32_bf16 v[236:239], a[172:175], v[76:79], v[236:239]
  v_fma_mix_f32 v18, v95, v123, v127 op_sel:[0,0,0] op_sel_hi:[1,1,1]
  v_fma_mix_f32 v19, v95, v123, v127 op_sel:[1,1,1] op_sel_hi:[1,1,1]
  v_mfma_f32_16x16x32_bf16 v[240:243], a[176:179], v[64:67], v[240:243]
  buffer_load_dwordx4 v40, s[8:11], s38 offen offset:0 lds
  v_mfma_f32_16x16x32_bf16 v[240:243], a[180:183], v[72:75], v[240:243]
  ds_read_b64_tr_b16 a[168:169], v9 offset:0
  v_cvt_pk_bf16_f32 v95, v18, v19
  v_mfma_f32_16x16x32_bf16 v[244:247], a[176:179], v[68:71], v[244:247]
  ds_read_b64_tr_b16 a[170:171], v9 offset:2048
  ds_read_b64_tr_b16 a[172:173], v9 offset:16384
  ds_read_b64_tr_b16 a[174:175], v9 offset:18432
  ds_read_b128 v[96:99], v30 offset:1024
  v_mfma_f32_16x16x32_bf16 v[244:247], a[180:183], v[76:79], v[244:247]
  ds_read_b128 v[100:103], v30 offset:1040
  ds_read_b128 v[104:107], v30 offset:1152
  v_mfma_f32_16x16x32_bf16 v[248:251], a[184:187], v[64:67], v[248:251]
  buffer_load_dwordx4 v41, s[8:11], s38 offen offset:1024 lds
  v_mfma_f32_16x16x32_bf16 v[248:251], a[188:191], v[72:75], v[248:251]
  ds_read_b128 v[108:111], v30 offset:1168
  ds_read_b64_tr_b16 a[176:177], v10 offset:0
  v_mfma_f32_16x16x32_bf16 v[252:255], a[184:187], v[68:71], v[252:255]
  ds_read_b64_tr_b16 a[178:179], v10 offset:2048
  ds_read_b64_tr_b16 a[180:181], v10 offset:16384
  ds_read_b64_tr_b16 a[182:183], v10 offset:18432
  v_mfma_f32_16x16x32_bf16 v[252:255], a[188:191], v[76:79], v[252:255]
  s_waitcnt lgkmcnt(15)
  ds_read_b64_tr_b16 a[184:185], v11 offset:0
  v_mfma_f32_16x16x32_bf16 v[128:131], a[128:131], v[80:83], v[128:131]
  buffer_load_dwordx4 v42, s[8:11], s38 offen offset:2048 lds
  v_mfma_f32_16x16x32_bf16 v[128:131], a[132:135], v[88:91], v[128:131]
  ds_read_b64_tr_b16 a[186:187], v11 offset:2048
  ds_read_b64_tr_b16 a[188:189], v11 offset:16384
  v_mfma_f32_16x16x32_bf16 v[132:135], a[128:131], v[84:87], v[132:135]
  ds_read_b64_tr_b16 a[190:191], v11 offset:18432
  s_waitcnt vmcnt(31)
  v_accvgpr_read_b32 v64, a64
  s_waitcnt lgkmcnt(10)
  v_fma_mix_f32 v16, v64, v96, v100 op_sel:[0,0,0] op_sel_hi:[1,1,1]
  v_mfma_f32_16x16x32_bf16 v[132:135], a[132:135], v[92:95], v[132:135]
  v_fma_mix_f32 v17, v64, v96, v100 op_sel:[1,1,1] op_sel_hi:[1,1,1]
  v_cvt_pk_bf16_f32 v64, v16, v17
  v_mfma_f32_16x16x32_bf16 v[136:139], a[136:139], v[80:83], v[136:139]
  buffer_load_dwordx4 v43, s[8:11], s38 offen offset:3072 lds
  s_add_u32 s38, s38, 65536
  s_add_u32 m0, s33, 102400
  v_mfma_f32_16x16x32_bf16 v[136:139], a[140:143], v[88:91], v[136:139]
  ds_read_b64_tr_b16 a[128:129], v4 offset:256
  v_accvgpr_read_b32 v65, a65
  v_mfma_f32_16x16x32_bf16 v[140:143], a[136:139], v[84:87], v[140:143]
  ds_read_b64_tr_b16 a[130:131], v4 offset:2304
  ds_read_b64_tr_b16 a[132:133], v4 offset:16640
  ds_read_b64_tr_b16 a[134:135], v4 offset:18688
  v_fma_mix_f32 v18, v65, v97, v101 op_sel:[0,0,0] op_sel_hi:[1,1,1]
  v_mfma_f32_16x16x32_bf16 v[140:143], a[140:143], v[92:95], v[140:143]
  v_fma_mix_f32 v19, v65, v97, v101 op_sel:[1,1,1] op_sel_hi:[1,1,1]
  v_cvt_pk_bf16_f32 v65, v18, v19
  v_mfma_f32_16x16x32_bf16 v[144:147], a[144:147], v[80:83], v[144:147]
  buffer_load_dwordx4 v44, s[8:11], s38 offen offset:0 lds
  v_mfma_f32_16x16x32_bf16 v[144:147], a[148:151], v[88:91], v[144:147]
  v_accvgpr_read_b32 v66, a66
  v_fma_mix_f32 v16, v66, v98, v102 op_sel:[0,0,0] op_sel_hi:[1,1,1]
  v_mfma_f32_16x16x32_bf16 v[148:151], a[144:147], v[84:87], v[148:151]
  ds_read_b64_tr_b16 a[136:137], v5 offset:256
  ds_read_b64_tr_b16 a[138:139], v5 offset:2304
  ds_read_b64_tr_b16 a[140:141], v5 offset:16640
  ds_read_b64_tr_b16 a[142:143], v5 offset:18688
  v_fma_mix_f32 v17, v66, v98, v102 op_sel:[1,1,1] op_sel_hi:[1,1,1]
  v_mfma_f32_16x16x32_bf16 v[148:151], a[148:151], v[92:95], v[148:151]
  v_cvt_pk_bf16_f32 v66, v16, v17
  v_accvgpr_read_b32 v67, a67
  v_mfma_f32_16x16x32_bf16 v[152:155], a[152:155], v[80:83], v[152:155]
  buffer_load_dwordx4 v45, s[8:11], s38 offen offset:1024 lds
  v_mfma_f32_16x16x32_bf16 v[152:155], a[156:159], v[88:91], v[152:155]
  ds_read_b64_tr_b16 a[144:145], v6 offset:256
  v_fma_mix_f32 v18, v67, v99, v103 op_sel:[0,0,0] op_sel_hi:[1,1,1]
  v_mfma_f32_16x16x32_bf16 v[156:159], a[152:155], v[84:87], v[156:159]
  ds_read_b64_tr_b16 a[146:147], v6 offset:2304
  ds_read_b64_tr_b16 a[148:149], v6 offset:16640
  ds_read_b64_tr_b16 a[150:151], v6 offset:18688
  v_fma_mix_f32 v19, v67, v99, v103 op_sel:[1,1,1] op_sel_hi:[1,1,1]
  v_mfma_f32_16x16x32_bf16 v[156:159], a[156:159], v[92:95], v[156:159]
  s_waitcnt lgkmcnt(12)
  v_cvt_pk_bf16_f32 v67, v18, v19
  v_mfma_f32_16x16x32_bf16 v[160:163], a[160:163], v[80:83], v[160:163]
  buffer_load_dwordx4 v46, s[8:11], s38 offen offset:2048 lds
  s_waitcnt vmcnt(33)
  v_accvgpr_read_b32 v68, a68
  v_mfma_f32_16x16x32_bf16 v[160:163], a[164:167], v[88:91], v[160:163]
  v_fma_mix_f32 v16, v68, v96, v100 op_sel:[0,0,0] op_sel_hi:[1,1,1]
  v_fma_mix_f32 v17, v68, v96, v100 op_sel:[1,1,1] op_sel_hi:[1,1,1]
  v_mfma_f32_16x16x32_bf16 v[164:167], a[160:163], v[84:87], v[164:167]
  ds_read_b64_tr_b16 a[152:153], v7 offset:256
  ds_read_b64_tr_b16 a[154:155], v7 offset:2304
  ds_read_b64_tr_b16 a[156:157], v7 offset:16640
  ds_read_b64_tr_b16 a[158:159], v7 offset:18688
  v_cvt_pk_bf16_f32 v68, v16, v17
  v_mfma_f32_16x16x32_bf16 v[164:167], a[164:167], v[92:95], v[164:167]
  v_accvgpr_read_b32 v69, a69
  v_fma_mix_f32 v18, v69, v97, v101 op_sel:[0,0,0] op_sel_hi:[1,1,1]
  v_mfma_f32_16x16x32_bf16 v[168:171], a[168:171], v[80:83], v[168:171]
  buffer_load_dwordx4 v47, s[8:11], s38 offen offset:3072 lds
  v_mfma_f32_16x16x32_bf16 v[168:171], a[172:175], v[88:91], v[168:171]
  ds_read_b64_tr_b16 a[160:161], v8 offset:256
  v_fma_mix_f32 v19, v69, v97, v101 op_sel:[1,1,1] op_sel_hi:[1,1,1]
  v_mfma_f32_16x16x32_bf16 v[172:175], a[168:171], v[84:87], v[172:175]
  ds_read_b64_tr_b16 a[162:163], v8 offset:2304
  ds_read_b64_tr_b16 a[164:165], v8 offset:16640
  ds_read_b64_tr_b16 a[166:167], v8 offset:18688
  v_cvt_pk_bf16_f32 v69, v18, v19
  v_mfma_f32_16x16x32_bf16 v[172:175], a[172:175], v[92:95], v[172:175]
  v_accvgpr_read_b32 v70, a70
  v_fma_mix_f32 v16, v70, v98, v102 op_sel:[0,0,0] op_sel_hi:[1,1,1]
  v_mfma_f32_16x16x32_bf16 v[176:179], a[176:179], v[80:83], v[176:179]
  v_fma_mix_f32 v17, v70, v98, v102 op_sel:[1,1,1] op_sel_hi:[1,1,1]
  v_cvt_pk_bf16_f32 v70, v16, v17
  v_mfma_f32_16x16x32_bf16 v[176:179], a[180:183], v[88:91], v[176:179]
  ds_read_b64_tr_b16 a[168:169], v9 offset:256
  ds_read_b64_tr_b16 a[170:171], v9 offset:2304
  v_mfma_f32_16x16x32_bf16 v[180:183], a[176:179], v[84:87], v[180:183]
  ds_read_b64_tr_b16 a[172:173], v9 offset:16640
  ds_read_b64_tr_b16 a[174:175], v9 offset:18688
  v_accvgpr_read_b32 v71, a71
  v_mfma_f32_16x16x32_bf16 v[180:183], a[180:183], v[92:95], v[180:183]
  v_fma_mix_f32 v18, v71, v99, v103 op_sel:[0,0,0] op_sel_hi:[1,1,1]
  v_fma_mix_f32 v19, v71, v99, v103 op_sel:[1,1,1] op_sel_hi:[1,1,1]
  v_mfma_f32_16x16x32_bf16 v[184:187], a[184:187], v[80:83], v[184:187]
  ds_read_b64_tr_b16 a[176:177], v10 offset:256
  v_cvt_pk_bf16_f32 v71, v18, v19
  v_mfma_f32_16x16x32_bf16 v[184:187], a[188:191], v[88:91], v[184:187]
  ds_read_b64_tr_b16 a[178:179], v10 offset:2304
  ds_read_b64_tr_b16 a[180:181], v10 offset:16640
  v_mfma_f32_16x16x32_bf16 v[188:191], a[184:187], v[84:87], v[188:191]
  ds_read_b64_tr_b16 a[182:183], v10 offset:18688
  v_accvgpr_read_b32 v72, a72
  v_mfma_f32_16x16x32_bf16 v[188:191], a[188:191], v[92:95], v[188:191]
  s_waitcnt lgkmcnt(12)
  v_fma_mix_f32 v16, v72, v104, v108 op_sel:[0,0,0] op_sel_hi:[1,1,1]
  v_mfma_f32_16x16x32_bf16 v[192:195], a[128:131], v[80:83], v[192:195]
  v_fma_mix_f32 v17, v72, v104, v108 op_sel:[1,1,1] op_sel_hi:[1,1,1]
  v_cvt_pk_bf16_f32 v72, v16, v17
  v_mfma_f32_16x16x32_bf16 v[192:195], a[132:135], v[88:91], v[192:195]
  ds_read_b64_tr_b16 a[184:185], v11 offset:256
  v_accvgpr_read_b32 v73, a73
  v_mfma_f32_16x16x32_bf16 v[196:199], a[128:131], v[84:87], v[196:199]
  ds_read_b64_tr_b16 a[186:187], v11 offset:2304
  ds_read_b64_tr_b16 a[188:189], v11 offset:16640
  ds_read_b64_tr_b16 a[190:191], v11 offset:18688
  v_fma_mix_f32 v18, v73, v105, v109 op_sel:[0,0,0] op_sel_hi:[1,1,1]
  v_mfma_f32_16x16x32_bf16 v[196:199], a[132:135], v[92:95], v[196:199]
  v_fma_mix_f32 v19, v73, v105, v109 op_sel:[1,1,1] op_sel_hi:[1,1,1]
  v_cvt_pk_bf16_f32 v73, v18, v19
  v_mfma_f32_16x16x32_bf16 v[200:203], a[136:139], v[80:83], v[200:203]
  v_accvgpr_read_b32 v74, a74
  v_fma_mix_f32 v16, v74, v106, v110 op_sel:[0,0,0] op_sel_hi:[1,1,1]
  v_mfma_f32_16x16x32_bf16 v[200:203], a[140:143], v[88:91], v[200:203]
  v_fma_mix_f32 v17, v74, v106, v110 op_sel:[1,1,1] op_sel_hi:[1,1,1]
  v_cvt_pk_bf16_f32 v74, v16, v17
  v_mfma_f32_16x16x32_bf16 v[204:207], a[136:139], v[84:87], v[204:207]
  v_accvgpr_read_b32 v75, a75
  v_mfma_f32_16x16x32_bf16 v[204:207], a[140:143], v[92:95], v[204:207]
  s_waitcnt vmcnt(25) lgkmcnt(0)
  s_barrier
  v_mfma_f32_16x16x32_bf16 v[208:211], a[144:147], v[80:83], v[208:211]
  s_add_u32 m0, s33, 0
  v_fma_mix_f32 v18, v75, v107, v111 op_sel:[0,0,0] op_sel_hi:[1,1,1]
  v_mfma_f32_16x16x32_bf16 v[208:211], a[148:151], v[88:91], v[208:211]
  ds_read_b64_tr_b16 a[128:129], v4 offset:32768
  v_fma_mix_f32 v19, v75, v107, v111 op_sel:[1,1,1] op_sel_hi:[1,1,1]
  v_mfma_f32_16x16x32_bf16 v[212:215], a[144:147], v[84:87], v[212:215]
  ds_read_b64_tr_b16 a[130:131], v4 offset:34816
  ds_read_b64_tr_b16 a[132:133], v4 offset:49152
  v_mfma_f32_16x16x32_bf16 v[212:215], a[148:151], v[92:95], v[212:215]
  buffer_load_dwordx4 v12, s[12:15], s34 offen offset:0 lds
  ds_read_b64_tr_b16 a[134:135], v4 offset:51200
  ds_read_b64_tr_b16 a[136:137], v5 offset:32768
  ds_read_b64_tr_b16 a[138:139], v5 offset:34816
  ds_read_b64_tr_b16 a[140:141], v5 offset:49152
  ds_read_b64_tr_b16 a[142:143], v5 offset:51200
  v_cvt_pk_bf16_f32 v75, v18, v19
  v_mfma_f32_16x16x32_bf16 v[216:219], a[152:155], v[80:83], v[216:219]
  v_accvgpr_read_b32 v76, a76
  v_fma_mix_f32 v16, v76, v104, v108 op_sel:[0,0,0] op_sel_hi:[1,1,1]
  v_mfma_f32_16x16x32_bf16 v[216:219], a[156:159], v[88:91], v[216:219]
  ds_read_b64_tr_b16 a[144:145], v6 offset:32768
  ds_read_b64_tr_b16 a[146:147], v6 offset:34816
  v_mfma_f32_16x16x32_bf16 v[220:223], a[152:155], v[84:87], v[220:223]
  ds_read_b64_tr_b16 a[148:149], v6 offset:49152
  ds_read_b64_tr_b16 a[150:151], v6 offset:51200
  v_fma_mix_f32 v17, v76, v104, v108 op_sel:[1,1,1] op_sel_hi:[1,1,1]
  v_mfma_f32_16x16x32_bf16 v[220:223], a[156:159], v[92:95], v[220:223]
  buffer_load_dwordx4 v13, s[12:15], s34 offen offset:1024 lds
  v_cvt_pk_bf16_f32 v76, v16, v17
  v_accvgpr_read_b32 v77, a77
  v_mfma_f32_16x16x32_bf16 v[224:227], a[160:163], v[80:83], v[224:227]
  v_fma_mix_f32 v18, v77, v105, v109 op_sel:[0,0,0] op_sel_hi:[1,1,1]
  v_fma_mix_f32 v19, v77, v105, v109 op_sel:[1,1,1] op_sel_hi:[1,1,1]
  v_mfma_f32_16x16x32_bf16 v[224:227], a[164:167], v[88:91], v[224:227]
  ds_read_b64_tr_b16 a[152:153], v7 offset:32768
  ds_read_b64_tr_b16 a[154:155], v7 offset:34816
  v_mfma_f32_16x16x32_bf16 v[228:231], a[160:163], v[84:87], v[228:231]
  ds_read_b64_tr_b16 a[156:157], v7 offset:49152
  ds_read_b64_tr_b16 a[158:159], v7 offset:51200
  v_cvt_pk_bf16_f32 v77, v18, v19
  v_mfma_f32_16x16x32_bf16 v[228:231], a[164:167], v[92:95], v[228:231]
  buffer_load_dwordx4 v14, s[12:15], s34 offen offset:2048 lds
  v_accvgpr_read_b32 v78, a78
  v_mfma_f32_16x16x32_bf16 v[232:235], a[168:171], v[80:83], v[232:235]
  v_fma_mix_f32 v16, v78, v106, v110 op_sel:[0,0,0] op_sel_hi:[1,1,1]
  v_fma_mix_f32 v17, v78, v106, v110 op_sel:[1,1,1] op_sel_hi:[1,1,1]
  v_mfma_f32_16x16x32_bf16 v[232:235], a[172:175], v[88:91], v[232:235]
  ds_read_b64_tr_b16 a[160:161], v8 offset:32768
  ds_read_b64_tr_b16 a[162:163], v8 offset:34816
  v_mfma_f32_16x16x32_bf16 v[236:239], a[168:171], v[84:87], v[236:239]
  ds_read_b64_tr_b16 a[164:165], v8 offset:49152
  ds_read_b64_tr_b16 a[166:167], v8 offset:51200
  v_cvt_pk_bf16_f32 v78, v16, v17
  v_accvgpr_read_b32 v79, a79
  v_mfma_f32_16x16x32_bf16 v[236:239], a[172:175], v[92:95], v[236:239]
  buffer_load_dwordx4 v15, s[12:15], s34 offen offset:3072 lds
  s_add_u32 s34, s34, 4096
  s_add_u32 m0, s33, 4096
  v_fma_mix_f32 v18, v79, v107, v111 op_sel:[0,0,0] op_sel_hi:[1,1,1]
  v_mfma_f32_16x16x32_bf16 v[240:243], a[176:179], v[80:83], v[240:243]
  v_fma_mix_f32 v19, v79, v107, v111 op_sel:[1,1,1] op_sel_hi:[1,1,1]
  v_cvt_pk_bf16_f32 v79, v18, v19
  v_mfma_f32_16x16x32_bf16 v[240:243], a[180:183], v[88:91], v[240:243]
  ds_read_b64_tr_b16 a[168:169], v9 offset:32768
  ds_read_b64_tr_b16 a[170:171], v9 offset:34816
  v_mfma_f32_16x16x32_bf16 v[244:247], a[176:179], v[84:87], v[244:247]
  ds_read_b64_tr_b16 a[172:173], v9 offset:49152
  ds_read_b64_tr_b16 a[174:175], v9 offset:51200
  ds_read_b128 v[112:115], v30 offset:1280
  v_mfma_f32_16x16x32_bf16 v[244:247], a[180:183], v[92:95], v[244:247]
  buffer_load_dwordx4 v12, s[12:15], s34 offen offset:0 lds
  ds_read_b128 v[116:119], v30 offset:1296
  v_mfma_f32_16x16x32_bf16 v[248:251], a[184:187], v[80:83], v[248:251]
  ds_read_b128 v[120:123], v30 offset:1408
  ds_read_b128 v[124:127], v30 offset:1424
  v_mfma_f32_16x16x32_bf16 v[248:251], a[188:191], v[88:91], v[248:251]
  ds_read_b64_tr_b16 a[176:177], v10 offset:32768
  ds_read_b64_tr_b16 a[178:179], v10 offset:34816
  v_mfma_f32_16x16x32_bf16 v[252:255], a[184:187], v[84:87], v[252:255]
  ds_read_b64_tr_b16 a[180:181], v10 offset:49152
  ds_read_b64_tr_b16 a[182:183], v10 offset:51200
  v_mfma_f32_16x16x32_bf16 v[252:255], a[188:191], v[92:95], v[252:255]
  buffer_load_dwordx4 v13, s[12:15], s34 offen offset:1024 lds
  s_waitcnt lgkmcnt(15)
  v_mfma_f32_16x16x32_bf16 v[128:131], a[128:131], v[64:67], v[128:131]
  ds_read_b64_tr_b16 a[184:185], v11 offset:32768
  ds_read_b64_tr_b16 a[186:187], v11 offset:34816
  v_mfma_f32_16x16x32_bf16 v[128:131], a[132:135], v[72:75], v[128:131]
  ds_read_b64_tr_b16 a[188:189], v11 offset:49152
  ds_read_b64_tr_b16 a[190:191], v11 offset:51200
  v_mfma_f32_16x16x32_bf16 v[132:135], a[128:131], v[68:71], v[132:135]
  s_waitcnt vmcnt(30)
  v_accvgpr_read_b32 v80, a80
  s_waitcnt lgkmcnt(10)
  v_fma_mix_f32 v16, v80, v112, v116 op_sel:[0,0,0] op_sel_hi:[1,1,1]
  v_mfma_f32_16x16x32_bf16 v[132:135], a[132:135], v[76:79], v[132:135]
  buffer_load_dwordx4 v14, s[12:15], s34 offen offset:2048 lds
  v_fma_mix_f32 v17, v80, v112, v116 op_sel:[1,1,1] op_sel_hi:[1,1,1]
  v_mfma_f32_16x16x32_bf16 v[136:139], a[136:139], v[64:67], v[136:139]
  v_cvt_pk_bf16_f32 v80, v16, v17
  v_accvgpr_read_b32 v81, a81
  v_mfma_f32_16x16x32_bf16 v[136:139], a[140:143], v[72:75], v[136:139]
  ds_read_b64_tr_b16 a[128:129], v4 offset:33024
  ds_read_b64_tr_b16 a[130:131], v4 offset:35072
  v_mfma_f32_16x16x32_bf16 v[140:143], a[136:139], v[68:71], v[140:143]
  ds_read_b64_tr_b16 a[132:133], v4 offset:49408
  ds_read_b64_tr_b16 a[134:135], v4 offset:51456
  v_fma_mix_f32 v18, v81, v113, v117 op_sel:[0,0,0] op_sel_hi:[1,1,1]
  v_mfma_f32_16x16x32_bf16 v[140:143], a[140:143], v[76:79], v[140:143]
  buffer_load_dwordx4 v15, s[12:15], s34 offen offset:3072 lds
  s_add_u32 s34, s34, 28672
  v_fma_mix_f32 v19, v81, v113, v117 op_sel:[1,1,1] op_sel_hi:[1,1,1]
  v_mfma_f32_16x16x32_bf16 v[144:147], a[144:147], v[64:67], v[144:147]
  v_cvt_pk_bf16_f32 v81, v18, v19
  v_accvgpr_read_b32 v82, a82
  v_mfma_f32_16x16x32_bf16 v[144:147], a[148:151], v[72:75], v[144:147]
  ds_read_b64_tr_b16 a[136:137], v5 offset:33024
  v_fma_mix_f32 v16, v82, v114, v118 op_sel:[0,0,0] op_sel_hi:[1,1,1]
  v_mfma_f32_16x16x32_bf16 v[148:151], a[144:147], v[68:71], v[148:151]
  ds_read_b64_tr_b16 a[138:139], v5 offset:35072
  ds_read_b64_tr_b16 a[140:141], v5 offset:49408
  ds_read_b64_tr_b16 a[142:143], v5 offset:51456
  v_fma_mix_f32 v17, v82, v114, v118 op_sel:[1,1,1] op_sel_hi:[1,1,1]
  v_mfma_f32_16x16x32_bf16 v[148:151], a[148:151], v[76:79], v[148:151]
  v_cvt_pk_bf16_f32 v82, v16, v17
  v_accvgpr_read_b32 v83, a83
  v_mfma_f32_16x16x32_bf16 v[152:155], a[152:155], v[64:67], v[152:155]
  ds_read_b64_tr_b16 a[144:145], v6 offset:33024
  v_fma_mix_f32 v18, v83, v115, v119 op_sel:[0,0,0] op_sel_hi:[1,1,1]
  v_mfma_f32_16x16x32_bf16 v[152:155], a[156:159], v[72:75], v[152:155]
  ds_read_b64_tr_b16 a[146:147], v6 offset:35072
  ds_read_b64_tr_b16 a[148:149], v6 offset:49408
  v_mfma_f32_16x16x32_bf16 v[156:159], a[152:155], v[68:71], v[156:159]
  ds_read_b64_tr_b16 a[150:151], v6 offset:51456
  v_fma_mix_f32 v19, v83, v115, v119 op_sel:[1,1,1] op_sel_hi:[1,1,1]
  v_mfma_f32_16x16x32_bf16 v[156:159], a[156:159], v[76:79], v[156:159]
  s_waitcnt lgkmcnt(12)
  v_cvt_pk_bf16_f32 v83, v18, v19
  v_mfma_f32_16x16x32_bf16 v[160:163], a[160:163], v[64:67], v[160:163]
  s_waitcnt vmcnt(30)
  v_accvgpr_read_b32 v84, a84
  v_fma_mix_f32 v16, v84, v112, v116 op_sel:[0,0,0] op_sel_hi:[1,1,1]
  v_mfma_f32_16x16x32_bf16 v[160:163], a[164:167], v[72:75], v[160:163]
  ds_read_b64_tr_b16 a[152:153], v7 offset:33024
  v_fma_mix_f32 v17, v84, v112, v116 op_sel:[1,1,1] op_sel_hi:[1,1,1]
  v_mfma_f32_16x16x32_bf16 v[164:167], a[160:163], v[68:71], v[164:167]
  ds_read_b64_tr_b16 a[154:155], v7 offset:35072
  ds_read_b64_tr_b16 a[156:157], v7 offset:49408
  ds_read_b64_tr_b16 a[158:159], v7 offset:51456
  v_cvt_pk_bf16_f32 v84, v16, v17
  v_mfma_f32_16x16x32_bf16 v[164:167], a[164:167], v[76:79], v[164:167]
  v_accvgpr_read_b32 v85, a85
  v_fma_mix_f32 v18, v85, v113, v117 op_sel:[0,0,0] op_sel_hi:[1,1,1]
  v_mfma_f32_16x16x32_bf16 v[168:171], a[168:171], v[64:67], v[168:171]
  ds_read_b64_tr_b16 a[160:161], v8 offset:33024
  v_fma_mix_f32 v19, v85, v113, v117 op_sel:[1,1,1] op_sel_hi:[1,1,1]
  v_mfma_f32_16x16x32_bf16 v[168:171], a[172:175], v[72:75], v[168:171]
  ds_read_b64_tr_b16 a[162:163], v8 offset:35072
  ds_read_b64_tr_b16 a[164:165], v8 offset:49408
  v_mfma_f32_16x16x32_bf16 v[172:175], a[168:171], v[68:71], v[172:175]
  ds_read_b64_tr_b16 a[166:167], v8 offset:51456
  v_cvt_pk_bf16_f32 v85, v18, v19
  v_mfma_f32_16x16x32_bf16 v[172:175], a[172:175], v[76:79], v[172:175]
  v_accvgpr_read_b32 v86, a86
  v_fma_mix_f32 v16, v86, v114, v118 op_sel:[0,0,0] op_sel_hi:[1,1,1]
  v_mfma_f32_16x16x32_bf16 v[176:179], a[176:179], v[64:67], v[176:179]
  v_fma_mix_f32 v17, v86, v114, v118 op_sel:[1,1,1] op_sel_hi:[1,1,1]
  v_cvt_pk_bf16_f32 v86, v16, v17
  v_mfma_f32_16x16x32_bf16 v[176:179], a[180:183], v[72:75], v[176:179]
  ds_read_b64_tr_b16 a[168:169], v9 offset:33024
  ds_read_b64_tr_b16 a[170:171], v9 offset:35072
  v_mfma_f32_16x16x32_bf16 v[180:183], a[176:179], v[68:71], v[180:183]
  ds_read_b64_tr_b16 a[172:173], v9 offset:49408
  ds_read_b64_tr_b16 a[174:175], v9 offset:51456
  v_accvgpr_read_b32 v87, a87
  v_mfma_f32_16x16x32_bf16 v[180:183], a[180:183], v[76:79], v[180:183]
  v_fma_mix_f32 v18, v87, v115, v119 op_sel:[0,0,0] op_sel_hi:[1,1,1]
  v_fma_mix_f32 v19, v87, v115, v119 op_sel:[1,1,1] op_sel_hi:[1,1,1]
  v_mfma_f32_16x16x32_bf16 v[184:187], a[184:187], v[64:67], v[184:187]
  ds_read_b64_tr_b16 a[176:177], v10 offset:33024
  v_cvt_pk_bf16_f32 v87, v18, v19
  v_mfma_f32_16x16x32_bf16 v[184:187], a[188:191], v[72:75], v[184:187]
  ds_read_b64_tr_b16 a[178:179], v10 offset:35072
  ds_read_b64_tr_b16 a[180:181], v10 offset:49408
  v_mfma_f32_16x16x32_bf16 v[188:191], a[184:187], v[68:71], v[188:191]
  ds_read_b64_tr_b16 a[182:183], v10 offset:51456
  v_accvgpr_read_b32 v88, a88
  v_mfma_f32_16x16x32_bf16 v[188:191], a[188:191], v[76:79], v[188:191]
  s_waitcnt lgkmcnt(12)
  v_fma_mix_f32 v16, v88, v120, v124 op_sel:[0,0,0] op_sel_hi:[1,1,1]
  v_mfma_f32_16x16x32_bf16 v[192:195], a[128:131], v[64:67], v[192:195]
  v_fma_mix_f32 v17, v88, v120, v124 op_sel:[1,1,1] op_sel_hi:[1,1,1]
  v_cvt_pk_bf16_f32 v88, v16, v17
  v_mfma_f32_16x16x32_bf16 v[192:195], a[132:135], v[72:75], v[192:195]
  ds_read_b64_tr_b16 a[184:185], v11 offset:33024
  v_accvgpr_read_b32 v89, a89
  v_mfma_f32_16x16x32_bf16 v[196:199], a[128:131], v[68:71], v[196:199]
  ds_read_b64_tr_b16 a[186:187], v11 offset:35072
  ds_read_b64_tr_b16 a[188:189], v11 offset:49408
  ds_read_b64_tr_b16 a[190:191], v11 offset:51456
  v_fma_mix_f32 v18, v89, v121, v125 op_sel:[0,0,0] op_sel_hi:[1,1,1]
  v_mfma_f32_16x16x32_bf16 v[196:199], a[132:135], v[76:79], v[196:199]
  v_fma_mix_f32 v19, v89, v121, v125 op_sel:[1,1,1] op_sel_hi:[1,1,1]
  v_cvt_pk_bf16_f32 v89, v18, v19
  v_mfma_f32_16x16x32_bf16 v[200:203], a[136:139], v[64:67], v[200:203]
  v_accvgpr_read_b32 v90, a90
  v_fma_mix_f32 v16, v90, v122, v126 op_sel:[0,0,0] op_sel_hi:[1,1,1]
  v_mfma_f32_16x16x32_bf16 v[200:203], a[140:143], v[72:75], v[200:203]
  v_fma_mix_f32 v17, v90, v122, v126 op_sel:[1,1,1] op_sel_hi:[1,1,1]
  v_cvt_pk_bf16_f32 v90, v16, v17
  v_mfma_f32_16x16x32_bf16 v[204:207], a[136:139], v[68:71], v[204:207]
  v_accvgpr_read_b32 v91, a91
  v_mfma_f32_16x16x32_bf16 v[204:207], a[140:143], v[76:79], v[204:207]
  s_waitcnt vmcnt(21) lgkmcnt(0)
  s_barrier
  v_mfma_f32_16x16x32_bf16 v[208:211], a[144:147], v[64:67], v[208:211]
  s_add_u32 m0, s33, 32768
  v_fma_mix_f32 v18, v91, v123, v127 op_sel:[0,0,0] op_sel_hi:[1,1,1]
  v_mfma_f32_16x16x32_bf16 v[208:211], a[148:151], v[72:75], v[208:211]
  ds_read_b64_tr_b16 a[128:129], v32 offset:0
  v_fma_mix_f32 v19, v91, v123, v127 op_sel:[1,1,1] op_sel_hi:[1,1,1]
  v_mfma_f32_16x16x32_bf16 v[212:215], a[144:147], v[68:71], v[212:215]
  ds_read_b64_tr_b16 a[130:131], v32 offset:2048
  ds_read_b64_tr_b16 a[132:133], v32 offset:16384
  v_mfma_f32_16x16x32_bf16 v[212:215], a[148:151], v[76:79], v[212:215]
  buffer_load_dwordx4 v12, s[12:15], s34 offen offset:0 lds
  ds_read_b64_tr_b16 a[134:135], v32 offset:18432
  ds_read_b64_tr_b16 a[136:137], v33 offset:0
  ds_read_b64_tr_b16 a[138:139], v33 offset:2048
  ds_read_b64_tr_b16 a[140:141], v33 offset:16384
  ds_read_b64_tr_b16 a[142:143], v33 offset:18432
  v_cvt_pk_bf16_f32 v91, v18, v19
  v_mfma_f32_16x16x32_bf16 v[216:219], a[152:155], v[64:67], v[216:219]
  v_accvgpr_read_b32 v92, a92
  v_fma_mix_f32 v16, v92, v120, v124 op_sel:[0,0,0] op_sel_hi:[1,1,1]
  v_mfma_f32_16x16x32_bf16 v[216:219], a[156:159], v[72:75], v[216:219]
  ds_read_b64_tr_b16 a[144:145], v34 offset:0
  ds_read_b64_tr_b16 a[146:147], v34 offset:2048
  v_mfma_f32_16x16x32_bf16 v[220:223], a[152:155], v[68:71], v[220:223]
  ds_read_b64_tr_b16 a[148:149], v34 offset:16384
  ds_read_b64_tr_b16 a[150:151], v34 offset:18432
  v_fma_mix_f32 v17, v92, v120, v124 op_sel:[1,1,1] op_sel_hi:[1,1,1]
  v_mfma_f32_16x16x32_bf16 v[220:223], a[156:159], v[76:79], v[220:223]
  buffer_load_dwordx4 v13, s[12:15], s34 offen offset:1024 lds
  v_cvt_pk_bf16_f32 v92, v16, v17
  v_accvgpr_read_b32 v93, a93
  v_mfma_f32_16x16x32_bf16 v[224:227], a[160:163], v[64:67], v[224:227]
  v_fma_mix_f32 v18, v93, v121, v125 op_sel:[0,0,0] op_sel_hi:[1,1,1]
  v_fma_mix_f32 v19, v93, v121, v125 op_sel:[1,1,1] op_sel_hi:[1,1,1]
  v_mfma_f32_16x16x32_bf16 v[224:227], a[164:167], v[72:75], v[224:227]
  ds_read_b64_tr_b16 a[152:153], v35 offset:0
  ds_read_b64_tr_b16 a[154:155], v35 offset:2048
  v_mfma_f32_16x16x32_bf16 v[228:231], a[160:163], v[68:71], v[228:231]
  ds_read_b64_tr_b16 a[156:157], v35 offset:16384
  ds_read_b64_tr_b16 a[158:159], v35 offset:18432
  v_cvt_pk_bf16_f32 v93, v18, v19
  v_mfma_f32_16x16x32_bf16 v[228:231], a[164:167], v[76:79], v[228:231]
  buffer_load_dwordx4 v14, s[12:15], s34 offen offset:2048 lds
  v_accvgpr_read_b32 v94, a94
  v_mfma_f32_16x16x32_bf16 v[232:235], a[168:171], v[64:67], v[232:235]
  v_fma_mix_f32 v16, v94, v122, v126 op_sel:[0,0,0] op_sel_hi:[1,1,1]
  v_fma_mix_f32 v17, v94, v122, v126 op_sel:[1,1,1] op_sel_hi:[1,1,1]
  v_mfma_f32_16x16x32_bf16 v[232:235], a[172:175], v[72:75], v[232:235]
  ds_read_b64_tr_b16 a[160:161], v36 offset:0
  ds_read_b64_tr_b16 a[162:163], v36 offset:2048
  v_mfma_f32_16x16x32_bf16 v[236:239], a[168:171], v[68:71], v[236:239]
  ds_read_b64_tr_b16 a[164:165], v36 offset:16384
  ds_read_b64_tr_b16 a[166:167], v36 offset:18432
  v_cvt_pk_bf16_f32 v94, v16, v17
  v_accvgpr_read_b32 v95, a95
  v_mfma_f32_16x16x32_bf16 v[236:239], a[172:175], v[76:79], v[236:239]
  buffer_load_dwordx4 v15, s[12:15], s34 offen offset:3072 lds
  s_add_u32 s34, s34, 4096
  s_add_u32 m0, s33, 36864
  v_fma_mix_f32 v18, v95, v123, v127 op_sel:[0,0,0] op_sel_hi:[1,1,1]
  v_mfma_f32_16x16x32_bf16 v[240:243], a[176:179], v[64:67], v[240:243]
  v_fma_mix_f32 v19, v95, v123, v127 op_sel:[1,1,1] op_sel_hi:[1,1,1]
  v_cvt_pk_bf16_f32 v95, v18, v19
  v_mfma_f32_16x16x32_bf16 v[240:243], a[180:183], v[72:75], v[240:243]
  ds_read_b64_tr_b16 a[168:169], v37 offset:0
  ds_read_b64_tr_b16 a[170:171], v37 offset:2048
  v_mfma_f32_16x16x32_bf16 v[244:247], a[176:179], v[68:71], v[244:247]
  ds_read_b64_tr_b16 a[172:173], v37 offset:16384
  ds_read_b64_tr_b16 a[174:175], v37 offset:18432
  ds_read_b128 v[96:99], v30 offset:1536
  v_mfma_f32_16x16x32_bf16 v[244:247], a[180:183], v[76:79], v[244:247]
  buffer_load_dwordx4 v12, s[12:15], s34 offen offset:0 lds
  ds_read_b128 v[100:103], v30 offset:1552
  v_mfma_f32_16x16x32_bf16 v[248:251], a[184:187], v[64:67], v[248:251]
  ds_read_b128 v[104:107], v30 offset:1664
  ds_read_b128 v[108:111], v30 offset:1680
  v_mfma_f32_16x16x32_bf16 v[248:251], a[188:191], v[72:75], v[248:251]
  ds_read_b64_tr_b16 a[176:177], v38 offset:0
  ds_read_b64_tr_b16 a[178:179], v38 offset:2048
  v_mfma_f32_16x16x32_bf16 v[252:255], a[184:187], v[68:71], v[252:255]
  ds_read_b64_tr_b16 a[180:181], v38 offset:16384
  ds_read_b64_tr_b16 a[182:183], v38 offset:18432
  v_mfma_f32_16x16x32_bf16 v[252:255], a[188:191], v[76:79], v[252:255]
  buffer_load_dwordx4 v13, s[12:15], s34 offen offset:1024 lds
  s_waitcnt lgkmcnt(15)
  v_mfma_f32_16x16x32_bf16 v[128:131], a[128:131], v[80:83], v[128:131]
  ds_read_b64_tr_b16 a[184:185], v39 offset:0
  ds_read_b64_tr_b16 a[186:187], v39 offset:2048
  v_mfma_f32_16x16x32_bf16 v[128:131], a[132:135], v[88:91], v[128:131]
  ds_read_b64_tr_b16 a[188:189], v39 offset:16384
  ds_read_b64_tr_b16 a[190:191], v39 offset:18432
  v_mfma_f32_16x16x32_bf16 v[132:135], a[128:131], v[84:87], v[132:135]
  s_waitcnt vmcnt(26)
  v_accvgpr_read_b32 v64, a96
  s_waitcnt lgkmcnt(10)
  v_fma_mix_f32 v16, v64, v96, v100 op_sel:[0,0,0] op_sel_hi:[1,1,1]
  v_mfma_f32_16x16x32_bf16 v[132:135], a[132:135], v[92:95], v[132:135]
  buffer_load_dwordx4 v14, s[12:15], s34 offen offset:2048 lds
  v_fma_mix_f32 v17, v64, v96, v100 op_sel:[1,1,1] op_sel_hi:[1,1,1]
  v_mfma_f32_16x16x32_bf16 v[136:139], a[136:139], v[80:83], v[136:139]
  v_cvt_pk_bf16_f32 v64, v16, v17
  v_accvgpr_read_b32 v65, a97
  v_mfma_f32_16x16x32_bf16 v[136:139], a[140:143], v[88:91], v[136:139]
  ds_read_b64_tr_b16 a[128:129], v32 offset:256
  ds_read_b64_tr_b16 a[130:131], v32 offset:2304
  v_mfma_f32_16x16x32_bf16 v[140:143], a[136:139], v[84:87], v[140:143]
  ds_read_b64_tr_b16 a[132:133], v32 offset:16640
  ds_read_b64_tr_b16 a[134:135], v32 offset:18688
  v_fma_mix_f32 v18, v65, v97, v101 op_sel:[0,0,0] op_sel_hi:[1,1,1]
  v_mfma_f32_16x16x32_bf16 v[140:143], a[140:143], v[92:95], v[140:143]
  buffer_load_dwordx4 v15, s[12:15], s34 offen offset:3072 lds
  s_add_u32 s34, s34, 28672
  v_fma_mix_f32 v19, v65, v97, v101 op_sel:[1,1,1] op_sel_hi:[1,1,1]
  v_mfma_f32_16x16x32_bf16 v[144:147], a[144:147], v[80:83], v[144:147]
  v_cvt_pk_bf16_f32 v65, v18, v19
  v_accvgpr_read_b32 v66, a98
  v_mfma_f32_16x16x32_bf16 v[144:147], a[148:151], v[88:91], v[144:147]
  ds_read_b64_tr_b16 a[136:137], v33 offset:256
  ds_read_b64_tr_b16 a[138:139], v33 offset:2304
  v_mfma_f32_16x16x32_bf16 v[148:151], a[144:147], v[84:87], v[148:151]
  ds_read_b64_tr_b16 a[140:141], v33 offset:16640
  ds_read_b64_tr_b16 a[142:143], v33 offset:18688
  v_fma_mix_f32 v16, v66, v98, v102 op_sel:[0,0,0] op_sel_hi:[1,1,1]
  v_mfma_f32_16x16x32_bf16 v[148:151], a[148:151], v[92:95], v[148:151]
  v_fma_mix_f32 v17, v66, v98, v102 op_sel:[1,1,1] op_sel_hi:[1,1,1]
  v_cvt_pk_bf16_f32 v66, v16, v17
  v_mfma_f32_16x16x32_bf16 v[152:155], a[152:155], v[80:83], v[152:155]
  ds_read_b64_tr_b16 a[144:145], v34 offset:256
  v_accvgpr_read_b32 v67, a99
  v_mfma_f32_16x16x32_bf16 v[152:155], a[156:159], v[88:91], v[152:155]
  ds_read_b64_tr_b16 a[146:147], v34 offset:2304
  ds_read_b64_tr_b16 a[148:149], v34 offset:16640
  v_mfma_f32_16x16x32_bf16 v[156:159], a[152:155], v[84:87], v[156:159]
  ds_read_b64_tr_b16 a[150:151], v34 offset:18688
  v_fma_mix_f32 v18, v67, v99, v103 op_sel:[0,0,0] op_sel_hi:[1,1,1]
  v_mfma_f32_16x16x32_bf16 v[156:159], a[156:159], v[92:95], v[156:159]
  s_waitcnt lgkmcnt(12)
  v_fma_mix_f32 v19, v67, v99, v103 op_sel:[1,1,1] op_sel_hi:[1,1,1]
  v_mfma_f32_16x16x32_bf16 v[160:163], a[160:163], v[80:83], v[160:163]
  v_cvt_pk_bf16_f32 v67, v18, v19
  s_waitcnt vmcnt(26)
  v_accvgpr_read_b32 v68, a100
  v_mfma_f32_16x16x32_bf16 v[160:163], a[164:167], v[88:91], v[160:163]
  ds_read_b64_tr_b16 a[152:153], v35 offset:256
  v_fma_mix_f32 v16, v68, v96, v100 op_sel:[0,0,0] op_sel_hi:[1,1,1]
  v_mfma_f32_16x16x32_bf16 v[164:167], a[160:163], v[84:87], v[164:167]
  ds_read_b64_tr_b16 a[154:155], v35 offset:2304
  ds_read_b64_tr_b16 a[156:157], v35 offset:16640
  ds_read_b64_tr_b16 a[158:159], v35 offset:18688
  v_fma_mix_f32 v17, v68, v96, v100 op_sel:[1,1,1] op_sel_hi:[1,1,1]
  v_mfma_f32_16x16x32_bf16 v[164:167], a[164:167], v[92:95], v[164:167]
  v_cvt_pk_bf16_f32 v68, v16, v17
  v_accvgpr_read_b32 v69, a101
  v_mfma_f32_16x16x32_bf16 v[168:171], a[168:171], v[80:83], v[168:171]
  ds_read_b64_tr_b16 a[160:161], v36 offset:256
  v_fma_mix_f32 v18, v69, v97, v101 op_sel:[0,0,0] op_sel_hi:[1,1,1]
  v_mfma_f32_16x16x32_bf16 v[168:171], a[172:175], v[88:91], v[168:171]
  ds_read_b64_tr_b16 a[162:163], v36 offset:2304
  ds_read_b64_tr_b16 a[164:165], v36 offset:16640
  v_mfma_f32_16x16x32_bf16 v[172:175], a[168:171], v[84:87], v[172:175]
  ds_read_b64_tr_b16 a[166:167], v36 offset:18688
  v_fma_mix_f32 v19, v69, v97, v101 op_sel:[1,1,1] op_sel_hi:[1,1,1]
  v_mfma_f32_16x16x32_bf16 v[172:175], a[172:175], v[92:95], v[172:175]
  v_cvt_pk_bf16_f32 v69, v18, v19
  v_accvgpr_read_b32 v70, a102
  v_mfma_f32_16x16x32_bf16 v[176:179], a[176:179], v[80:83], v[176:179]
  ds_read_b64_tr_b16 a[168:169], v37 offset:256
  v_fma_mix_f32 v16, v70, v98, v102 op_sel:[0,0,0] op_sel_hi:[1,1,1]
  v_mfma_f32_16x16x32_bf16 v[176:179], a[180:183], v[88:91], v[176:179]
  ds_read_b64_tr_b16 a[170:171], v37 offset:2304
  ds_read_b64_tr_b16 a[172:173], v37 offset:16640
  v_mfma_f32_16x16x32_bf16 v[180:183], a[176:179], v[84:87], v[180:183]
  ds_read_b64_tr_b16 a[174:175], v37 offset:18688
  v_fma_mix_f32 v17, v70, v98, v102 op_sel:[1,1,1] op_sel_hi:[1,1,1]
  v_mfma_f32_16x16x32_bf16 v[180:183], a[180:183], v[92:95], v[180:183]
  v_cvt_pk_bf16_f32 v70, v16, v17
  v_accvgpr_read_b32 v71, a103
  v_mfma_f32_16x16x32_bf16 v[184:187], a[184:187], v[80:83], v[184:187]
  ds_read_b64_tr_b16 a[176:177], v38 offset:256
  v_fma_mix_f32 v18, v71, v99, v103 op_sel:[0,0,0] op_sel_hi:[1,1,1]
  v_mfma_f32_16x16x32_bf16 v[184:187], a[188:191], v[88:91], v[184:187]
  ds_read_b64_tr_b16 a[178:179], v38 offset:2304
  ds_read_b64_tr_b16 a[180:181], v38 offset:16640
  v_mfma_f32_16x16x32_bf16 v[188:191], a[184:187], v[84:87], v[188:191]
  ds_read_b64_tr_b16 a[182:183], v38 offset:18688
  v_fma_mix_f32 v19, v71, v99, v103 op_sel:[1,1,1] op_sel_hi:[1,1,1]
  v_mfma_f32_16x16x32_bf16 v[188:191], a[188:191], v[92:95], v[188:191]
  s_waitcnt lgkmcnt(12)
  v_cvt_pk_bf16_f32 v71, v18, v19
  v_mfma_f32_16x16x32_bf16 v[192:195], a[128:131], v[80:83], v[192:195]
  v_accvgpr_read_b32 v72, a104
  v_fma_mix_f32 v16, v72, v104, v108 op_sel:[0,0,0] op_sel_hi:[1,1,1]
  v_mfma_f32_16x16x32_bf16 v[192:195], a[132:135], v[88:91], v[192:195]
  ds_read_b64_tr_b16 a[184:185], v39 offset:256
  v_fma_mix_f32 v17, v72, v104, v108 op_sel:[1,1,1] op_sel_hi:[1,1,1]
  v_mfma_f32_16x16x32_bf16 v[196:199], a[128:131], v[84:87], v[196:199]
  ds_read_b64_tr_b16 a[186:187], v39 offset:2304
  ds_read_b64_tr_b16 a[188:189], v39 offset:16640
  ds_read_b64_tr_b16 a[190:191], v39 offset:18688
  v_cvt_pk_bf16_f32 v72, v16, v17
  v_mfma_f32_16x16x32_bf16 v[196:199], a[132:135], v[92:95], v[196:199]
  v_accvgpr_read_b32 v73, a105
  v_fma_mix_f32 v18, v73, v105, v109 op_sel:[0,0,0] op_sel_hi:[1,1,1]
  v_mfma_f32_16x16x32_bf16 v[200:203], a[136:139], v[80:83], v[200:203]
  v_fma_mix_f32 v19, v73, v105, v109 op_sel:[1,1,1] op_sel_hi:[1,1,1]
  v_cvt_pk_bf16_f32 v73, v18, v19
  v_mfma_f32_16x16x32_bf16 v[200:203], a[140:143], v[88:91], v[200:203]
  v_accvgpr_read_b32 v74, a106
  v_mfma_f32_16x16x32_bf16 v[204:207], a[136:139], v[84:87], v[204:207]
  v_fma_mix_f32 v16, v74, v106, v110 op_sel:[0,0,0] op_sel_hi:[1,1,1]
  v_mfma_f32_16x16x32_bf16 v[204:207], a[140:143], v[92:95], v[204:207]
  s_waitcnt vmcnt(16) lgkmcnt(0)
  s_barrier
  v_mfma_f32_16x16x32_bf16 v[208:211], a[144:147], v[80:83], v[208:211]
  s_add_u32 m0, s33, 65536
  v_fma_mix_f32 v17, v74, v106, v110 op_sel:[1,1,1] op_sel_hi:[1,1,1]
  v_mfma_f32_16x16x32_bf16 v[208:211], a[148:151], v[88:91], v[208:211]
  ds_read_b64_tr_b16 a[128:129], v32 offset:32768
  v_cvt_pk_bf16_f32 v74, v16, v17
  v_mfma_f32_16x16x32_bf16 v[212:215], a[144:147], v[84:87], v[212:215]
  ds_read_b64_tr_b16 a[130:131], v32 offset:34816
  ds_read_b64_tr_b16 a[132:133], v32 offset:49152
  v_mfma_f32_16x16x32_bf16 v[212:215], a[148:151], v[92:95], v[212:215]
  buffer_load_dwordx4 v12, s[16:19], s35 offen offset:0 lds
  ds_read_b64_tr_b16 a[134:135], v32 offset:51200
  ds_read_b64_tr_b16 a[136:137], v33 offset:32768
  ds_read_b64_tr_b16 a[138:139], v33 offset:34816
  ds_read_b64_tr_b16 a[140:141], v33 offset:49152
  ds_read_b64_tr_b16 a[142:143], v33 offset:51200
  v_accvgpr_read_b32 v75, a107
  v_mfma_f32_16x16x32_bf16 v[216:219], a[152:155], v[80:83], v[216:219]
  v_fma_mix_f32 v18, v75, v107, v111 op_sel:[0,0,0] op_sel_hi:[1,1,1]
  v_fma_mix_f32 v19, v75, v107, v111 op_sel:[1,1,1] op_sel_hi:[1,1,1]
  v_mfma_f32_16x16x32_bf16 v[216:219], a[156:159], v[88:91], v[216:219]
  ds_read_b64_tr_b16 a[144:145], v34 offset:32768
  ds_read_b64_tr_b16 a[146:147], v34 offset:34816
  v_mfma_f32_16x16x32_bf16 v[220:223], a[152:155], v[84:87], v[220:223]
  ds_read_b64_tr_b16 a[148:149], v34 offset:49152
  ds_read_b64_tr_b16 a[150:151], v34 offset:51200
  v_cvt_pk_bf16_f32 v75, v18, v19
  v_mfma_f32_16x16x32_bf16 v[220:223], a[156:159], v[92:95], v[220:223]
  buffer_load_dwordx4 v13, s[16:19], s35 offen offset:1024 lds
  v_accvgpr_read_b32 v76, a108
  v_fma_mix_f32 v16, v76, v104, v108 op_sel:[0,0,0] op_sel_hi:[1,1,1]
  v_mfma_f32_16x16x32_bf16 v[224:227], a[160:163], v[80:83], v[224:227]
  v_fma_mix_f32 v17, v76, v104, v108 op_sel:[1,1,1] op_sel_hi:[1,1,1]
  v_cvt_pk_bf16_f32 v76, v16, v17
  v_mfma_f32_16x16x32_bf16 v[224:227], a[164:167], v[88:91], v[224:227]
  ds_read_b64_tr_b16 a[152:153], v35 offset:32768
  ds_read_b64_tr_b16 a[154:155], v35 offset:34816
  v_mfma_f32_16x16x32_bf16 v[228:231], a[160:163], v[84:87], v[228:231]
  ds_read_b64_tr_b16 a[156:157], v35 offset:49152
  ds_read_b64_tr_b16 a[158:159], v35 offset:51200
  v_accvgpr_read_b32 v77, a109
  v_mfma_f32_16x16x32_bf16 v[228:231], a[164:167], v[92:95], v[228:231]
  buffer_load_dwordx4 v14, s[16:19], s35 offen offset:2048 lds
  v_fma_mix_f32 v18, v77, v105, v109 op_sel:[0,0,0] op_sel_hi:[1,1,1]
  v_mfma_f32_16x16x32_bf16 v[232:235], a[168:171], v[80:83], v[232:235]
  v_fma_mix_f32 v19, v77, v105, v109 op_sel:[1,1,1] op_sel_hi:[1,1,1]
  v_cvt_pk_bf16_f32 v77, v18, v19
  v_mfma_f32_16x16x32_bf16 v[232:235], a[172:175], v[88:91], v[232:235]
  ds_read_b64_tr_b16 a[160:161], v36 offset:32768
  ds_read_b64_tr_b16 a[162:163], v36 offset:34816
  v_mfma_f32_16x16x32_bf16 v[236:239], a[168:171], v[84:87], v[236:239]
  ds_read_b64_tr_b16 a[164:165], v36 offset:49152
  ds_read_b64_tr_b16 a[166:167], v36 offset:51200
  v_accvgpr_read_b32 v78, a110
  v_mfma_f32_16x16x32_bf16 v[236:239], a[172:175], v[92:95], v[236:239]
  buffer_load_dwordx4 v15, s[16:19], s35 offen offset:3072 lds
  s_add_u32 s35, s35, 4096
  s_add_u32 m0, s33, 69632
  v_fma_mix_f32 v16, v78, v106, v110 op_sel:[0,0,0] op_sel_hi:[1,1,1]
  v_mfma_f32_16x16x32_bf16 v[240:243], a[176:179], v[80:83], v[240:243]
  v_fma_mix_f32 v17, v78, v106, v110 op_sel:[1,1,1] op_sel_hi:[1,1,1]
  v_cvt_pk_bf16_f32 v78, v16, v17
  v_mfma_f32_16x16x32_bf16 v[240:243], a[180:183], v[88:91], v[240:243]
  ds_read_b64_tr_b16 a[168:169], v37 offset:32768
  ds_read_b64_tr_b16 a[170:171], v37 offset:34816
  v_mfma_f32_16x16x32_bf16 v[244:247], a[176:179], v[84:87], v[244:247]
  ds_read_b64_tr_b16 a[172:173], v37 offset:49152
  ds_read_b64_tr_b16 a[174:175], v37 offset:51200
  v_accvgpr_read_b32 v79, a111
  v_mfma_f32_16x16x32_bf16 v[244:247], a[180:183], v[92:95], v[244:247]
  buffer_load_dwordx4 v12, s[16:19], s35 offen offset:0 lds
  v_fma_mix_f32 v18, v79, v107, v111 op_sel:[0,0,0] op_sel_hi:[1,1,1]
  v_mfma_f32_16x16x32_bf16 v[248:251], a[184:187], v[80:83], v[248:251]
  v_fma_mix_f32 v19, v79, v107, v111 op_sel:[1,1,1] op_sel_hi:[1,1,1]
  v_cvt_pk_bf16_f32 v79, v18, v19
  v_mfma_f32_16x16x32_bf16 v[248:251], a[188:191], v[88:91], v[248:251]
  ds_read_b64_tr_b16 a[176:177], v38 offset:32768
  ds_read_b64_tr_b16 a[178:179], v38 offset:34816
  v_mfma_f32_16x16x32_bf16 v[252:255], a[184:187], v[84:87], v[252:255]
  ds_read_b64_tr_b16 a[180:181], v38 offset:49152
  ds_read_b64_tr_b16 a[182:183], v38 offset:51200
  v_mfma_f32_16x16x32_bf16 v[252:255], a[188:191], v[92:95], v[252:255]
  buffer_load_dwordx4 v13, s[16:19], s35 offen offset:1024 lds
  s_waitcnt lgkmcnt(12)
  v_mfma_f32_16x16x32_bf16 v[128:131], a[128:131], v[64:67], v[128:131]
  ds_read_b64_tr_b16 a[184:185], v39 offset:32768
  ds_read_b64_tr_b16 a[186:187], v39 offset:34816
  v_mfma_f32_16x16x32_bf16 v[128:131], a[132:135], v[72:75], v[128:131]
  ds_read_b64_tr_b16 a[188:189], v39 offset:49152
  ds_read_b64_tr_b16 a[190:191], v39 offset:51200
  v_mfma_f32_16x16x32_bf16 v[132:135], a[128:131], v[68:71], v[132:135]
  v_lshrrev_b32 v48, 2, v24
  s_lshl_b32 s57, s53, 14
  s_add_u32 s57, s57, 65536
  v_mfma_f32_16x16x32_bf16 v[132:135], a[132:135], v[76:79], v[132:135]
  buffer_load_dwordx4 v14, s[16:19], s35 offen offset:2048 lds
  v_lshl_add_u32 v49, v48, 9, s57
  v_and_b32 v50, 3, v24
  v_mfma_f32_16x16x32_bf16 v[136:139], a[136:139], v[64:67], v[136:139]
  v_lshl_add_u32 v49, v50, 3, v49
  v_and_b32 v50, 7, v48
  v_mfma_f32_16x16x32_bf16 v[136:139], a[140:143], v[72:75], v[136:139]
  v_xor_b32 v51, 0, v50
  v_lshl_add_u32 v4, v51, 5, v49
  v_mfma_f32_16x16x32_bf16 v[140:143], a[136:139], v[68:71], v[140:143]
  ds_read_b64_tr_b16 a[128:129], v32 offset:33024
  ds_read_b64_tr_b16 a[130:131], v32 offset:35072
  ds_read_b64_tr_b16 a[132:133], v32 offset:49408
  ds_read_b64_tr_b16 a[134:135], v32 offset:51456
  v_xor_b32 v51, 1, v50
  v_lshl_add_u32 v5, v51, 5, v49
  v_xor_b32 v51, 2, v50
  v_mfma_f32_16x16x32_bf16 v[140:143], a[140:143], v[76:79], v[140:143]
  buffer_load_dwordx4 v15, s[16:19], s35 offen offset:3072 lds
  s_add_u32 s35, s35, 28672
  v_lshl_add_u32 v6, v51, 5, v49
  v_xor_b32 v51, 3, v50
  v_mfma_f32_16x16x32_bf16 v[144:147], a[144:147], v[64:67], v[144:147]
  v_lshl_add_u32 v7, v51, 5, v49
  v_xor_b32 v51, 4, v50
  v_mfma_f32_16x16x32_bf16 v[144:147], a[148:151], v[72:75], v[144:147]
  v_lshl_add_u32 v8, v51, 5, v49
  v_xor_b32 v51, 5, v50
  v_mfma_f32_16x16x32_bf16 v[148:151], a[144:147], v[68:71], v[148:151]
  ds_read_b64_tr_b16 a[136:137], v33 offset:33024
  ds_read_b64_tr_b16 a[138:139], v33 offset:35072
  ds_read_b64_tr_b16 a[140:141], v33 offset:49408
  ds_read_b64_tr_b16 a[142:143], v33 offset:51456
  v_lshl_add_u32 v9, v51, 5, v49
  v_xor_b32 v51, 6, v50
  v_lshl_add_u32 v10, v51, 5, v49
  v_mfma_f32_16x16x32_bf16 v[148:151], a[148:151], v[76:79], v[148:151]
  v_add_u32 v58, 0x10000, v58
  buffer_store_dword v58, v56, s[24:27], 0 offen sc1
  v_add_u32 v31, 1, v31
  v_xor_b32 v51, 7, v50
  v_lshl_add_u32 v11, v51, 5, v49
  v_mfma_f32_16x16x32_bf16 v[152:155], a[152:155], v[64:67], v[152:155]
  v_mov_b32 v80, 0xff800000
  v_mov_b32 v81, 0xff800000
  v_mfma_f32_16x16x32_bf16 v[152:155], a[156:159], v[72:75], v[152:155]
  v_mov_b32 v82, 0xff800000
  v_mov_b32 v83, 0xff800000
  v_cvt_pk_bf16_f32 v128, v128, v129
  v_cvt_pk_bf16_f32 v129, v130, v131
  v_cvt_pk_bf16_f32 v130, v136, v137
  v_cvt_pk_bf16_f32 v131, v138, v139
  v_mfma_f32_16x16x32_bf16 v[156:159], a[152:155], v[68:71], v[156:159]
  ds_read_b64_tr_b16 a[144:145], v34 offset:33024
  ds_read_b64_tr_b16 a[146:147], v34 offset:35072
  ds_read_b64_tr_b16 a[148:149], v34 offset:49408
  ds_read_b64_tr_b16 a[150:151], v34 offset:51456
  v_cvt_pk_bf16_f32 v132, v132, v133
  v_cvt_pk_bf16_f32 v133, v134, v135
  v_mfma_f32_16x16x32_bf16 v[156:159], a[156:159], v[76:79], v[156:159]
  buffer_store_dword v31, v23, s[24:27], s97 offen sc1
  s_waitcnt lgkmcnt(12)
  v_cvt_pk_bf16_f32 v134, v140, v141
  v_mfma_f32_16x16x32_bf16 v[160:163], a[160:163], v[64:67], v[160:163]
  v_cvt_pk_bf16_f32 v135, v142, v143
  v_permlane32_swap_b32 v128, v130
  v_mfma_f32_16x16x32_bf16 v[160:163], a[164:167], v[72:75], v[160:163]
  v_permlane32_swap_b32 v129, v131
  v_permlane32_swap_b32 v132, v134
  v_mfma_f32_16x16x32_bf16 v[164:167], a[160:163], v[68:71], v[164:167]
  ds_read_b64_tr_b16 a[152:153], v35 offset:33024
  ds_read_b64_tr_b16 a[154:155], v35 offset:35072
  ds_read_b64_tr_b16 a[156:157], v35 offset:49408
  ds_read_b64_tr_b16 a[158:159], v35 offset:51456
  v_permlane32_swap_b32 v133, v135
  ds_write_b128 v21, v[128:131] offset:32768
  v_mfma_f32_16x16x32_bf16 v[164:167], a[164:167], v[76:79], v[164:167]
  ds_write_b128 v21, v[132:135] offset:33792
  v_mfma_f32_16x16x32_bf16 v[168:171], a[168:171], v[64:67], v[168:171]
  v_cvt_pk_bf16_f32 v144, v144, v145
  v_cvt_pk_bf16_f32 v145, v146, v147
  v_mfma_f32_16x16x32_bf16 v[168:171], a[172:175], v[72:75], v[168:171]
  v_cvt_pk_bf16_f32 v146, v152, v153
  v_cvt_pk_bf16_f32 v147, v154, v155
  v_mfma_f32_16x16x32_bf16 v[172:175], a[168:171], v[68:71], v[172:175]
  ds_read_b64_tr_b16 a[160:161], v36 offset:33024
  ds_read_b64_tr_b16 a[162:163], v36 offset:35072
  ds_read_b64_tr_b16 a[164:165], v36 offset:49408
  ds_read_b64_tr_b16 a[166:167], v36 offset:51456
  v_cvt_pk_bf16_f32 v148, v148, v149
  v_cvt_pk_bf16_f32 v149, v150, v151
  v_mfma_f32_16x16x32_bf16 v[172:175], a[172:175], v[76:79], v[172:175]
  v_cvt_pk_bf16_f32 v150, v156, v157
  v_cvt_pk_bf16_f32 v151, v158, v159
  v_mfma_f32_16x16x32_bf16 v[176:179], a[176:179], v[64:67], v[176:179]
  v_permlane32_swap_b32 v144, v146
  v_permlane32_swap_b32 v145, v147
  v_mfma_f32_16x16x32_bf16 v[176:179], a[180:183], v[72:75], v[176:179]
  ds_read_b64_tr_b16 a[168:169], v37 offset:33024
  v_permlane32_swap_b32 v148, v150
  v_mfma_f32_16x16x32_bf16 v[180:183], a[176:179], v[68:71], v[180:183]
  ds_read_b64_tr_b16 a[170:171], v37 offset:35072
  ds_read_b64_tr_b16 a[172:173], v37 offset:49408
  ds_read_b64_tr_b16 a[174:175], v37 offset:51456
  v_permlane32_swap_b32 v149, v151
  ds_write_b128 v21, v[144:147] offset:34816
  v_mfma_f32_16x16x32_bf16 v[180:183], a[180:183], v[76:79], v[180:183]
  ds_write_b128 v21, v[148:151] offset:35840
  v_mfma_f32_16x16x32_bf16 v[184:187], a[184:187], v[64:67], v[184:187]
  v_cvt_pk_bf16_f32 v160, v160, v161
  v_cvt_pk_bf16_f32 v161, v162, v163
  v_mfma_f32_16x16x32_bf16 v[184:187], a[188:191], v[72:75], v[184:187]
  v_cvt_pk_bf16_f32 v162, v168, v169
  v_cvt_pk_bf16_f32 v163, v170, v171
  v_mfma_f32_16x16x32_bf16 v[188:191], a[184:187], v[68:71], v[188:191]
  ds_read_b64_tr_b16 a[176:177], v38 offset:33024
  ds_read_b64_tr_b16 a[178:179], v38 offset:35072
  ds_read_b64_tr_b16 a[180:181], v38 offset:49408
  ds_read_b64_tr_b16 a[182:183], v38 offset:51456
  v_cvt_pk_bf16_f32 v164, v164, v165
  v_cvt_pk_bf16_f32 v165, v166, v167
  v_mfma_f32_16x16x32_bf16 v[188:191], a[188:191], v[76:79], v[188:191]
  s_waitcnt lgkmcnt(15)
  v_cvt_pk_bf16_f32 v166, v172, v173
  v_mfma_f32_16x16x32_bf16 v[192:195], a[128:131], v[64:67], v[192:195]
  v_cvt_pk_bf16_f32 v167, v174, v175
  v_permlane32_swap_b32 v160, v162
  v_mfma_f32_16x16x32_bf16 v[192:195], a[132:135], v[72:75], v[192:195]
  v_permlane32_swap_b32 v161, v163
  v_permlane32_swap_b32 v164, v166
  v_mfma_f32_16x16x32_bf16 v[196:199], a[128:131], v[68:71], v[196:199]
  ds_read_b64_tr_b16 a[184:185], v39 offset:33024
  ds_read_b64_tr_b16 a[186:187], v39 offset:35072
  ds_read_b64_tr_b16 a[188:189], v39 offset:49408
  ds_read_b64_tr_b16 a[190:191], v39 offset:51456
  v_permlane32_swap_b32 v165, v167
  ds_write_b128 v21, v[160:163] offset:36864
  v_mfma_f32_16x16x32_bf16 v[196:199], a[132:135], v[76:79], v[196:199]
  ds_write_b128 v21, v[164:167] offset:37888
  v_mfma_f32_16x16x32_bf16 v[200:203], a[136:139], v[64:67], v[200:203]
  v_cvt_pk_bf16_f32 v176, v176, v177
  v_cvt_pk_bf16_f32 v177, v178, v179
  v_mfma_f32_16x16x32_bf16 v[200:203], a[140:143], v[72:75], v[200:203]
  v_cvt_pk_bf16_f32 v178, v184, v185
  v_cvt_pk_bf16_f32 v179, v186, v187
  v_mfma_f32_16x16x32_bf16 v[204:207], a[136:139], v[68:71], v[204:207]
  v_cvt_pk_bf16_f32 v180, v180, v181
  v_cvt_pk_bf16_f32 v181, v182, v183
  v_mfma_f32_16x16x32_bf16 v[204:207], a[140:143], v[76:79], v[204:207]
  v_cvt_pk_bf16_f32 v182, v188, v189
  s_waitcnt vmcnt(18) lgkmcnt(0)
  s_barrier
  v_mfma_f32_16x16x32_bf16 v[208:211], a[144:147], v[64:67], v[208:211]
  v_cvt_pk_bf16_f32 v183, v190, v191
  v_permlane32_swap_b32 v176, v178
  v_mfma_f32_16x16x32_bf16 v[208:211], a[148:151], v[72:75], v[208:211]
  v_permlane32_swap_b32 v177, v179
  v_permlane32_swap_b32 v180, v182
  v_mfma_f32_16x16x32_bf16 v[212:215], a[144:147], v[68:71], v[212:215]
  ds_read_b128 v[96:99], v0 offset:0
  v_permlane32_swap_b32 v181, v183
  ds_write_b128 v21, v[176:179] offset:38912
  v_mfma_f32_16x16x32_bf16 v[212:215], a[148:151], v[76:79], v[212:215]
  ds_read_b128 v[100:103], v1 offset:0
  ds_write_b128 v21, v[180:183] offset:39936
  v_mfma_f32_16x16x32_bf16 v[216:219], a[152:155], v[64:67], v[216:219]
  ds_read_b128 v[104:107], v2 offset:0
  v_cvt_pk_bf16_f32 v192, v192, v193
  v_cvt_pk_bf16_f32 v193, v194, v195
  v_mfma_f32_16x16x32_bf16 v[216:219], a[156:159], v[72:75], v[216:219]
  ds_read_b128 v[108:111], v3 offset:0
  v_cvt_pk_bf16_f32 v194, v200, v201
  v_cvt_pk_bf16_f32 v195, v202, v203
  v_mfma_f32_16x16x32_bf16 v[220:223], a[152:155], v[68:71], v[220:223]
  v_cvt_pk_bf16_f32 v196, v196, v197
  v_cvt_pk_bf16_f32 v197, v198, v199
  v_mfma_f32_16x16x32_bf16 v[220:223], a[156:159], v[76:79], v[220:223]
  ds_read_b128 v[112:115], v0 offset:256
  v_cvt_pk_bf16_f32 v198, v204, v205
  v_mfma_f32_16x16x32_bf16 v[224:227], a[160:163], v[64:67], v[224:227]
  ds_read_b128 v[116:119], v1 offset:256
  v_cvt_pk_bf16_f32 v199, v206, v207
  v_permlane32_swap_b32 v192, v194
  v_mfma_f32_16x16x32_bf16 v[224:227], a[164:167], v[72:75], v[224:227]
  ds_read_b128 v[120:123], v2 offset:256
  v_permlane32_swap_b32 v193, v195
  v_permlane32_swap_b32 v196, v198
  v_mfma_f32_16x16x32_bf16 v[228:231], a[160:163], v[68:71], v[228:231]
  ds_read_b128 v[124:127], v3 offset:256
  v_permlane32_swap_b32 v197, v199
  ds_write_b128 v21, v[192:195] offset:0
  v_mfma_f32_16x16x32_bf16 v[228:231], a[164:167], v[76:79], v[228:231]
  ds_write_b128 v21, v[196:199] offset:1024
  v_mfma_f32_16x16x32_bf16 v[232:235], a[168:171], v[64:67], v[232:235]
  ds_read_b128 a[192:195], v0 offset:8192
  v_cvt_pk_bf16_f32 v208, v208, v209
  v_cvt_pk_bf16_f32 v209, v210, v211
  v_mfma_f32_16x16x32_bf16 v[232:235], a[172:175], v[72:75], v[232:235]
  ds_read_b128 a[196:199], v1 offset:8192
  v_cvt_pk_bf16_f32 v210, v216, v217
  v_cvt_pk_bf16_f32 v211, v218, v219
  v_mfma_f32_16x16x32_bf16 v[236:239], a[168:171], v[68:71], v[236:239]
  ds_read_b128 a[200:203], v2 offset:8192
  v_cvt_pk_bf16_f32 v212, v212, v213
  v_cvt_pk_bf16_f32 v213, v214, v215
  v_mfma_f32_16x16x32_bf16 v[236:239], a[172:175], v[76:79], v[236:239]
  ds_read_b128 a[204:207], v3 offset:8192
  v_cvt_pk_bf16_f32 v214, v220, v221
  v_mfma_f32_16x16x32_bf16 v[240:243], a[176:179], v[64:67], v[240:243]
  v_cvt_pk_bf16_f32 v215, v222, v223
  v_permlane32_swap_b32 v208, v210
  v_mfma_f32_16x16x32_bf16 v[240:243], a[180:183], v[72:75], v[240:243]
  ds_read_b128 a[208:211], v0 offset:8448
  v_permlane32_swap_b32 v209, v211
  v_permlane32_swap_b32 v212, v214
  v_mfma_f32_16x16x32_bf16 v[244:247], a[176:179], v[68:71], v[244:247]
  ds_read_b128 a[212:215], v1 offset:8448
  v_permlane32_swap_b32 v213, v215
  ds_write_b128 v21, v[208:211] offset:2048
  v_mfma_f32_16x16x32_bf16 v[244:247], a[180:183], v[76:79], v[244:247]
  ds_read_b128 a[216:219], v2 offset:8448
  ds_write_b128 v21, v[212:215] offset:3072
  v_mfma_f32_16x16x32_bf16 v[248:251], a[184:187], v[64:67], v[248:251]
  ds_read_b128 a[220:223], v3 offset:8448
  v_cvt_pk_bf16_f32 v224, v224, v225
  v_cvt_pk_bf16_f32 v225, v226, v227
  v_mfma_f32_16x16x32_bf16 v[248:251], a[188:191], v[72:75], v[248:251]
  v_cvt_pk_bf16_f32 v226, v232, v233
  v_cvt_pk_bf16_f32 v227, v234, v235
  v_mfma_f32_16x16x32_bf16 v[252:255], a[184:187], v[68:71], v[252:255]
  v_cvt_pk_bf16_f32 v228, v228, v229
  v_cvt_pk_bf16_f32 v229, v230, v231
  v_mfma_f32_16x16x32_bf16 v[252:255], a[188:191], v[76:79], v[252:255]
  v_cvt_pk_bf16_f32 v230, v236, v237
  v_cvt_pk_bf16_f32 v231, v238, v239
  v_permlane32_swap_b32 v224, v226
  v_permlane32_swap_b32 v225, v227
  v_permlane32_swap_b32 v228, v230
  v_permlane32_swap_b32 v229, v231
  ds_write_b128 v21, v[224:227] offset:4096
  ds_write_b128 v21, v[228:231] offset:5120
  v_cvt_pk_bf16_f32 v240, v240, v241
  v_cvt_pk_bf16_f32 v241, v242, v243
  v_cvt_pk_bf16_f32 v242, v248, v249
  v_cvt_pk_bf16_f32 v243, v250, v251
  v_cvt_pk_bf16_f32 v244, v244, v245
  v_cvt_pk_bf16_f32 v245, v246, v247
  v_cvt_pk_bf16_f32 v246, v252, v253
  v_cvt_pk_bf16_f32 v247, v254, v255
  v_permlane32_swap_b32 v240, v242
  v_permlane32_swap_b32 v241, v243
  v_permlane32_swap_b32 v244, v246
  v_permlane32_swap_b32 v245, v247
  ds_write_b128 v21, v[240:243] offset:6144
  ds_write_b128 v21, v[244:247] offset:7168
  s_cmp_lg_u32 s37, 0
  s_waitcnt vmcnt(10) lgkmcnt(0)
  s_barrier
  s_cbranch_scc1 L_k2_maxpass
L_k2_att:
  ds_read_b128 a[0:3], v21 offset:32768
  ds_read_b128 a[16:19], v21 offset:34816
  ds_read_b128 a[4:7], v21 offset:33792
  ds_read_b128 a[20:23], v21 offset:35840
  ds_read_b128 a[8:11], v22 offset:32768
  ds_read_b128 a[24:27], v22 offset:34816
  ds_read_b128 a[12:15], v22 offset:33792
  ds_read_b128 a[28:31], v22 offset:35840
  ds_read_b128 a[32:35], v21 offset:36864
  ds_read_b128 a[48:51], v21 offset:38912
  ds_read_b128 a[36:39], v21 offset:37888
  ds_read_b128 a[52:55], v21 offset:39936
  ds_read_b128 a[40:43], v22 offset:36864
  ds_read_b128 a[56:59], v22 offset:38912
  ds_read_b128 a[44:47], v22 offset:37888
  ds_read_b128 a[60:63], v22 offset:39936
  s_mov_b32 s36, 14
  s_waitcnt lgkmcnt(8)
  v_mfma_f32_16x16x32_bf16 v[64:67], v[96:99], a[0:3], 0
  s_mov_b32 s56, 2109440
  buffer_load_dwordx4 v[236:239], v20, s[24:27], s56 offen sc1
  v_mfma_f32_16x16x32_bf16 v[64:67], v[100:103], a[16:19], v[64:67]
  ds_read_b128 a[64:67], v21 offset:0
  ds_read_b128 a[80:83], v21 offset:2048
  v_mfma_f32_16x16x32_bf16 v[68:71], v[96:99], a[4:7], 0
  ds_read_b128 a[68:71], v21 offset:1024
  s_add_u32 m0, s33, 0
  v_mfma_f32_16x16x32_bf16 v[68:71], v[100:103], a[20:23], v[68:71]
  ds_read_b128 a[84:87], v21 offset:3072
  ds_read_b128 a[72:75], v22 offset:0
  v_mfma_f32_16x16x32_bf16 v[72:75], v[96:99], a[8:11], 0
  buffer_load_dwordx4 v12, s[12:15], s34 offen offset:0 lds
  v_mfma_f32_16x16x32_bf16 v[72:75], v[100:103], a[24:27], v[72:75]
  ds_read_b128 a[88:91], v22 offset:2048
  ds_read_b128 a[76:79], v22 offset:1024
  v_mfma_f32_16x16x32_bf16 v[76:79], v[96:99], a[12:15], 0
  s_waitcnt lgkmcnt(7)
  ds_read_b128 a[92:95], v22 offset:3072
  v_mfma_f32_16x16x32_bf16 v[76:79], v[100:103], a[28:31], v[76:79]
  buffer_load_dwordx4 v13, s[12:15], s34 offen offset:1024 lds
  v_mfma_f32_16x16x32_bf16 v[64:67], v[104:107], a[32:35], v[64:67]
  ds_read_b128 a[96:99], v21 offset:4096
  ds_read_b128 a[112:115], v21 offset:6144
  v_mfma_f32_16x16x32_bf16 v[64:67], v[108:111], a[48:51], v[64:67]
  buffer_load_dwordx4 v14, s[12:15], s34 offen offset:2048 lds
  v_mfma_f32_16x16x32_bf16 v[68:71], v[104:107], a[36:39], v[68:71]
  ds_read_b128 a[100:103], v21 offset:5120
  ds_read_b128 a[116:119], v21 offset:7168
  v_mfma_f32_16x16x32_bf16 v[68:71], v[108:111], a[52:55], v[68:71]
  buffer_load_dwordx4 v15, s[12:15], s34 offen offset:3072 lds
  v_mfma_f32_16x16x32_bf16 v[72:75], v[104:107], a[40:43], v[72:75]
  ds_read_b128 a[104:107], v22 offset:4096
  ds_read_b128 a[120:123], v22 offset:6144
  v_mfma_f32_16x16x32_bf16 v[72:75], v[108:111], a[56:59], v[72:75]
  ds_read_b128 a[108:111], v22 offset:5120
  s_waitcnt lgkmcnt(7)
  v_mfma_f32_16x16x32_bf16 v[76:79], v[104:107], a[44:47], v[76:79]
  s_add_u32 s34, s34, 4096
  ds_read_b128 a[124:127], v22 offset:7168
  v_mfma_f32_16x16x32_bf16 v[76:79], v[108:111], a[60:63], v[76:79]
  s_add_u32 m0, s33, 4096
  v_mfma_f32_16x16x32_bf16 v[64:67], v[112:115], a[64:67], v[64:67]
  ds_read_b128 v[96:99], v0 offset:32768
  v_mov_b32 v16, 0
  v_mfma_f32_16x16x32_bf16 v[64:67], v[116:119], a[80:83], v[64:67]
  buffer_load_dwordx4 v12, s[12:15], s34 offen offset:0 lds
  v_mfma_f32_16x16x32_bf16 v[68:71], v[112:115], a[68:71], v[68:71]
  ds_read_b128 v[100:103], v1 offset:32768
  ds_read_b128 v[104:107], v2 offset:32768
  v_mfma_f32_16x16x32_bf16 v[68:71], v[116:119], a[84:87], v[68:71]
  ds_read_b128 v[108:111], v3 offset:32768
  v_mov_b32 v17, 0
  v_mfma_f32_16x16x32_bf16 v[72:75], v[112:115], a[72:75], v[72:75]
  buffer_load_dwordx4 v13, s[12:15], s34 offen offset:1024 lds
  v_mfma_f32_16x16x32_bf16 v[72:75], v[116:119], a[88:91], v[72:75]
  s_waitcnt lgkmcnt(4)
  v_mov_b32 v18, 0
  v_mfma_f32_16x16x32_bf16 v[76:79], v[112:115], a[76:79], v[76:79]
  buffer_load_dwordx4 v14, s[12:15], s34 offen offset:2048 lds
  v_mfma_f32_16x16x32_bf16 v[76:79], v[116:119], a[92:95], v[76:79]
  ds_read_b128 v[112:115], v0 offset:33024
  ds_read_b128 v[116:119], v1 offset:33024
  v_mfma_f32_16x16x32_bf16 v[64:67], v[120:123], a[96:99], v[64:67]
  v_mov_b32 v19, 0
  v_mfma_f32_16x16x32_bf16 v[64:67], v[124:127], a[112:115], v[64:67]
  buffer_load_dwordx4 v15, s[12:15], s34 offen offset:3072 lds
  v_mfma_f32_16x16x32_bf16 v[68:71], v[120:123], a[100:103], v[68:71]
  v_mfma_f32_16x16x32_bf16 v[68:71], v[124:127], a[116:119], v[68:71]
  s_add_u32 s34, s34, 28672
  v_mfma_f32_16x16x32_bf16 v[72:75], v[120:123], a[104:107], v[72:75]
  v_mfma_f32_16x16x32_bf16 v[72:75], v[124:127], a[120:123], v[72:75]
  s_nop 1
  v_max3_f32 v80, v80, v64, v65
  v_max3_f32 v80, v80, v66, v67
  v_mfma_f32_16x16x32_bf16 v[76:79], v[120:123], a[108:111], v[76:79]
  v_mfma_f32_16x16x32_bf16 v[76:79], v[124:127], a[124:127], v[76:79]
  v_max3_f32 v81, v81, v68, v69
  v_max3_f32 v81, v81, v70, v71
  v_mfma_f32_16x16x32_bf16 v[240:243], a[192:195], a[0:3], 0
  ds_read_b128 v[120:123], v2 offset:33024
  ds_read_b128 v[124:127], v3 offset:33024
  v_mfma_f32_16x16x32_bf16 v[240:243], a[196:199], a[16:19], v[240:243]
  v_max3_f32 v82, v82, v72, v73
  v_max3_f32 v82, v82, v74, v75
  v_mfma_f32_16x16x32_bf16 v[244:247], a[192:195], a[4:7], 0
  v_mfma_f32_16x16x32_bf16 v[244:247], a[196:199], a[20:23], v[244:247]
  s_waitcnt lgkmcnt(0)
  s_barrier
  v_mfma_f32_16x16x32_bf16 v[248:251], a[192:195], a[8:11], 0
  v_max3_f32 v83, v83, v76, v77
  v_max3_f32 v83, v83, v78, v79
  v_mov_b32 v84, v80
  v_mov_b32 v85, v81
  v_mfma_f32_16x16x32_bf16 v[248:251], a[196:199], a[24:27], v[248:251]
  v_mov_b32 v86, v82
  v_mov_b32 v87, v83
  v_mfma_f32_16x16x32_bf16 v[252:255], a[192:195], a[12:15], 0
  v_permlane16_swap_b32 v80, v84
  v_permlane16_swap_b32 v81, v85
  v_mfma_f32_16x16x32_bf16 v[252:255], a[196:199], a[28:31], v[252:255]
  v_permlane16_swap_b32 v82, v86
  v_permlane16_swap_b32 v83, v87
  v_mfma_f32_16x16x32_bf16 v[240:243], a[200:203], a[32:35], v[240:243]
  v_max_f32 v80, v80, v84
  v_max_f32 v81, v81, v85
  v_mfma_f32_16x16x32_bf16 v[240:243], a[204:207], a[48:51], v[240:243]
  v_max_f32 v82, v82, v86
  v_max_f32 v83, v83, v87
  v_mfma_f32_16x16x32_bf16 v[244:247], a[200:203], a[36:39], v[244:247]
  v_mov_b32 v84, v80
  v_mov_b32 v85, v81
  v_mfma_f32_16x16x32_bf16 v[244:247], a[204:207], a[52:55], v[244:247]
  v_mov_b32 v86, v82
  v_mfma_f32_16x16x32_bf16 v[248:251], a[200:203], a[40:43], v[248:251]
  v_mov_b32 v87, v83
  v_permlane32_swap_b32 v80, v84
  v_mfma_f32_16x16x32_bf16 v[248:251], a[204:207], a[56:59], v[248:251]
  v_permlane32_swap_b32 v81, v85
  v_mfma_f32_16x16x32_bf16 v[252:255], a[200:203], a[44:47], v[252:255]
  v_permlane32_swap_b32 v82, v86
  v_permlane32_swap_b32 v83, v87
  v_mfma_f32_16x16x32_bf16 v[252:255], a[204:207], a[60:63], v[252:255]
  v_max_f32 v80, v80, v84
  v_mfma_f32_16x16x32_bf16 v[240:243], a[208:211], a[64:67], v[240:243]
  v_max_f32 v81, v81, v85
  v_max_f32 v82, v82, v86
  v_mfma_f32_16x16x32_bf16 v[240:243], a[212:215], a[80:83], v[240:243]
  v_max_f32 v83, v83, v87
  v_mfma_f32_16x16x32_bf16 v[244:247], a[208:211], a[68:71], v[244:247]
  v_sub_f32 v32, 0xc2cc0000, v80
  v_sub_f32 v36, 0xc2cc0000, v81
  v_mfma_f32_16x16x32_bf16 v[244:247], a[212:215], a[84:87], v[244:247]
  v_sub_f32 v40, 0xc2cc0000, v82
  v_mfma_f32_16x16x32_bf16 v[248:251], a[208:211], a[72:75], v[248:251]
  v_sub_f32 v44, 0xc2cc0000, v83
  v_mov_b32 v33, v32
  v_mfma_f32_16x16x32_bf16 v[248:251], a[212:215], a[88:91], v[248:251]
  v_mov_b32 v37, v36
  v_mfma_f32_16x16x32_bf16 v[252:255], a[208:211], a[76:79], v[252:255]
  v_mov_b32 v41, v40
  v_mov_b32 v45, v44
  v_mfma_f32_16x16x32_bf16 v[252:255], a[212:215], a[92:95], v[252:255]
  v_mov_b64 v[34:35], v[32:33]
  v_mfma_f32_16x16x32_bf16 v[240:243], a[216:219], a[96:99], v[240:243]
  v_mov_b64 v[38:39], v[36:37]
  v_mov_b64 v[42:43], v[40:41]
  v_mfma_f32_16x16x32_bf16 v[240:243], a[220:223], a[112:115], v[240:243]
  v_mov_b64 v[46:47], v[44:45]
  v_mfma_f32_16x16x32_bf16 v[244:247], a[216:219], a[100:103], v[244:247]
  v_add_f32 v64, v64, v32
  v_mfma_f32_16x16x32_bf16 v[244:247], a[220:223], a[116:119], v[244:247]
  v_add_f32 v65, v65, v32
  v_mfma_f32_16x16x32_bf16 v[248:251], a[216:219], a[104:107], v[248:251]
  v_add_f32 v66, v66, v32
  v_mfma_f32_16x16x32_bf16 v[248:251], a[220:223], a[120:123], v[248:251]
  v_exp_f32 v64, v64
  v_mfma_f32_16x16x32_bf16 v[252:255], a[216:219], a[108:111], v[252:255]
  v_add_f32 v67, v67, v32
  v_add_f32 v16, v16, v64
  v_mfma_f32_16x16x32_bf16 v[252:255], a[220:223], a[124:127], v[252:255]
  v_exp_f32 v65, v65
  v_mfma_f32_16x16x32_bf16 v[80:83], v[96:99], a[0:3], v[32:35]
  v_add_f32 v68, v68, v36
  v_add_f32 v16, v16, v65
  v_mfma_f32_16x16x32_bf16 v[80:83], v[100:103], a[16:19], v[80:83]
  v_exp_f32 v66, v66
  v_mfma_f32_16x16x32_bf16 v[84:87], v[96:99], a[4:7], v[36:39]
  s_add_u32 m0, s33, 98304
  v_add_f32 v69, v69, v36
  v_mfma_f32_16x16x32_bf16 v[84:87], v[100:103], a[20:23], v[84:87]
  v_add_f32 v70, v70, v36
  v_exp_f32 v67, v67
  v_add_f32 v16, v16, v66
  v_mfma_f32_16x16x32_bf16 v[88:91], v[96:99], a[8:11], v[40:43]
  buffer_load_dwordx4 v12, s[16:19], s35 offen offset:0 lds
  v_mfma_f32_16x16x32_bf16 v[88:91], v[100:103], a[24:27], v[88:91]
  v_add_f32 v71, v71, v36
  v_exp_f32 v68, v68
  v_add_f32 v16, v16, v67
  v_cvt_pk_bf16_f32 v64, v64, v65
  v_mfma_f32_16x16x32_bf16 v[92:95], v[96:99], a[12:15], v[44:47]
  v_add_f32 v72, v72, v40
  v_add_f32 v73, v73, v40
  v_mfma_f32_16x16x32_bf16 v[92:95], v[100:103], a[28:31], v[92:95]
  v_exp_f32 v69, v69
  v_add_f32 v17, v17, v68
  v_mfma_f32_16x16x32_bf16 v[80:83], v[104:107], a[32:35], v[80:83]
  buffer_load_dwordx4 v13, s[16:19], s35 offen offset:1024 lds
  v_exp_f32 v70, v70
  v_mfma_f32_16x16x32_bf16 v[80:83], v[108:111], a[48:51], v[80:83]
  v_add_f32 v74, v74, v40
  v_add_f32 v17, v17, v69
  v_cvt_pk_bf16_f32 v65, v66, v67
  v_mfma_f32_16x16x32_bf16 v[84:87], v[104:107], a[36:39], v[84:87]
  ds_read_b128 v[96:99], v0 offset:40960
  ds_read_b128 v[100:103], v1 offset:40960
  v_add_f32 v75, v75, v40
  v_exp_f32 v71, v71
  v_add_f32 v17, v17, v70
  v_mfma_f32_16x16x32_bf16 v[84:87], v[108:111], a[52:55], v[84:87]
  buffer_load_dwordx4 v14, s[16:19], s35 offen offset:2048 lds
  v_add_f32 v76, v76, v44
  v_mfma_f32_16x16x32_bf16 v[88:91], v[104:107], a[40:43], v[88:91]
  v_exp_f32 v72, v72
  v_add_f32 v17, v17, v71
  v_mfma_f32_16x16x32_bf16 v[88:91], v[108:111], a[56:59], v[88:91]
  v_add_f32 v77, v77, v44
  v_cvt_pk_bf16_f32 v68, v68, v69
  v_mfma_f32_16x16x32_bf16 v[92:95], v[104:107], a[44:47], v[92:95]
  buffer_load_dwordx4 v15, s[16:19], s35 offen offset:3072 lds
  v_add_f32 v78, v78, v44
  v_exp_f32 v73, v73
  v_add_f32 v18, v18, v72
  v_mfma_f32_16x16x32_bf16 v[92:95], v[108:111], a[60:63], v[92:95]
  v_add_f32 v79, v79, v44
  v_add_f32 v18, v18, v73
  v_mfma_f32_16x16x32_bf16 v[80:83], v[112:115], a[64:67], v[80:83]
  v_exp_f32 v74, v74
  v_cvt_pk_bf16_f32 v69, v70, v71
  v_mfma_f32_16x16x32_bf16 v[80:83], v[116:119], a[80:83], v[80:83]
  s_add_u32 s35, s35, 4096
  v_add_f32 v240, v240, v32
  v_exp_f32 v75, v75
  v_mfma_f32_16x16x32_bf16 v[84:87], v[112:115], a[68:71], v[84:87]
  ds_read_b128 v[104:107], v2 offset:40960
  ds_read_b128 v[108:111], v3 offset:40960
  v_add_f32 v241, v241, v32
  v_add_f32 v18, v18, v74
  v_mfma_f32_16x16x32_bf16 v[84:87], v[116:119], a[84:87], v[84:87]
  v_add_f32 v242, v242, v32
  v_exp_f32 v76, v76
  v_add_f32 v18, v18, v75
  v_mfma_f32_16x16x32_bf16 v[88:91], v[112:115], a[72:75], v[88:91]
  s_add_u32 m0, s33, 102400
  v_add_f32 v243, v243, v32
  v_cvt_pk_bf16_f32 v72, v72, v73
  v_mfma_f32_16x16x32_bf16 v[88:91], v[116:119], a[88:91], v[88:91]
  v_exp_f32 v77, v77
  v_add_f32 v19, v19, v76
  v_mfma_f32_16x16x32_bf16 v[92:95], v[112:115], a[76:79], v[92:95]
  v_add_f32 v244, v244, v36
  v_add_f32 v245, v245, v36
  v_mfma_f32_16x16x32_bf16 v[92:95], v[116:119], a[92:95], v[92:95]
  buffer_load_dwordx4 v12, s[16:19], s35 offen offset:0 lds
  v_exp_f32 v78, v78
  v_add_f32 v19, v19, v77
  v_cvt_pk_bf16_f32 v73, v74, v75
  v_mfma_f32_16x16x32_bf16 v[80:83], v[120:123], a[96:99], v[80:83]
  v_add_f32 v246, v246, v36
  v_add_f32 v19, v19, v78
  v_mfma_f32_16x16x32_bf16 v[80:83], v[124:127], a[112:115], v[80:83]
  v_exp_f32 v79, v79
  v_mfma_f32_16x16x32_bf16 v[84:87], v[120:123], a[100:103], v[84:87]
  ds_read_b128 v[112:115], v0 offset:41216
  ds_read_b128 v[116:119], v1 offset:41216
  buffer_load_dwordx4 v13, s[16:19], s35 offen offset:1024 lds
  v_add_f32 v247, v247, v36
  v_mfma_f32_16x16x32_bf16 v[84:87], v[124:127], a[116:119], v[84:87]
  v_add_f32 v248, v248, v40
  v_exp_f32 v240, v240
  v_add_f32 v19, v19, v79
  v_cvt_pk_bf16_f32 v76, v76, v77
  v_mfma_f32_16x16x32_bf16 v[88:91], v[120:123], a[104:107], v[88:91]
  v_add_f32 v249, v249, v40
  v_exp_f32 v241, v241
  v_mfma_f32_16x16x32_bf16 v[88:91], v[124:127], a[120:123], v[88:91]
  buffer_load_dwordx4 v14, s[16:19], s35 offen offset:2048 lds
  v_add_f32 v16, v16, v240
  v_mfma_f32_16x16x32_bf16 v[92:95], v[120:123], a[108:111], v[92:95]
  v_add_f32 v250, v250, v40
  v_exp_f32 v242, v242
  v_add_f32 v16, v16, v241
  v_mfma_f32_16x16x32_bf16 v[92:95], v[124:127], a[124:127], v[92:95]
  s_waitcnt lgkmcnt(2)
  v_add_f32 v251, v251, v40
  v_cvt_pk_bf16_f32 v77, v78, v79
  v_mfma_f32_16x16x32_bf16 v[48:51], v[96:99], a[0:3], v[32:35]
  buffer_load_dwordx4 v15, s[16:19], s35 offen offset:3072 lds
  v_add_f32 v252, v252, v44
  v_exp_f32 v243, v243
  v_add_f32 v16, v16, v242
  v_mfma_f32_16x16x32_bf16 v[48:51], v[100:103], a[16:19], v[48:51]
  ds_read_b128 v[120:123], v2 offset:41216
  ds_read_b128 v[124:127], v3 offset:41216
  v_mfma_f32_16x16x32_bf16 v[52:55], v[96:99], a[4:7], v[36:39]
  v_add_f32 v253, v253, v44
  v_exp_f32 v244, v244
  v_add_f32 v16, v16, v243
  v_cvt_pk_bf16_f32 v66, v240, v241
  v_mfma_f32_16x16x32_bf16 v[52:55], v[100:103], a[20:23], v[52:55]
  s_add_u32 s35, s35, 28672
  v_add_f32 v254, v254, v44
  v_mfma_f32_16x16x32_bf16 v[56:59], v[96:99], a[8:11], v[40:43]
  v_add_f32 v255, v255, v44
  v_exp_f32 v245, v245
  v_add_f32 v17, v17, v244
  v_mfma_f32_16x16x32_bf16 v[56:59], v[100:103], a[24:27], v[56:59]
  v_exp_f32 v246, v246
  v_mfma_f32_16x16x32_bf16 v[60:63], v[96:99], a[12:15], v[44:47]
  v_add_f32 v17, v17, v245
  v_cvt_pk_bf16_f32 v67, v242, v243
  s_waitcnt vmcnt(19) lgkmcnt(0)
  s_barrier
  v_mfma_f32_16x16x32_bf16 v[60:63], v[100:103], a[28:31], v[60:63]
  v_exp_f32 v247, v247
  v_add_f32 v17, v17, v246
  v_mfma_f32_16x16x32_bf16 v[48:51], v[104:107], a[32:35], v[48:51]
  v_exp_f32 v248, v248
  v_mfma_f32_16x16x32_bf16 v[48:51], v[108:111], a[48:51], v[48:51]
  ds_read_b64_tr_b16 v[96:97], v4 offset:0
  v_add_f32 v17, v17, v247
  v_mfma_f32_16x16x32_bf16 v[52:55], v[104:107], a[36:39], v[52:55]
  ds_read_b64_tr_b16 v[98:99], v4 offset:8192
  ds_read_b64_tr_b16 v[100:101], v5 offset:0
  ds_read_b64_tr_b16 v[102:103], v5 offset:8192
  v_cvt_pk_bf16_f32 v70, v244, v245
  v_mfma_f32_16x16x32_bf16 v[52:55], v[108:111], a[52:55], v[52:55]
  s_add_u32 m0, s33, 32768
  v_exp_f32 v249, v249
  v_add_f32 v18, v18, v248
  v_mfma_f32_16x16x32_bf16 v[56:59], v[104:107], a[40:43], v[56:59]
  v_exp_f32 v250, v250
  v_mfma_f32_16x16x32_bf16 v[56:59], v[108:111], a[56:59], v[56:59]
  v_add_f32 v18, v18, v249
  v_cvt_pk_bf16_f32 v71, v246, v247
  v_mfma_f32_16x16x32_bf16 v[60:63], v[104:107], a[44:47], v[60:63]
  v_exp_f32 v251, v251
  v_mfma_f32_16x16x32_bf16 v[60:63], v[108:111], a[60:63], v[60:63]
  buffer_load_dwordx4 v12, s[12:15], s34 offen offset:0 lds
  v_add_f32 v18, v18, v250
  v_mfma_f32_16x16x32_bf16 v[48:51], v[112:115], a[64:67], v[48:51]
  v_exp_f32 v252, v252
  v_add_f32 v18, v18, v251
  v_mfma_f32_16x16x32_bf16 v[48:51], v[116:119], a[80:83], v[48:51]
  ds_read_b64_tr_b16 v[104:105], v6 offset:0
  v_cvt_pk_bf16_f32 v74, v248, v249
  v_mfma_f32_16x16x32_bf16 v[52:55], v[112:115], a[68:71], v[52:55]
  ds_read_b64_tr_b16 v[106:107], v6 offset:8192
  ds_read_b64_tr_b16 v[108:109], v7 offset:0
  ds_read_b64_tr_b16 v[110:111], v7 offset:8192
  v_exp_f32 v253, v253
  v_add_f32 v19, v19, v252
  v_mfma_f32_16x16x32_bf16 v[52:55], v[116:119], a[84:87], v[52:55]
  buffer_load_dwordx4 v13, s[12:15], s34 offen offset:1024 lds
  v_mfma_f32_16x16x32_bf16 v[56:59], v[112:115], a[72:75], v[56:59]
  v_exp_f32 v254, v254
  v_add_f32 v19, v19, v253
  v_cvt_pk_bf16_f32 v75, v250, v251
  v_mfma_f32_16x16x32_bf16 v[56:59], v[116:119], a[88:91], v[56:59]
  v_exp_f32 v255, v255
  v_mfma_f32_16x16x32_bf16 v[60:63], v[112:115], a[76:79], v[60:63]
  v_add_f32 v19, v19, v254
  v_add_f32 v19, v19, v255
  v_mfma_f32_16x16x32_bf16 v[60:63], v[116:119], a[92:95], v[60:63]
  ds_read_b64_tr_b16 v[112:113], v8 offset:0
  v_cvt_pk_bf16_f32 v78, v252, v253
  v_mfma_f32_16x16x32_bf16 v[48:51], v[120:123], a[96:99], v[48:51]
  buffer_load_dwordx4 v14, s[12:15], s34 offen offset:2048 lds
  v_mfma_f32_16x16x32_bf16 v[48:51], v[124:127], a[112:115], v[48:51]
  ds_read_b64_tr_b16 v[114:115], v8 offset:8192
  ds_read_b64_tr_b16 v[116:117], v9 offset:0
  v_mfma_f32_16x16x32_bf16 v[52:55], v[120:123], a[100:103], v[52:55]
  ds_read_b64_tr_b16 v[118:119], v9 offset:8192
  v_exp_f32 v80, v80
  v_mfma_f32_16x16x32_bf16 v[52:55], v[124:127], a[116:119], v[52:55]
  v_exp_f32 v81, v81
  v_mfma_f32_16x16x32_bf16 v[56:59], v[120:123], a[104:107], v[56:59]
  v_cvt_pk_bf16_f32 v79, v254, v255
  v_add_f32 v16, v16, v80
  v_mfma_f32_16x16x32_bf16 v[56:59], v[124:127], a[120:123], v[56:59]
  buffer_load_dwordx4 v15, s[12:15], s34 offen offset:3072 lds
  v_mfma_f32_16x16x32_bf16 v[60:63], v[120:123], a[108:111], v[60:63]
  v_exp_f32 v82, v82
  v_mfma_f32_16x16x32_bf16 v[60:63], v[124:127], a[124:127], v[60:63]
  s_waitcnt lgkmcnt(4)
  v_add_f32 v16, v16, v81
  v_mfma_f32_16x16x32_bf16 v[128:131], v[96:99], v[64:67], 0
  v_exp_f32 v83, v83
  v_mfma_f32_16x16x32_bf16 v[132:135], v[96:99], v[68:71], 0
  ds_read_b64_tr_b16 v[120:121], v10 offset:0
  v_add_f32 v16, v16, v82
  v_mfma_f32_16x16x32_bf16 a[128:131], v[96:99], v[72:75], 0
  ds_read_b64_tr_b16 v[122:123], v10 offset:8192
  ds_read_b64_tr_b16 v[124:125], v11 offset:0
  ds_read_b64_tr_b16 v[126:127], v11 offset:8192
  v_exp_f32 v84, v84
  v_mfma_f32_16x16x32_bf16 a[132:135], v[96:99], v[76:79], 0
  s_add_u32 s34, s34, 4096
  v_add_f32 v16, v16, v83
  v_mfma_f32_16x16x32_bf16 v[136:139], v[100:103], v[64:67], 0
  v_exp_f32 v85, v85
  v_mfma_f32_16x16x32_bf16 v[140:143], v[100:103], v[68:71], 0
  ds_read_b64_tr_b16 v[96:97], v4 offset:256
  v_add_f32 v17, v17, v84
  v_mfma_f32_16x16x32_bf16 a[136:139], v[100:103], v[72:75], 0
  ds_read_b64_tr_b16 v[98:99], v4 offset:8448
  v_exp_f32 v86, v86
  v_mfma_f32_16x16x32_bf16 a[140:143], v[100:103], v[76:79], 0
  v_add_f32 v17, v17, v85
  s_add_u32 m0, s33, 36864
  v_mfma_f32_16x16x32_bf16 v[144:147], v[104:107], v[64:67], 0
  v_exp_f32 v87, v87
  v_mfma_f32_16x16x32_bf16 v[148:151], v[104:107], v[68:71], 0
  ds_read_b64_tr_b16 v[100:101], v5 offset:256
  v_add_f32 v17, v17, v86
  v_mfma_f32_16x16x32_bf16 a[144:147], v[104:107], v[72:75], 0
  ds_read_b64_tr_b16 v[102:103], v5 offset:8448
  v_exp_f32 v88, v88
  v_mfma_f32_16x16x32_bf16 a[148:151], v[104:107], v[76:79], 0
  v_add_f32 v17, v17, v87
  v_cvt_pk_bf16_f32 v80, v80, v81
  v_mfma_f32_16x16x32_bf16 v[152:155], v[108:111], v[64:67], 0
  v_exp_f32 v89, v89
  v_mfma_f32_16x16x32_bf16 v[156:159], v[108:111], v[68:71], 0
  buffer_load_dwordx4 v12, s[12:15], s34 offen offset:0 lds
  v_add_f32 v18, v18, v88
  v_mfma_f32_16x16x32_bf16 a[152:155], v[108:111], v[72:75], 0
  ds_read_b64_tr_b16 v[104:105], v6 offset:256
  ds_read_b64_tr_b16 v[106:107], v6 offset:8448
  v_exp_f32 v90, v90
  v_mfma_f32_16x16x32_bf16 a[156:159], v[108:111], v[76:79], 0
  s_waitcnt lgkmcnt(6)
  v_add_f32 v18, v18, v89
  v_cvt_pk_bf16_f32 v81, v82, v83
  v_mfma_f32_16x16x32_bf16 v[160:163], v[112:115], v[64:67], 0
  v_exp_f32 v91, v91
  v_mfma_f32_16x16x32_bf16 v[164:167], v[112:115], v[68:71], 0
  ds_read_b64_tr_b16 v[108:109], v7 offset:256
  v_add_f32 v18, v18, v90
  v_mfma_f32_16x16x32_bf16 a[160:163], v[112:115], v[72:75], 0
  ds_read_b64_tr_b16 v[110:111], v7 offset:8448
  buffer_load_dwordx4 v13, s[12:15], s34 offen offset:1024 lds
  v_exp_f32 v92, v92
  v_mfma_f32_16x16x32_bf16 a[164:167], v[112:115], v[76:79], 0
  v_add_f32 v18, v18, v91
  v_cvt_pk_bf16_f32 v84, v84, v85
  v_mfma_f32_16x16x32_bf16 v[168:171], v[116:119], v[64:67], 0
  v_exp_f32 v93, v93
  v_mfma_f32_16x16x32_bf16 v[172:175], v[116:119], v[68:71], 0
  ds_read_b64_tr_b16 v[112:113], v8 offset:256
  v_add_f32 v19, v19, v92
  v_mfma_f32_16x16x32_bf16 a[168:171], v[116:119], v[72:75], 0
  ds_read_b64_tr_b16 v[114:115], v8 offset:8448
  v_exp_f32 v94, v94
  v_mfma_f32_16x16x32_bf16 a[172:175], v[116:119], v[76:79], 0
  buffer_load_dwordx4 v14, s[12:15], s34 offen offset:2048 lds
  v_add_f32 v19, v19, v93
  v_cvt_pk_bf16_f32 v85, v86, v87
  v_mfma_f32_16x16x32_bf16 v[176:179], v[120:123], v[64:67], 0
  v_exp_f32 v95, v95
  v_mfma_f32_16x16x32_bf16 v[180:183], v[120:123], v[68:71], 0
  ds_read_b64_tr_b16 v[116:117], v9 offset:256
  v_add_f32 v19, v19, v94
  v_mfma_f32_16x16x32_bf16 a[176:179], v[120:123], v[72:75], 0
  ds_read_b64_tr_b16 v[118:119], v9 offset:8448
  v_exp_f32 v48, v48
  v_mfma_f32_16x16x32_bf16 a[180:183], v[120:123], v[76:79], 0
  v_add_f32 v19, v19, v95
  v_cvt_pk_bf16_f32 v88, v88, v89
  v_mfma_f32_16x16x32_bf16 v[184:187], v[124:127], v[64:67], 0
  buffer_load_dwordx4 v15, s[12:15], s34 offen offset:3072 lds
  v_exp_f32 v49, v49
  v_mfma_f32_16x16x32_bf16 v[188:191], v[124:127], v[68:71], 0
  ds_read_b64_tr_b16 v[120:121], v10 offset:256
  v_add_f32 v16, v16, v48
  v_mfma_f32_16x16x32_bf16 a[184:187], v[124:127], v[72:75], 0
  ds_read_b64_tr_b16 v[122:123], v10 offset:8448
  v_exp_f32 v50, v50
  v_mfma_f32_16x16x32_bf16 a[188:191], v[124:127], v[76:79], 0
  s_waitcnt lgkmcnt(6)
  v_add_f32 v16, v16, v49
  v_cvt_pk_bf16_f32 v89, v90, v91
  v_mfma_f32_16x16x32_bf16 v[192:195], v[96:99], v[64:67], 0
  v_exp_f32 v51, v51
  v_mfma_f32_16x16x32_bf16 v[196:199], v[96:99], v[68:71], 0
  s_add_u32 s34, s34, 28672
  v_add_f32 v16, v16, v50
  v_mfma_f32_16x16x32_bf16 a[192:195], v[96:99], v[72:75], 0
  ds_read_b64_tr_b16 v[124:125], v11 offset:256
  ds_read_b64_tr_b16 v[126:127], v11 offset:8448
  v_exp_f32 v52, v52
  v_mfma_f32_16x16x32_bf16 a[196:199], v[96:99], v[76:79], 0
  v_add_f32 v16, v16, v51
  v_cvt_pk_bf16_f32 v92, v92, v93
  v_mfma_f32_16x16x32_bf16 v[200:203], v[100:103], v[64:67], 0
  v_exp_f32 v53, v53
  v_mfma_f32_16x16x32_bf16 v[204:207], v[100:103], v[68:71], 0
  v_add_f32 v17, v17, v52
  v_add_f32 v17, v17, v53
  v_mfma_f32_16x16x32_bf16 a[200:203], v[100:103], v[72:75], 0
  v_exp_f32 v54, v54
  s_waitcnt vmcnt(16) lgkmcnt(0)
  s_barrier
  v_mfma_f32_16x16x32_bf16 a[204:207], v[100:103], v[76:79], 0
  v_cvt_pk_bf16_f32 v93, v94, v95
  v_xor_b32 v236, v236, v26
  v_mfma_f32_16x16x32_bf16 v[208:211], v[104:107], v[64:67], 0
  v_xor_b32 v237, v237, v27
  v_exp_f32 v55, v55
  v_mfma_f32_16x16x32_bf16 v[212:215], v[104:107], v[68:71], 0
  v_xor_b32 v238, v238, v28
  v_add_f32 v17, v17, v54
  v_mfma_f32_16x16x32_bf16 a[208:211], v[104:107], v[72:75], 0
  ds_read_b128 v[96:99], v0 offset:0
  ds_read_b128 v[100:103], v1 offset:0
  v_xor_b32 v239, v239, v29
  v_exp_f32 v56, v56
  v_mfma_f32_16x16x32_bf16 a[212:215], v[104:107], v[76:79], 0
  v_min3_u32 v236, v236, v237, v238
  v_add_f32 v17, v17, v55
  v_cvt_pk_bf16_f32 v82, v48, v49
  v_mfma_f32_16x16x32_bf16 v[216:219], v[108:111], v[64:67], 0
  v_min_u32 v236, v236, v239
  v_cmp_eq_u32 vcc, 0, v236
  v_exp_f32 v57, v57
  v_mfma_f32_16x16x32_bf16 v[220:223], v[108:111], v[68:71], 0
  s_nop 0
  s_or_b32 s56, vcc_lo, vcc_hi
  v_add_f32 v18, v18, v56
  v_mfma_f32_16x16x32_bf16 a[216:219], v[108:111], v[72:75], 0
  ds_read_b128 v[104:107], v2 offset:0
  s_and_b32 s56, s56, s91
  v_exp_f32 v58, v58
  v_mfma_f32_16x16x32_bf16 a[220:223], v[108:111], v[76:79], 0
  s_or_b32 s90, s90, s56
  v_add_f32 v18, v18, v57
  v_cvt_pk_bf16_f32 v83, v50, v51
  v_mfma_f32_16x16x32_bf16 v[224:227], v[112:115], v[64:67], 0
  v_exp_f32 v59, v59
  v_mfma_f32_16x16x32_bf16 v[228:231], v[112:115], v[68:71], 0
  ds_read_b128 v[108:111], v3 offset:0
  v_add_f32 v18, v18, v58
  v_mfma_f32_16x16x32_bf16 a[224:227], v[112:115], v[72:75], 0
  v_exp_f32 v60, v60
  v_mfma_f32_16x16x32_bf16 a[228:231], v[112:115], v[76:79], 0
  v_add_f32 v18, v18, v59
  v_cvt_pk_bf16_f32 v86, v52, v53
  v_mfma_f32_16x16x32_bf16 v[232:235], v[116:119], v[64:67], 0
  v_exp_f32 v61, v61
  v_mfma_f32_16x16x32_bf16 v[236:239], v[116:119], v[68:71], 0
  ds_read_b128 v[112:115], v0 offset:256
  v_add_f32 v19, v19, v60
  v_mfma_f32_16x16x32_bf16 a[232:235], v[116:119], v[72:75], 0
  v_exp_f32 v62, v62
  v_mfma_f32_16x16x32_bf16 a[236:239], v[116:119], v[76:79], 0
  v_add_f32 v19, v19, v61
  v_cvt_pk_bf16_f32 v87, v54, v55
  v_mfma_f32_16x16x32_bf16 v[240:243], v[120:123], v[64:67], 0
  v_exp_f32 v63, v63
  v_mfma_f32_16x16x32_bf16 v[244:247], v[120:123], v[68:71], 0
  ds_read_b128 v[116:119], v1 offset:256
  v_add_f32 v19, v19, v62
  v_mfma_f32_16x16x32_bf16 a[240:243], v[120:123], v[72:75], 0
  v_add_f32 v19, v19, v63
  v_cvt_pk_bf16_f32 v90, v56, v57
  v_mfma_f32_16x16x32_bf16 a[244:247], v[120:123], v[76:79], 0
  ds_read_b128 v[120:123], v2 offset:256
  v_cvt_pk_bf16_f32 v91, v58, v59
  v_mfma_f32_16x16x32_bf16 v[248:251], v[124:127], v[64:67], 0
  v_cvt_pk_bf16_f32 v94, v60, v61
  v_cvt_pk_bf16_f32 v95, v62, v63
  v_mfma_f32_16x16x32_bf16 v[252:255], v[124:127], v[68:71], 0
  s_waitcnt lgkmcnt(3)
  v_mfma_f32_16x16x32_bf16 a[248:251], v[124:127], v[72:75], 0
  v_mfma_f32_16x16x32_bf16 a[252:255], v[124:127], v[76:79], 0
  ds_read_b128 v[124:127], v3 offset:256
.p2align 6
L_k2_loop:
  v_mfma_f32_16x16x32_bf16 v[64:67], v[96:99], a[0:3], v[32:35]
  s_add_u32 m0, s33, 65536
  v_mfma_f32_16x16x32_bf16 v[64:67], v[100:103], a[16:19], v[64:67]
  v_mfma_f32_16x16x32_bf16 v[68:71], v[96:99], a[4:7], v[36:39]
  v_mfma_f32_16x16x32_bf16 v[68:71], v[100:103], a[20:23], v[68:71]
  buffer_load_dwordx4 v12, s[16:19], s35 offen offset:0 lds
  v_mfma_f32_16x16x32_bf16 v[72:75], v[96:99], a[8:11], v[40:43]
  v_mfma_f32_16x16x32_bf16 v[72:75], v[100:103], a[24:27], v[72:75]
  v_mfma_f32_16x16x32_bf16 v[76:79], v[96:99], a[12:15], v[44:47]
  buffer_load_dwordx4 v13, s[16:19], s35 offen offset:1024 lds
  v_mfma_f32_16x16x32_bf16 v[76:79], v[100:103], a[28:31], v[76:79]
  ds_read_b128 v[96:99], v0 offset:8192
  ds_read_b128 v[100:103], v1 offset:8192
  v_mfma_f32_16x16x32_bf16 v[64:67], v[104:107], a[32:35], v[64:67]
  v_mfma_f32_16x16x32_bf16 v[64:67], v[108:111], a[48:51], v[64:67]
  buffer_load_dwordx4 v14, s[16:19], s35 offen offset:2048 lds
  v_mfma_f32_16x16x32_bf16 v[68:71], v[104:107], a[36:39], v[68:71]
  v_mfma_f32_16x16x32_bf16 v[68:71], v[108:111], a[52:55], v[68:71]
  v_mfma_f32_16x16x32_bf16 v[72:75], v[104:107], a[40:43], v[72:75]
  buffer_load_dwordx4 v15, s[16:19], s35 offen offset:3072 lds
  v_mfma_f32_16x16x32_bf16 v[72:75], v[108:111], a[56:59], v[72:75]
  s_waitcnt lgkmcnt(2)
  v_mfma_f32_16x16x32_bf16 v[76:79], v[104:107], a[44:47], v[76:79]
  v_mfma_f32_16x16x32_bf16 v[76:79], v[108:111], a[60:63], v[76:79]
  s_add_u32 s35, s35, 4096
  ds_read_b128 v[104:107], v2 offset:8192
  v_mfma_f32_16x16x32_bf16 v[64:67], v[112:115], a[64:67], v[64:67]
  ds_read_b128 v[108:111], v3 offset:8192
  v_mfma_f32_16x16x32_bf16 v[64:67], v[116:119], a[80:83], v[64:67]
  v_mfma_f32_16x16x32_bf16 v[68:71], v[112:115], a[68:71], v[68:71]
  s_add_u32 m0, s33, 69632
  v_mfma_f32_16x16x32_bf16 v[68:71], v[116:119], a[84:87], v[68:71]
  v_mfma_f32_16x16x32_bf16 v[72:75], v[112:115], a[72:75], v[72:75]
  v_mfma_f32_16x16x32_bf16 v[72:75], v[116:119], a[88:91], v[72:75]
  buffer_load_dwordx4 v12, s[16:19], s35 offen offset:0 lds
  v_mfma_f32_16x16x32_bf16 v[76:79], v[112:115], a[76:79], v[76:79]
  v_mfma_f32_16x16x32_bf16 v[76:79], v[116:119], a[92:95], v[76:79]
  ds_read_b128 v[112:115], v0 offset:8448
  ds_read_b128 v[116:119], v1 offset:8448
  v_mfma_f32_16x16x32_bf16 v[64:67], v[120:123], a[96:99], v[64:67]
  buffer_load_dwordx4 v13, s[16:19], s35 offen offset:1024 lds
  v_mfma_f32_16x16x32_bf16 v[64:67], v[124:127], a[112:115], v[64:67]
  v_mfma_f32_16x16x32_bf16 v[68:71], v[120:123], a[100:103], v[68:71]
  v_mfma_f32_16x16x32_bf16 v[68:71], v[124:127], a[116:119], v[68:71]
  buffer_load_dwordx4 v14, s[16:19], s35 offen offset:2048 lds
  v_mfma_f32_16x16x32_bf16 v[72:75], v[120:123], a[104:107], v[72:75]
  v_mfma_f32_16x16x32_bf16 v[72:75], v[124:127], a[120:123], v[72:75]
  s_waitcnt lgkmcnt(2)
  v_mfma_f32_16x16x32_bf16 v[76:79], v[120:123], a[108:111], v[76:79]
  buffer_load_dwordx4 v15, s[16:19], s35 offen offset:3072 lds
  v_mfma_f32_16x16x32_bf16 v[76:79], v[124:127], a[124:127], v[76:79]
  v_exp_f32 v64, v64
  v_mfma_f32_16x16x32_bf16 v[48:51], v[96:99], a[0:3], v[32:35]
  ds_read_b128 v[120:123], v2 offset:8448
  ds_read_b128 v[124:127], v3 offset:8448
  v_mfma_f32_16x16x32_bf16 v[48:51], v[100:103], a[16:19], v[48:51]
  v_exp_f32 v65, v65
  v_mfma_f32_16x16x32_bf16 v[52:55], v[96:99], a[4:7], v[36:39]
  s_add_u32 s35, s35, 28672
  v_add_f32 v16, v16, v64
  v_mfma_f32_16x16x32_bf16 v[52:55], v[100:103], a[20:23], v[52:55]
  v_exp_f32 v66, v66
  v_mfma_f32_16x16x32_bf16 v[56:59], v[96:99], a[8:11], v[40:43]
  v_add_f32 v16, v16, v65
  v_add_f32 v16, v16, v66
  v_mfma_f32_16x16x32_bf16 v[56:59], v[100:103], a[24:27], v[56:59]
  v_exp_f32 v67, v67
  v_mfma_f32_16x16x32_bf16 v[60:63], v[96:99], a[12:15], v[44:47]
  s_waitcnt vmcnt(16) lgkmcnt(0)
  s_barrier
  v_mfma_f32_16x16x32_bf16 v[60:63], v[100:103], a[28:31], v[60:63]
  v_exp_f32 v68, v68
  v_mfma_f32_16x16x32_bf16 v[48:51], v[104:107], a[32:35], v[48:51]
  ds_read_b64_tr_b16 v[96:97], v4 offset:32768
  v_add_f32 v16, v16, v67
  v_mfma_f32_16x16x32_bf16 v[48:51], v[108:111], a[48:51], v[48:51]
  ds_read_b64_tr_b16 v[98:99], v4 offset:40960
  ds_read_b64_tr_b16 v[100:101], v5 offset:32768
  v_mfma_f32_16x16x32_bf16 v[52:55], v[104:107], a[36:39], v[52:55]
  ds_read_b64_tr_b16 v[102:103], v5 offset:40960
  v_exp_f32 v69, v69
  v_mfma_f32_16x16x32_bf16 v[52:55], v[108:111], a[52:55], v[52:55]
  s_add_u32 m0, s33, 0
  v_add_f32 v17, v17, v68
  v_mfma_f32_16x16x32_bf16 v[56:59], v[104:107], a[40:43], v[56:59]
  v_exp_f32 v70, v70
  v_mfma_f32_16x16x32_bf16 v[56:59], v[108:111], a[56:59], v[56:59]
  v_add_f32 v17, v17, v69
  v_add_f32 v17, v17, v70
  v_mfma_f32_16x16x32_bf16 v[60:63], v[104:107], a[44:47], v[60:63]
  v_exp_f32 v71, v71
  v_mfma_f32_16x16x32_bf16 v[60:63], v[108:111], a[60:63], v[60:63]
  buffer_load_dwordx4 v12, s[12:15], s34 offen offset:0 lds
  v_mfma_f32_16x16x32_bf16 v[48:51], v[112:115], a[64:67], v[48:51]
  v_exp_f32 v72, v72
  v_mfma_f32_16x16x32_bf16 v[48:51], v[116:119], a[80:83], v[48:51]
  v_add_f32 v17, v17, v71
  v_cvt_pk_bf16_f32 v64, v64, v65
  v_mfma_f32_16x16x32_bf16 v[52:55], v[112:115], a[68:71], v[52:55]
  ds_read_b64_tr_b16 v[104:105], v6 offset:32768
  ds_read_b64_tr_b16 v[106:107], v6 offset:40960
  ds_read_b64_tr_b16 v[108:109], v7 offset:32768
  ds_read_b64_tr_b16 v[110:111], v7 offset:40960
  v_exp_f32 v73, v73
  v_mfma_f32_16x16x32_bf16 v[52:55], v[116:119], a[84:87], v[52:55]
  v_add_f32 v18, v18, v72
  v_add_f32 v18, v18, v73
  v_mfma_f32_16x16x32_bf16 v[56:59], v[112:115], a[72:75], v[56:59]
  buffer_load_dwordx4 v13, s[12:15], s34 offen offset:1024 lds
  v_exp_f32 v74, v74
  v_mfma_f32_16x16x32_bf16 v[56:59], v[116:119], a[88:91], v[56:59]
  v_cvt_pk_bf16_f32 v65, v66, v67
  v_add_f32 v18, v18, v74
  v_mfma_f32_16x16x32_bf16 v[60:63], v[112:115], a[76:79], v[60:63]
  v_exp_f32 v75, v75
  v_mfma_f32_16x16x32_bf16 v[60:63], v[116:119], a[92:95], v[60:63]
  v_exp_f32 v76, v76
  v_mfma_f32_16x16x32_bf16 v[48:51], v[120:123], a[96:99], v[48:51]
  buffer_load_dwordx4 v14, s[12:15], s34 offen offset:2048 lds
  v_mfma_f32_16x16x32_bf16 v[48:51], v[124:127], a[112:115], v[48:51]
  v_add_f32 v18, v18, v75
  v_cvt_pk_bf16_f32 v68, v68, v69
  v_mfma_f32_16x16x32_bf16 v[52:55], v[120:123], a[100:103], v[52:55]
  ds_read_b64_tr_b16 v[112:113], v8 offset:32768
  ds_read_b64_tr_b16 v[114:115], v8 offset:40960
  ds_read_b64_tr_b16 v[116:117], v9 offset:32768
  ds_read_b64_tr_b16 v[118:119], v9 offset:40960
  v_exp_f32 v77, v77
  v_mfma_f32_16x16x32_bf16 v[52:55], v[124:127], a[116:119], v[52:55]
  v_add_f32 v19, v19, v76
  v_add_f32 v19, v19, v77
  v_mfma_f32_16x16x32_bf16 v[56:59], v[120:123], a[104:107], v[56:59]
  v_exp_f32 v78, v78
  v_mfma_f32_16x16x32_bf16 v[56:59], v[124:127], a[120:123], v[56:59]
  v_cvt_pk_bf16_f32 v69, v70, v71
  s_waitcnt lgkmcnt(4)
  v_mfma_f32_16x16x32_bf16 v[60:63], v[120:123], a[108:111], v[60:63]
  buffer_load_dwordx4 v15, s[12:15], s34 offen offset:3072 lds
  v_exp_f32 v79, v79
  v_mfma_f32_16x16x32_bf16 v[60:63], v[124:127], a[124:127], v[60:63]
  v_add_f32 v19, v19, v78
  v_add_f32 v19, v19, v79
  v_mfma_f32_16x16x32_bf16 v[128:131], v[96:99], v[80:83], v[128:131]
  v_exp_f32 v48, v48
  v_mfma_f32_16x16x32_bf16 v[132:135], v[96:99], v[84:87], v[132:135]
  ds_read_b64_tr_b16 v[120:121], v10 offset:32768
  v_cvt_pk_bf16_f32 v72, v72, v73
  v_mfma_f32_16x16x32_bf16 a[128:131], v[96:99], v[88:91], a[128:131]
  ds_read_b64_tr_b16 v[122:123], v10 offset:40960
  ds_read_b64_tr_b16 v[124:125], v11 offset:32768
  ds_read_b64_tr_b16 v[126:127], v11 offset:40960
  v_mfma_f32_16x16x32_bf16 a[132:135], v[96:99], v[92:95], a[132:135]
  s_add_u32 s34, s34, 4096
  v_add_f32 v16, v16, v48
  v_mfma_f32_16x16x32_bf16 v[136:139], v[100:103], v[80:83], v[136:139]
  v_exp_f32 v49, v49
  v_mfma_f32_16x16x32_bf16 v[140:143], v[100:103], v[84:87], v[140:143]
  ds_read_b64_tr_b16 v[96:97], v4 offset:33024
  v_cvt_pk_bf16_f32 v73, v74, v75
  v_mfma_f32_16x16x32_bf16 a[136:139], v[100:103], v[88:91], a[136:139]
  ds_read_b64_tr_b16 v[98:99], v4 offset:41216
  v_add_f32 v16, v16, v49
  v_mfma_f32_16x16x32_bf16 a[140:143], v[100:103], v[92:95], a[140:143]
  v_exp_f32 v50, v50
  v_mfma_f32_16x16x32_bf16 v[144:147], v[104:107], v[80:83], v[144:147]
  s_add_u32 m0, s33, 4096
  v_cvt_pk_bf16_f32 v76, v76, v77
  v_mfma_f32_16x16x32_bf16 v[148:151], v[104:107], v[84:87], v[148:151]
  ds_read_b64_tr_b16 v[100:101], v5 offset:33024
  ds_read_b64_tr_b16 v[102:103], v5 offset:41216
  v_mfma_f32_16x16x32_bf16 a[144:147], v[104:107], v[88:91], a[144:147]
  v_exp_f32 v51, v51
  v_add_f32 v16, v16, v50
  v_mfma_f32_16x16x32_bf16 a[148:151], v[104:107], v[92:95], a[148:151]
  buffer_load_dwordx4 v12, s[12:15], s34 offen offset:0 lds
  v_mfma_f32_16x16x32_bf16 v[152:155], v[108:111], v[80:83], v[152:155]
  v_exp_f32 v52, v52
  v_mfma_f32_16x16x32_bf16 v[156:159], v[108:111], v[84:87], v[156:159]
  v_add_f32 v16, v16, v51
  v_cvt_pk_bf16_f32 v77, v78, v79
  v_mfma_f32_16x16x32_bf16 a[152:155], v[108:111], v[88:91], a[152:155]
  ds_read_b64_tr_b16 v[104:105], v6 offset:33024
  ds_read_b64_tr_b16 v[106:107], v6 offset:41216
  v_mfma_f32_16x16x32_bf16 a[156:159], v[108:111], v[92:95], a[156:159]
  s_waitcnt lgkmcnt(6)
  v_add_f32 v17, v17, v52
  v_mfma_f32_16x16x32_bf16 v[160:163], v[112:115], v[80:83], v[160:163]
  v_exp_f32 v53, v53
  v_mfma_f32_16x16x32_bf16 v[164:167], v[112:115], v[84:87], v[164:167]
  ds_read_b64_tr_b16 v[108:109], v7 offset:33024
  ds_read_b64_tr_b16 v[110:111], v7 offset:41216
  v_mfma_f32_16x16x32_bf16 a[160:163], v[112:115], v[88:91], a[160:163]
  buffer_load_dwordx4 v13, s[12:15], s34 offen offset:1024 lds
  v_mfma_f32_16x16x32_bf16 a[164:167], v[112:115], v[92:95], a[164:167]
  v_exp_f32 v54, v54
  v_add_f32 v17, v17, v53
  v_cvt_pk_bf16_f32 v66, v48, v49
  v_mfma_f32_16x16x32_bf16 v[168:171], v[116:119], v[80:83], v[168:171]
  ds_read_b64_tr_b16 v[112:113], v8 offset:33024
  ds_read_b64_tr_b16 v[114:115], v8 offset:41216
  v_mfma_f32_16x16x32_bf16 v[172:175], v[116:119], v[84:87], v[172:175]
  v_exp_f32 v55, v55
  v_mfma_f32_16x16x32_bf16 a[168:171], v[116:119], v[88:91], a[168:171]
  v_add_f32 v17, v17, v54
  v_add_f32 v17, v17, v55
  v_mfma_f32_16x16x32_bf16 a[172:175], v[116:119], v[92:95], a[172:175]
  buffer_load_dwordx4 v14, s[12:15], s34 offen offset:2048 lds
  v_mfma_f32_16x16x32_bf16 v[176:179], v[120:123], v[80:83], v[176:179]
  v_exp_f32 v56, v56
  v_mfma_f32_16x16x32_bf16 v[180:183], v[120:123], v[84:87], v[180:183]
  ds_read_b64_tr_b16 v[116:117], v9 offset:33024
  v_cvt_pk_bf16_f32 v67, v50, v51
  v_mfma_f32_16x16x32_bf16 a[176:179], v[120:123], v[88:91], a[176:179]
  ds_read_b64_tr_b16 v[118:119], v9 offset:41216
  v_add_f32 v18, v18, v56
  v_mfma_f32_16x16x32_bf16 a[180:183], v[120:123], v[92:95], a[180:183]
  buffer_load_dwordx4 v15, s[12:15], s34 offen offset:3072 lds
  v_mfma_f32_16x16x32_bf16 v[184:187], v[124:127], v[80:83], v[184:187]
  v_exp_f32 v57, v57
  v_mfma_f32_16x16x32_bf16 v[188:191], v[124:127], v[84:87], v[188:191]
  ds_read_b64_tr_b16 v[120:121], v10 offset:33024
  ds_read_b64_tr_b16 v[122:123], v10 offset:41216
  v_mfma_f32_16x16x32_bf16 a[184:187], v[124:127], v[88:91], a[184:187]
  s_waitcnt lgkmcnt(6)
  v_add_f32 v18, v18, v57
  v_mfma_f32_16x16x32_bf16 a[188:191], v[124:127], v[92:95], a[188:191]
  v_exp_f32 v58, v58
  v_cvt_pk_bf16_f32 v70, v52, v53
  v_mfma_f32_16x16x32_bf16 v[192:195], v[96:99], v[80:83], v[192:195]
  s_add_u32 s34, s34, 28672
  ds_read_b64_tr_b16 v[124:125], v11 offset:33024
  v_mfma_f32_16x16x32_bf16 v[196:199], v[96:99], v[84:87], v[196:199]
  ds_read_b64_tr_b16 v[126:127], v11 offset:41216
  v_add_f32 v18, v18, v58
  v_mfma_f32_16x16x32_bf16 a[192:195], v[96:99], v[88:91], a[192:195]
  v_exp_f32 v59, v59
  v_mfma_f32_16x16x32_bf16 a[196:199], v[96:99], v[92:95], a[196:199]
  v_exp_f32 v60, v60
  v_mfma_f32_16x16x32_bf16 v[200:203], v[100:103], v[80:83], v[200:203]
  v_add_f32 v18, v18, v59
  v_cvt_pk_bf16_f32 v71, v54, v55
  v_mfma_f32_16x16x32_bf16 v[204:207], v[100:103], v[84:87], v[204:207]
  v_add_f32 v19, v19, v60
  v_cvt_pk_bf16_f32 v74, v56, v57
  v_mfma_f32_16x16x32_bf16 a[200:203], v[100:103], v[88:91], a[200:203]
  s_waitcnt vmcnt(16) lgkmcnt(0)
  s_barrier
  v_mfma_f32_16x16x32_bf16 a[204:207], v[100:103], v[92:95], a[204:207]
  v_exp_f32 v61, v61
  v_mfma_f32_16x16x32_bf16 v[208:211], v[104:107], v[80:83], v[208:211]
  ds_read_b128 v[96:99], v0 offset:32768
  ds_read_b128 v[100:103], v1 offset:32768
  v_mfma_f32_16x16x32_bf16 v[212:215], v[104:107], v[84:87], v[212:215]
  v_exp_f32 v62, v62
  v_mfma_f32_16x16x32_bf16 a[208:211], v[104:107], v[88:91], a[208:211]
  v_add_f32 v19, v19, v61
  v_add_f32 v19, v19, v62
  v_mfma_f32_16x16x32_bf16 a[212:215], v[104:107], v[92:95], a[212:215]
  ds_read_b128 v[104:107], v2 offset:32768
  v_cvt_pk_bf16_f32 v75, v58, v59
  v_mfma_f32_16x16x32_bf16 v[216:219], v[108:111], v[80:83], v[216:219]
  v_exp_f32 v63, v63
  v_mfma_f32_16x16x32_bf16 v[220:223], v[108:111], v[84:87], v[220:223]
  v_add_f32 v19, v19, v63
  v_cvt_pk_bf16_f32 v78, v60, v61
  v_mfma_f32_16x16x32_bf16 a[216:219], v[108:111], v[88:91], a[216:219]
  v_cvt_pk_bf16_f32 v79, v62, v63
  v_mfma_f32_16x16x32_bf16 a[220:223], v[108:111], v[92:95], a[220:223]
  ds_read_b128 v[108:111], v3 offset:32768
  v_mfma_f32_16x16x32_bf16 v[224:227], v[112:115], v[80:83], v[224:227]
  v_mfma_f32_16x16x32_bf16 v[228:231], v[112:115], v[84:87], v[228:231]
  v_mfma_f32_16x16x32_bf16 a[224:227], v[112:115], v[88:91], a[224:227]
  v_mfma_f32_16x16x32_bf16 a[228:231], v[112:115], v[92:95], a[228:231]
  ds_read_b128 v[112:115], v0 offset:33024
  v_mfma_f32_16x16x32_bf16 v[232:235], v[116:119], v[80:83], v[232:235]
  v_mfma_f32_16x16x32_bf16 v[236:239], v[116:119], v[84:87], v[236:239]
  v_mfma_f32_16x16x32_bf16 a[232:235], v[116:119], v[88:91], a[232:235]
  v_mfma_f32_16x16x32_bf16 a[236:239], v[116:119], v[92:95], a[236:239]
  ds_read_b128 v[116:119], v1 offset:33024
  v_mfma_f32_16x16x32_bf16 v[240:243], v[120:123], v[80:83], v[240:243]
  v_mfma_f32_16x16x32_bf16 v[244:247], v[120:123], v[84:87], v[244:247]
  v_mfma_f32_16x16x32_bf16 a[240:243], v[120:123], v[88:91], a[240:243]
  v_mfma_f32_16x16x32_bf16 a[244:247], v[120:123], v[92:95], a[244:247]
  ds_read_b128 v[120:123], v2 offset:33024
  v_mfma_f32_16x16x32_bf16 v[248:251], v[124:127], v[80:83], v[248:251]
  v_mfma_f32_16x16x32_bf16 v[252:255], v[124:127], v[84:87], v[252:255]
  s_waitcnt lgkmcnt(3)
  v_mfma_f32_16x16x32_bf16 a[248:251], v[124:127], v[88:91], a[248:251]
  v_mfma_f32_16x16x32_bf16 a[252:255], v[124:127], v[92:95], a[252:255]
  ds_read_b128 v[124:127], v3 offset:33024
  v_mfma_f32_16x16x32_bf16 v[80:83], v[96:99], a[0:3], v[32:35]
  s_add_u32 m0, s33, 98304
  v_mfma_f32_16x16x32_bf16 v[80:83], v[100:103], a[16:19], v[80:83]
  v_mfma_f32_16x16x32_bf16 v[84:87], v[96:99], a[4:7], v[36:39]
  v_mfma_f32_16x16x32_bf16 v[84:87], v[100:103], a[20:23], v[84:87]
  buffer_load_dwordx4 v12, s[16:19], s35 offen offset:0 lds
  v_mfma_f32_16x16x32_bf16 v[88:91], v[96:99], a[8:11], v[40:43]
  v_mfma_f32_16x16x32_bf16 v[88:91], v[100:103], a[24:27], v[88:91]
  v_mfma_f32_16x16x32_bf16 v[92:95], v[96:99], a[12:15], v[44:47]
  buffer_load_dwordx4 v13, s[16:19], s35 offen offset:1024 lds
  v_mfma_f32_16x16x32_bf16 v[92:95], v[100:103], a[28:31], v[92:95]
  ds_read_b128 v[96:99], v0 offset:40960
  ds_read_b128 v[100:103], v1 offset:40960
  v_mfma_f32_16x16x32_bf16 v[80:83], v[104:107], a[32:35], v[80:83]
  v_mfma_f32_16x16x32_bf16 v[80:83], v[108:111], a[48:51], v[80:83]
  buffer_load_dwordx4 v14, s[16:19], s35 offen offset:2048 lds
  v_mfma_f32_16x16x32_bf16 v[84:87], v[104:107], a[36:39], v[84:87]
  v_mfma_f32_16x16x32_bf16 v[84:87], v[108:111], a[52:55], v[84:87]
  v_mfma_f32_16x16x32_bf16 v[88:91], v[104:107], a[40:43], v[88:91]
  buffer_load_dwordx4 v15, s[16:19], s35 offen offset:3072 lds
  v_mfma_f32_16x16x32_bf16 v[88:91], v[108:111], a[56:59], v[88:91]
  s_waitcnt lgkmcnt(2)
  v_mfma_f32_16x16x32_bf16 v[92:95], v[104:107], a[44:47], v[92:95]
  v_mfma_f32_16x16x32_bf16 v[92:95], v[108:111], a[60:63], v[92:95]
  s_add_u32 s35, s35, 4096
  ds_read_b128 v[104:107], v2 offset:40960
  v_mfma_f32_16x16x32_bf16 v[80:83], v[112:115], a[64:67], v[80:83]
  ds_read_b128 v[108:111], v3 offset:40960
  v_mfma_f32_16x16x32_bf16 v[80:83], v[116:119], a[80:83], v[80:83]
  v_mfma_f32_16x16x32_bf16 v[84:87], v[112:115], a[68:71], v[84:87]
  s_add_u32 m0, s33, 102400
  v_mfma_f32_16x16x32_bf16 v[84:87], v[116:119], a[84:87], v[84:87]
  v_mfma_f32_16x16x32_bf16 v[88:91], v[112:115], a[72:75], v[88:91]
  v_mfma_f32_16x16x32_bf16 v[88:91], v[116:119], a[88:91], v[88:91]
  buffer_load_dwordx4 v12, s[16:19], s35 offen offset:0 lds
  v_mfma_f32_16x16x32_bf16 v[92:95], v[112:115], a[76:79], v[92:95]
  v_mfma_f32_16x16x32_bf16 v[92:95], v[116:119], a[92:95], v[92:95]
  ds_read_b128 v[112:115], v0 offset:41216
  ds_read_b128 v[116:119], v1 offset:41216
  v_mfma_f32_16x16x32_bf16 v[80:83], v[120:123], a[96:99], v[80:83]
  buffer_load_dwordx4 v13, s[16:19], s35 offen offset:1024 lds
  v_mfma_f32_16x16x32_bf16 v[80:83], v[124:127], a[112:115], v[80:83]
  v_mfma_f32_16x16x32_bf16 v[84:87], v[120:123], a[100:103], v[84:87]
  v_mfma_f32_16x16x32_bf16 v[84:87], v[124:127], a[116:119], v[84:87]
  buffer_load_dwordx4 v14, s[16:19], s35 offen offset:2048 lds
  v_mfma_f32_16x16x32_bf16 v[88:91], v[120:123], a[104:107], v[88:91]
  v_mfma_f32_16x16x32_bf16 v[88:91], v[124:127], a[120:123], v[88:91]
  s_waitcnt lgkmcnt(2)
  v_mfma_f32_16x16x32_bf16 v[92:95], v[120:123], a[108:111], v[92:95]
  buffer_load_dwordx4 v15, s[16:19], s35 offen offset:3072 lds
  v_mfma_f32_16x16x32_bf16 v[92:95], v[124:127], a[124:127], v[92:95]
  v_exp_f32 v80, v80
  v_mfma_f32_16x16x32_bf16 v[48:51], v[96:99], a[0:3], v[32:35]
  ds_read_b128 v[120:123], v2 offset:41216
  ds_read_b128 v[124:127], v3 offset:41216
  v_mfma_f32_16x16x32_bf16 v[48:51], v[100:103], a[16:19], v[48:51]
  v_exp_f32 v81, v81
  v_mfma_f32_16x16x32_bf16 v[52:55], v[96:99], a[4:7], v[36:39]
  s_add_u32 s35, s35, 28672
  v_add_f32 v16, v16, v80
  v_mfma_f32_16x16x32_bf16 v[52:55], v[100:103], a[20:23], v[52:55]
  v_exp_f32 v82, v82
  v_mfma_f32_16x16x32_bf16 v[56:59], v[96:99], a[8:11], v[40:43]
  v_add_f32 v16, v16, v81
  v_add_f32 v16, v16, v82
  v_mfma_f32_16x16x32_bf16 v[56:59], v[100:103], a[24:27], v[56:59]
  v_exp_f32 v83, v83
  v_mfma_f32_16x16x32_bf16 v[60:63], v[96:99], a[12:15], v[44:47]
  s_waitcnt vmcnt(16) lgkmcnt(0)
  s_barrier
  v_mfma_f32_16x16x32_bf16 v[60:63], v[100:103], a[28:31], v[60:63]
  v_exp_f32 v84, v84
  v_mfma_f32_16x16x32_bf16 v[48:51], v[104:107], a[32:35], v[48:51]
  ds_read_b64_tr_b16 v[96:97], v4 offset:0
  v_add_f32 v16, v16, v83
  v_mfma_f32_16x16x32_bf16 v[48:51], v[108:111], a[48:51], v[48:51]
  ds_read_b64_tr_b16 v[98:99], v4 offset:8192
  ds_read_b64_tr_b16 v[100:101], v5 offset:0
  v_mfma_f32_16x16x32_bf16 v[52:55], v[104:107], a[36:39], v[52:55]
  ds_read_b64_tr_b16 v[102:103], v5 offset:8192
  v_exp_f32 v85, v85
  v_mfma_f32_16x16x32_bf16 v[52:55], v[108:111], a[52:55], v[52:55]
  s_add_u32 m0, s33, 32768
  v_add_f32 v17, v17, v84
  v_mfma_f32_16x16x32_bf16 v[56:59], v[104:107], a[40:43], v[56:59]
  v_exp_f32 v86, v86
  v_mfma_f32_16x16x32_bf16 v[56:59], v[108:111], a[56:59], v[56:59]
  v_add_f32 v17, v17, v85
  v_add_f32 v17, v17, v86
  v_mfma_f32_16x16x32_bf16 v[60:63], v[104:107], a[44:47], v[60:63]
  v_exp_f32 v87, v87
  v_mfma_f32_16x16x32_bf16 v[60:63], v[108:111], a[60:63], v[60:63]
  buffer_load_dwordx4 v12, s[12:15], s34 offen offset:0 lds
  v_mfma_f32_16x16x32_bf16 v[48:51], v[112:115], a[64:67], v[48:51]
  v_exp_f32 v88, v88
  v_mfma_f32_16x16x32_bf16 v[48:51], v[116:119], a[80:83], v[48:51]
  v_add_f32 v17, v17, v87
  v_cvt_pk_bf16_f32 v80, v80, v81
  v_mfma_f32_16x16x32_bf16 v[52:55], v[112:115], a[68:71], v[52:55]
  ds_read_b64_tr_b16 v[104:105], v6 offset:0
  ds_read_b64_tr_b16 v[106:107], v6 offset:8192
  ds_read_b64_tr_b16 v[108:109], v7 offset:0
  ds_read_b64_tr_b16 v[110:111], v7 offset:8192
  v_exp_f32 v89, v89
  v_mfma_f32_16x16x32_bf16 v[52:55], v[116:119], a[84:87], v[52:55]
  v_add_f32 v18, v18, v88
  v_add_f32 v18, v18, v89
  v_mfma_f32_16x16x32_bf16 v[56:59], v[112:115], a[72:75], v[56:59]
  buffer_load_dwordx4 v13, s[12:15], s34 offen offset:1024 lds
  v_exp_f32 v90, v90
  v_mfma_f32_16x16x32_bf16 v[56:59], v[116:119], a[88:91], v[56:59]
  v_cvt_pk_bf16_f32 v81, v82, v83
  v_add_f32 v18, v18, v90
  v_mfma_f32_16x16x32_bf16 v[60:63], v[112:115], a[76:79], v[60:63]
  v_exp_f32 v91, v91
  v_mfma_f32_16x16x32_bf16 v[60:63], v[116:119], a[92:95], v[60:63]
  v_exp_f32 v92, v92
  v_mfma_f32_16x16x32_bf16 v[48:51], v[120:123], a[96:99], v[48:51]
  buffer_load_dwordx4 v14, s[12:15], s34 offen offset:2048 lds
  v_mfma_f32_16x16x32_bf16 v[48:51], v[124:127], a[112:115], v[48:51]
  v_add_f32 v18, v18, v91
  v_cvt_pk_bf16_f32 v84, v84, v85
  v_mfma_f32_16x16x32_bf16 v[52:55], v[120:123], a[100:103], v[52:55]
  ds_read_b64_tr_b16 v[112:113], v8 offset:0
  ds_read_b64_tr_b16 v[114:115], v8 offset:8192
  ds_read_b64_tr_b16 v[116:117], v9 offset:0
  ds_read_b64_tr_b16 v[118:119], v9 offset:8192
  v_exp_f32 v93, v93
  v_mfma_f32_16x16x32_bf16 v[52:55], v[124:127], a[116:119], v[52:55]
  v_add_f32 v19, v19, v92
  v_add_f32 v19, v19, v93
  v_mfma_f32_16x16x32_bf16 v[56:59], v[120:123], a[104:107], v[56:59]
  v_exp_f32 v94, v94
  v_mfma_f32_16x16x32_bf16 v[56:59], v[124:127], a[120:123], v[56:59]
  v_cvt_pk_bf16_f32 v85, v86, v87
  s_waitcnt lgkmcnt(4)
  v_mfma_f32_16x16x32_bf16 v[60:63], v[120:123], a[108:111], v[60:63]
  buffer_load_dwordx4 v15, s[12:15], s34 offen offset:3072 lds
  v_exp_f32 v95, v95
  v_mfma_f32_16x16x32_bf16 v[60:63], v[124:127], a[124:127], v[60:63]
  v_add_f32 v19, v19, v94
  v_add_f32 v19, v19, v95
  v_mfma_f32_16x16x32_bf16 v[128:131], v[96:99], v[64:67], v[128:131]
  v_exp_f32 v48, v48
  v_mfma_f32_16x16x32_bf16 v[132:135], v[96:99], v[68:71], v[132:135]
  ds_read_b64_tr_b16 v[120:121], v10 offset:0
  v_cvt_pk_bf16_f32 v88, v88, v89
  v_mfma_f32_16x16x32_bf16 a[128:131], v[96:99], v[72:75], a[128:131]
  ds_read_b64_tr_b16 v[122:123], v10 offset:8192
  ds_read_b64_tr_b16 v[124:125], v11 offset:0
  ds_read_b64_tr_b16 v[126:127], v11 offset:8192
  v_mfma_f32_16x16x32_bf16 a[132:135], v[96:99], v[76:79], a[132:135]
  s_add_u32 s34, s34, 4096
  v_add_f32 v16, v16, v48
  v_mfma_f32_16x16x32_bf16 v[136:139], v[100:103], v[64:67], v[136:139]
  v_exp_f32 v49, v49
  v_mfma_f32_16x16x32_bf16 v[140:143], v[100:103], v[68:71], v[140:143]
  ds_read_b64_tr_b16 v[96:97], v4 offset:256
  v_cvt_pk_bf16_f32 v89, v90, v91
  v_mfma_f32_16x16x32_bf16 a[136:139], v[100:103], v[72:75], a[136:139]
  ds_read_b64_tr_b16 v[98:99], v4 offset:8448
  v_add_f32 v16, v16, v49
  v_mfma_f32_16x16x32_bf16 a[140:143], v[100:103], v[76:79], a[140:143]
  v_exp_f32 v50, v50
  v_mfma_f32_16x16x32_bf16 v[144:147], v[104:107], v[64:67], v[144:147]
  s_add_u32 m0, s33, 36864
  v_cvt_pk_bf16_f32 v92, v92, v93
  v_mfma_f32_16x16x32_bf16 v[148:151], v[104:107], v[68:71], v[148:151]
  ds_read_b64_tr_b16 v[100:101], v5 offset:256
  ds_read_b64_tr_b16 v[102:103], v5 offset:8448
  v_mfma_f32_16x16x32_bf16 a[144:147], v[104:107], v[72:75], a[144:147]
  v_exp_f32 v51, v51
  v_add_f32 v16, v16, v50
  v_mfma_f32_16x16x32_bf16 a[148:151], v[104:107], v[76:79], a[148:151]
  buffer_load_dwordx4 v12, s[12:15], s34 offen offset:0 lds
  v_mfma_f32_16x16x32_bf16 v[152:155], v[108:111], v[64:67], v[152:155]
  v_exp_f32 v52, v52
  v_mfma_f32_16x16x32_bf16 v[156:159], v[108:111], v[68:71], v[156:159]
  v_add_f32 v16, v16, v51
  v_cvt_pk_bf16_f32 v93, v94, v95
  v_mfma_f32_16x16x32_bf16 a[152:155], v[108:111], v[72:75], a[152:155]
  ds_read_b64_tr_b16 v[104:105], v6 offset:256
  ds_read_b64_tr_b16 v[106:107], v6 offset:8448
  v_mfma_f32_16x16x32_bf16 a[156:159], v[108:111], v[76:79], a[156:159]
  s_waitcnt lgkmcnt(6)
  v_add_f32 v17, v17, v52
  v_mfma_f32_16x16x32_bf16 v[160:163], v[112:115], v[64:67], v[160:163]
  v_exp_f32 v53, v53
  v_mfma_f32_16x16x32_bf16 v[164:167], v[112:115], v[68:71], v[164:167]
  ds_read_b64_tr_b16 v[108:109], v7 offset:256
  ds_read_b64_tr_b16 v[110:111], v7 offset:8448
  v_mfma_f32_16x16x32_bf16 a[160:163], v[112:115], v[72:75], a[160:163]
  buffer_load_dwordx4 v13, s[12:15], s34 offen offset:1024 lds
  v_mfma_f32_16x16x32_bf16 a[164:167], v[112:115], v[76:79], a[164:167]
  v_exp_f32 v54, v54
  v_add_f32 v17, v17, v53
  v_cvt_pk_bf16_f32 v82, v48, v49
  v_mfma_f32_16x16x32_bf16 v[168:171], v[116:119], v[64:67], v[168:171]
  ds_read_b64_tr_b16 v[112:113], v8 offset:256
  ds_read_b64_tr_b16 v[114:115], v8 offset:8448
  v_mfma_f32_16x16x32_bf16 v[172:175], v[116:119], v[68:71], v[172:175]
  v_exp_f32 v55, v55
  v_mfma_f32_16x16x32_bf16 a[168:171], v[116:119], v[72:75], a[168:171]
  v_add_f32 v17, v17, v54
  v_add_f32 v17, v17, v55
  v_mfma_f32_16x16x32_bf16 a[172:175], v[116:119], v[76:79], a[172:175]
  buffer_load_dwordx4 v14, s[12:15], s34 offen offset:2048 lds
  v_mfma_f32_16x16x32_bf16 v[176:179], v[120:123], v[64:67], v[176:179]
  v_exp_f32 v56, v56
  v_mfma_f32_16x16x32_bf16 v[180:183], v[120:123], v[68:71], v[180:183]
  ds_read_b64_tr_b16 v[116:117], v9 offset:256
  v_cvt_pk_bf16_f32 v83, v50, v51
  v_mfma_f32_16x16x32_bf16 a[176:179], v[120:123], v[72:75], a[176:179]
  ds_read_b64_tr_b16 v[118:119], v9 offset:8448
  v_add_f32 v18, v18, v56
  v_mfma_f32_16x16x32_bf16 a[180:183], v[120:123], v[76:79], a[180:183]
  buffer_load_dwordx4 v15, s[12:15], s34 offen offset:3072 lds
  v_mfma_f32_16x16x32_bf16 v[184:187], v[124:127], v[64:67], v[184:187]
  v_exp_f32 v57, v57
  v_mfma_f32_16x16x32_bf16 v[188:191], v[124:127], v[68:71], v[188:191]
  ds_read_b64_tr_b16 v[120:121], v10 offset:256
  ds_read_b64_tr_b16 v[122:123], v10 offset:8448
  v_mfma_f32_16x16x32_bf16 a[184:187], v[124:127], v[72:75], a[184:187]
  s_waitcnt lgkmcnt(6)
  v_add_f32 v18, v18, v57
  v_mfma_f32_16x16x32_bf16 a[188:191], v[124:127], v[76:79], a[188:191]
  v_exp_f32 v58, v58
  v_cvt_pk_bf16_f32 v86, v52, v53
  v_mfma_f32_16x16x32_bf16 v[192:195], v[96:99], v[64:67], v[192:195]
  s_add_u32 s34, s34, 28672
  ds_read_b64_tr_b16 v[124:125], v11 offset:256
  v_mfma_f32_16x16x32_bf16 v[196:199], v[96:99], v[68:71], v[196:199]
  ds_read_b64_tr_b16 v[126:127], v11 offset:8448
  v_add_f32 v18, v18, v58
  v_mfma_f32_16x16x32_bf16 a[192:195], v[96:99], v[72:75], a[192:195]
  v_exp_f32 v59, v59
  v_mfma_f32_16x16x32_bf16 a[196:199], v[96:99], v[76:79], a[196:199]
  v_exp_f32 v60, v60
  v_mfma_f32_16x16x32_bf16 v[200:203], v[100:103], v[64:67], v[200:203]
  v_add_f32 v18, v18, v59
  v_cvt_pk_bf16_f32 v87, v54, v55
  v_mfma_f32_16x16x32_bf16 v[204:207], v[100:103], v[68:71], v[204:207]
  v_add_f32 v19, v19, v60
  v_cvt_pk_bf16_f32 v90, v56, v57
  v_mfma_f32_16x16x32_bf16 a[200:203], v[100:103], v[72:75], a[200:203]
  s_waitcnt vmcnt(16) lgkmcnt(0)
  s_barrier
  v_mfma_f32_16x16x32_bf16 a[204:207], v[100:103], v[76:79], a[204:207]
  v_exp_f32 v61, v61
  v_mfma_f32_16x16x32_bf16 v[208:211], v[104:107], v[64:67], v[208:211]
  ds_read_b128 v[96:99], v0 offset:0
  ds_read_b128 v[100:103], v1 offset:0
  v_mfma_f32_16x16x32_bf16 v[212:215], v[104:107], v[68:71], v[212:215]
  v_exp_f32 v62, v62
  v_mfma_f32_16x16x32_bf16 a[208:211], v[104:107], v[72:75], a[208:211]
  v_add_f32 v19, v19, v61
  v_add_f32 v19, v19, v62
  v_mfma_f32_16x16x32_bf16 a[212:215], v[104:107], v[76:79], a[212:215]
  ds_read_b128 v[104:107], v2 offset:0
  v_cvt_pk_bf16_f32 v91, v58, v59
  v_mfma_f32_16x16x32_bf16 v[216:219], v[108:111], v[64:67], v[216:219]
  v_exp_f32 v63, v63
  v_mfma_f32_16x16x32_bf16 v[220:223], v[108:111], v[68:71], v[220:223]
  v_add_f32 v19, v19, v63
  v_cvt_pk_bf16_f32 v94, v60, v61
  v_mfma_f32_16x16x32_bf16 a[216:219], v[108:111], v[72:75], a[216:219]
  v_cvt_pk_bf16_f32 v95, v62, v63
  v_mfma_f32_16x16x32_bf16 a[220:223], v[108:111], v[76:79], a[220:223]
  ds_read_b128 v[108:111], v3 offset:0
  v_mfma_f32_16x16x32_bf16 v[224:227], v[112:115], v[64:67], v[224:227]
  v_mfma_f32_16x16x32_bf16 v[228:231], v[112:115], v[68:71], v[228:231]
  v_mfma_f32_16x16x32_bf16 a[224:227], v[112:115], v[72:75], a[224:227]
  v_mfma_f32_16x16x32_bf16 a[228:231], v[112:115], v[76:79], a[228:231]
  ds_read_b128 v[112:115], v0 offset:256
  v_mfma_f32_16x16x32_bf16 v[232:235], v[116:119], v[64:67], v[232:235]
  v_mfma_f32_16x16x32_bf16 v[236:239], v[116:119], v[68:71], v[236:239]
  v_mfma_f32_16x16x32_bf16 a[232:235], v[116:119], v[72:75], a[232:235]
  v_mfma_f32_16x16x32_bf16 a[236:239], v[116:119], v[76:79], a[236:239]
  ds_read_b128 v[116:119], v1 offset:256
  v_mfma_f32_16x16x32_bf16 v[240:243], v[120:123], v[64:67], v[240:243]
  v_mfma_f32_16x16x32_bf16 v[244:247], v[120:123], v[68:71], v[244:247]
  v_mfma_f32_16x16x32_bf16 a[240:243], v[120:123], v[72:75], a[240:243]
  v_mfma_f32_16x16x32_bf16 a[244:247], v[120:123], v[76:79], a[244:247]
  ds_read_b128 v[120:123], v2 offset:256
  v_mfma_f32_16x16x32_bf16 v[248:251], v[124:127], v[64:67], v[248:251]
  v_mfma_f32_16x16x32_bf16 v[252:255], v[124:127], v[68:71], v[252:255]
  s_waitcnt lgkmcnt(3)
  v_mfma_f32_16x16x32_bf16 a[248:251], v[124:127], v[72:75], a[248:251]
  v_mfma_f32_16x16x32_bf16 a[252:255], v[124:127], v[76:79], a[252:255]
  ds_read_b128 v[124:127], v3 offset:256
  s_sub_u32 s36, s36, 1
  s_cmp_lg_u32 s36, 0
  s_cbranch_scc1 L_k2_loop
  v_mfma_f32_16x16x32_bf16 v[64:67], v[96:99], a[0:3], v[32:35]
  s_add_u32 m0, s33, 65536
  v_mfma_f32_16x16x32_bf16 v[64:67], v[100:103], a[16:19], v[64:67]
  v_mfma_f32_16x16x32_bf16 v[68:71], v[96:99], a[4:7], v[36:39]
  v_mfma_f32_16x16x32_bf16 v[68:71], v[100:103], a[20:23], v[68:71]
  buffer_load_dwordx4 v12, s[16:19], s35 offen offset:0 lds
  v_mfma_f32_16x16x32_bf16 v[72:75], v[96:99], a[8:11], v[40:43]
  v_mfma_f32_16x16x32_bf16 v[72:75], v[100:103], a[24:27], v[72:75]
  v_mfma_f32_16x16x32_bf16 v[76:79], v[96:99], a[12:15], v[44:47]
  buffer_load_dwordx4 v13, s[16:19], s35 offen offset:1024 lds
  v_mfma_f32_16x16x32_bf16 v[76:79], v[100:103], a[28:31], v[76:79]
  ds_read_b128 v[96:99], v0 offset:8192
  ds_read_b128 v[100:103], v1 offset:8192
  v_mfma_f32_16x16x32_bf16 v[64:67], v[104:107], a[32:35], v[64:67]
  v_mfma_f32_16x16x32_bf16 v[64:67], v[108:111], a[48:51], v[64:67]
  buffer_load_dwordx4 v14, s[16:19], s35 offen offset:2048 lds
  v_mfma_f32_16x16x32_bf16 v[68:71], v[104:107], a[36:39], v[68:71]
  v_mfma_f32_16x16x32_bf16 v[68:71], v[108:111], a[52:55], v[68:71]
  v_mfma_f32_16x16x32_bf16 v[72:75], v[104:107], a[40:43], v[72:75]
  buffer_load_dwordx4 v15, s[16:19], s35 offen offset:3072 lds
  v_mfma_f32_16x16x32_bf16 v[72:75], v[108:111], a[56:59], v[72:75]
  s_mov_b64 s[8:9], s[4:5]
  s_waitcnt lgkmcnt(2)
  v_mfma_f32_16x16x32_bf16 v[76:79], v[104:107], a[44:47], v[76:79]
  s_mov_b32 s10, s6
  v_mfma_f32_16x16x32_bf16 v[76:79], v[108:111], a[60:63], v[76:79]
  s_add_u32 s35, s35, 4096
  ds_read_b128 v[104:107], v2 offset:8192
  v_mfma_f32_16x16x32_bf16 v[64:67], v[112:115], a[64:67], v[64:67]
  ds_read_b128 v[108:111], v3 offset:8192
  s_lshr_b32 s56, s2, 3
  v_mfma_f32_16x16x32_bf16 v[64:67], v[116:119], a[80:83], v[64:67]
  v_mfma_f32_16x16x32_bf16 v[68:71], v[112:115], a[68:71], v[68:71]
  s_add_u32 m0, s33, 69632
  v_mfma_f32_16x16x32_bf16 v[68:71], v[116:119], a[84:87], v[68:71]
  s_lshl_b32 s56, s56, 2
  v_mfma_f32_16x16x32_bf16 v[72:75], v[112:115], a[72:75], v[72:75]
  v_mfma_f32_16x16x32_bf16 v[72:75], v[116:119], a[88:91], v[72:75]
  buffer_load_dwordx4 v12, s[16:19], s35 offen offset:0 lds
  v_mfma_f32_16x16x32_bf16 v[76:79], v[112:115], a[76:79], v[76:79]
  s_add_u32 s56, s56, s32
  v_mfma_f32_16x16x32_bf16 v[76:79], v[116:119], a[92:95], v[76:79]
  ds_read_b128 v[112:115], v0 offset:8448
  ds_read_b128 v[116:119], v1 offset:8448
  v_mfma_f32_16x16x32_bf16 v[64:67], v[120:123], a[96:99], v[64:67]
  buffer_load_dwordx4 v13, s[16:19], s35 offen offset:1024 lds
  v_mfma_f32_16x16x32_bf16 v[64:67], v[124:127], a[112:115], v[64:67]
  s_lshl_b32 s56, s56, 8
  v_mfma_f32_16x16x32_bf16 v[68:71], v[120:123], a[100:103], v[68:71]
  v_lshl_add_u32 v31, v24, 2, s56
  v_mfma_f32_16x16x32_bf16 v[68:71], v[124:127], a[116:119], v[68:71]
  buffer_load_dwordx4 v14, s[16:19], s35 offen offset:2048 lds
  v_mfma_f32_16x16x32_bf16 v[72:75], v[120:123], a[104:107], v[72:75]
  s_getpc_b64 s[4:5]
L_k2_pc:
  s_add_u32 s4, s4, L_tail-L_k2_pc
  s_addc_u32 s5, s5, 0
  v_mfma_f32_16x16x32_bf16 v[72:75], v[124:127], a[120:123], v[72:75]
  s_waitcnt lgkmcnt(2)
  v_mfma_f32_16x16x32_bf16 v[76:79], v[120:123], a[108:111], v[76:79]
  buffer_load_dwordx4 v15, s[16:19], s35 offen offset:3072 lds
  v_mfma_f32_16x16x32_bf16 v[76:79], v[124:127], a[124:127], v[76:79]
  v_exp_f32 v64, v64
  v_mfma_f32_16x16x32_bf16 v[48:51], v[96:99], a[0:3], v[32:35]
  s_mov_b32 s6, L_text_end-L_tail
  ds_read_b128 v[120:123], v2 offset:8448
  v_mfma_f32_16x16x32_bf16 v[48:51], v[100:103], a[16:19], v[48:51]
  ds_read_b128 v[124:127], v3 offset:8448
  s_add_u32 s35, s35, 28672
  v_mfma_f32_16x16x32_bf16 v[52:55], v[96:99], a[4:7], v[36:39]
  v_exp_f32 v65, v65
  v_mfma_f32_16x16x32_bf16 v[52:55], v[100:103], a[20:23], v[52:55]
  buffer_load_dword v30, v31, s[4:7], 0 offen
  v_add_f32 v16, v16, v64
  v_mfma_f32_16x16x32_bf16 v[56:59], v[96:99], a[8:11], v[40:43]
  v_exp_f32 v66, v66
  v_mfma_f32_16x16x32_bf16 v[56:59], v[100:103], a[24:27], v[56:59]
  v_add_f32 v16, v16, v65
  v_add_f32 v16, v16, v66
  v_mfma_f32_16x16x32_bf16 v[60:63], v[96:99], a[12:15], v[44:47]
  v_exp_f32 v67, v67
  s_waitcnt vmcnt(17) lgkmcnt(0)
  s_barrier
  v_mfma_f32_16x16x32_bf16 v[60:63], v[100:103], a[28:31], v[60:63]
  v_exp_f32 v68, v68
  v_mfma_f32_16x16x32_bf16 v[48:51], v[104:107], a[32:35], v[48:51]
  ds_read_b64_tr_b16 v[96:97], v4 offset:32768
  v_add_f32 v16, v16, v67
  v_mfma_f32_16x16x32_bf16 v[48:51], v[108:111], a[48:51], v[48:51]
  ds_read_b64_tr_b16 v[98:99], v4 offset:40960
  ds_read_b64_tr_b16 v[100:101], v5 offset:32768
  v_mfma_f32_16x16x32_bf16 v[52:55], v[104:107], a[36:39], v[52:55]
  ds_read_b64_tr_b16 v[102:103], v5 offset:40960
  v_exp_f32 v69, v69
  v_mfma_f32_16x16x32_bf16 v[52:55], v[108:111], a[52:55], v[52:55]
  s_add_u32 m0, s33, 0
  v_add_f32 v17, v17, v68
  v_mfma_f32_16x16x32_bf16 v[56:59], v[104:107], a[40:43], v[56:59]
  v_exp_f32 v70, v70
  v_mfma_f32_16x16x32_bf16 v[56:59], v[108:111], a[56:59], v[56:59]
  v_add_f32 v17, v17, v69
  s_lshl_b32 s57, s51, 2
  v_mfma_f32_16x16x32_bf16 v[60:63], v[104:107], a[44:47], v[60:63]
  v_exp_f32 v71, v71
  v_mfma_f32_16x16x32_bf16 v[60:63], v[108:111], a[60:63], v[60:63]
  buffer_load_dwordx4 v12, s[16:19], s35 offen offset:0 lds
  v_add_f32 v17, v17, v70
  v_mfma_f32_16x16x32_bf16 v[48:51], v[112:115], a[64:67], v[48:51]
  v_exp_f32 v72, v72
  v_mfma_f32_16x16x32_bf16 v[48:51], v[116:119], a[80:83], v[48:51]
  s_add_u32 s57, s57, s32
  v_add_f32 v17, v17, v71
  v_cvt_pk_bf16_f32 v64, v64, v65
  v_mfma_f32_16x16x32_bf16 v[52:55], v[112:115], a[68:71], v[52:55]
  ds_read_b64_tr_b16 v[104:105], v6 offset:32768
  ds_read_b64_tr_b16 v[106:107], v6 offset:40960
  ds_read_b64_tr_b16 v[108:109], v7 offset:32768
  ds_read_b64_tr_b16 v[110:111], v7 offset:40960
  v_exp_f32 v73, v73
  v_mfma_f32_16x16x32_bf16 v[52:55], v[116:119], a[84:87], v[52:55]
  v_add_f32 v18, v18, v72
  s_mul_i32 s57, s57, 3584
  v_mfma_f32_16x16x32_bf16 v[56:59], v[112:115], a[72:75], v[56:59]
  buffer_load_dwordx4 v13, s[16:19], s35 offen offset:1024 lds
  v_exp_f32 v74, v74
  v_mfma_f32_16x16x32_bf16 v[56:59], v[116:119], a[88:91], v[56:59]
  v_add_f32 v18, v18, v73
  v_cvt_pk_bf16_f32 v65, v66, v67
  v_mfma_f32_16x16x32_bf16 v[60:63], v[112:115], a[76:79], v[60:63]
  v_exp_f32 v75, v75
  v_mfma_f32_16x16x32_bf16 v[60:63], v[116:119], a[92:95], v[60:63]
  v_add_f32 v18, v18, v74
  s_mul_i32 s58, s57, 7
  v_mfma_f32_16x16x32_bf16 v[48:51], v[120:123], a[96:99], v[48:51]
  v_exp_f32 v76, v76
  v_mfma_f32_16x16x32_bf16 v[48:51], v[124:127], a[112:115], v[48:51]
  buffer_load_dwordx4 v14, s[16:19], s35 offen offset:2048 lds
  v_add_f32 v18, v18, v75
  v_cvt_pk_bf16_f32 v68, v68, v69
  v_mfma_f32_16x16x32_bf16 v[52:55], v[120:123], a[100:103], v[52:55]
  ds_read_b64_tr_b16 v[112:113], v8 offset:32768
  ds_read_b64_tr_b16 v[114:115], v8 offset:40960
  ds_read_b64_tr_b16 v[116:117], v9 offset:32768
  ds_read_b64_tr_b16 v[118:119], v9 offset:40960
  v_exp_f32 v77, v77
  v_mfma_f32_16x16x32_bf16 v[52:55], v[124:127], a[116:119], v[52:55]
  s_lshl_b32 s59, s3, 9
  v_add_f32 v19, v19, v76
  v_mfma_f32_16x16x32_bf16 v[56:59], v[120:123], a[104:107], v[56:59]
  v_exp_f32 v78, v78
  v_mfma_f32_16x16x32_bf16 v[56:59], v[124:127], a[120:123], v[56:59]
  v_add_f32 v19, v19, v77
  v_cvt_pk_bf16_f32 v69, v70, v71
  v_mfma_f32_16x16x32_bf16 v[60:63], v[120:123], a[108:111], v[60:63]
  buffer_load_dwordx4 v15, s[16:19], s35 offen offset:3072 lds
  v_exp_f32 v79, v79
  v_mfma_f32_16x16x32_bf16 v[60:63], v[124:127], a[124:127], v[60:63]
  s_waitcnt lgkmcnt(4)
  s_add_u32 s58, s58, s59
  v_add_f32 v19, v19, v78
  v_mfma_f32_16x16x32_bf16 v[128:131], v[96:99], v[80:83], v[128:131]
  v_exp_f32 v48, v48
  v_mfma_f32_16x16x32_bf16 v[132:135], v[96:99], v[84:87], v[132:135]
  v_add_f32 v19, v19, v79
  v_cvt_pk_bf16_f32 v72, v72, v73
  v_mfma_f32_16x16x32_bf16 a[128:131], v[96:99], v[88:91], a[128:131]
  ds_read_b64_tr_b16 v[120:121], v10 offset:32768
  ds_read_b64_tr_b16 v[122:123], v10 offset:40960
  ds_read_b64_tr_b16 v[124:125], v11 offset:32768
  ds_read_b64_tr_b16 v[126:127], v11 offset:40960
  v_lshrrev_b32 v22, 3, v24
  v_mfma_f32_16x16x32_bf16 a[132:135], v[96:99], v[92:95], a[132:135]
  s_add_u32 s35, s35, 4096
  v_add_f32 v16, v16, v48
  v_mfma_f32_16x16x32_bf16 v[136:139], v[100:103], v[80:83], v[136:139]
  v_exp_f32 v49, v49
  v_mfma_f32_16x16x32_bf16 v[140:143], v[100:103], v[84:87], v[140:143]
  ds_read_b64_tr_b16 v[96:97], v4 offset:33024
  v_cvt_pk_bf16_f32 v73, v74, v75
  v_mfma_f32_16x16x32_bf16 a[136:139], v[100:103], v[88:91], a[136:139]
  ds_read_b64_tr_b16 v[98:99], v4 offset:41216
  v_mul_u32_u24 v22, 3072, v22
  v_mfma_f32_16x16x32_bf16 a[140:143], v[100:103], v[92:95], a[140:143]
  v_exp_f32 v50, v50
  v_add_f32 v16, v16, v49
  v_mfma_f32_16x16x32_bf16 v[144:147], v[104:107], v[80:83], v[144:147]
  s_add_u32 m0, s33, 4096
  v_lshl_add_u32 v21, v24, 6, s58
  v_mfma_f32_16x16x32_bf16 v[148:151], v[104:107], v[84:87], v[148:151]
  ds_read_b64_tr_b16 v[100:101], v5 offset:33024
  v_cvt_pk_bf16_f32 v76, v76, v77
  v_mfma_f32_16x16x32_bf16 a[144:147], v[104:107], v[88:91], a[144:147]
  ds_read_b64_tr_b16 v[102:103], v5 offset:41216
  v_exp_f32 v51, v51
  v_add_f32 v16, v16, v50
  v_mfma_f32_16x16x32_bf16 a[148:151], v[104:107], v[92:95], a[148:151]
  buffer_load_dwordx4 v12, s[16:19], s35 offen offset:0 lds
  v_mfma_f32_16x16x32_bf16 v[152:155], v[108:111], v[80:83], v[152:155]
  v_add_u32 v21, v21, v22
  v_add_f32 v16, v16, v51
  v_mfma_f32_16x16x32_bf16 v[156:159], v[108:111], v[84:87], v[156:159]
  v_exp_f32 v52, v52
  v_cvt_pk_bf16_f32 v77, v78, v79
  v_mfma_f32_16x16x32_bf16 a[152:155], v[108:111], v[88:91], a[152:155]
  ds_read_b64_tr_b16 v[104:105], v6 offset:33024
  ds_read_b64_tr_b16 v[106:107], v6 offset:41216
  v_mfma_f32_16x16x32_bf16 a[156:159], v[108:111], v[92:95], a[156:159]
  s_waitcnt lgkmcnt(6)
  v_mul_u32_u24 v22, 56, v24
  v_mfma_f32_16x16x32_bf16 v[160:163], v[112:115], v[80:83], v[160:163]
  v_exp_f32 v53, v53
  v_add_f32 v17, v17, v52
  v_mfma_f32_16x16x32_bf16 v[164:167], v[112:115], v[84:87], v[164:167]
  ds_read_b64_tr_b16 v[108:109], v7 offset:33024
  ds_read_b64_tr_b16 v[110:111], v7 offset:41216
  v_mfma_f32_16x16x32_bf16 a[160:163], v[112:115], v[88:91], a[160:163]
  buffer_load_dwordx4 v13, s[16:19], s35 offen offset:1024 lds
  v_mfma_f32_16x16x32_bf16 a[164:167], v[112:115], v[92:95], a[164:167]
  v_exp_f32 v54, v54
  v_add_f32 v17, v17, v53
  v_cvt_pk_bf16_f32 v66, v48, v49
  v_mfma_f32_16x16x32_bf16 v[168:171], v[116:119], v[80:83], v[168:171]
  ds_read_b64_tr_b16 v[112:113], v8 offset:33024
  v_add_u32 v22, s57, v22
  v_mfma_f32_16x16x32_bf16 v[172:175], v[116:119], v[84:87], v[172:175]
  ds_read_b64_tr_b16 v[114:115], v8 offset:41216
  v_add_f32 v17, v17, v54
  v_mfma_f32_16x16x32_bf16 a[168:171], v[116:119], v[88:91], a[168:171]
  v_exp_f32 v55, v55
  v_mfma_f32_16x16x32_bf16 a[172:175], v[116:119], v[92:95], a[172:175]
  buffer_load_dwordx4 v14, s[16:19], s35 offen offset:2048 lds
  v_add_u32 v26, 6144, v25
  v_mfma_f32_16x16x32_bf16 v[176:179], v[120:123], v[80:83], v[176:179]
  v_exp_f32 v56, v56
  v_mfma_f32_16x16x32_bf16 v[180:183], v[120:123], v[84:87], v[180:183]
  v_add_f32 v17, v17, v55
  v_cvt_pk_bf16_f32 v67, v50, v51
  v_mfma_f32_16x16x32_bf16 a[176:179], v[120:123], v[88:91], a[176:179]
  ds_read_b64_tr_b16 v[116:117], v9 offset:33024
  ds_read_b64_tr_b16 v[118:119], v9 offset:41216
  v_mfma_f32_16x16x32_bf16 a[180:183], v[120:123], v[92:95], a[180:183]
  v_add_u32 v27, 12288, v25
  v_add_f32 v18, v18, v56
  v_mfma_f32_16x16x32_bf16 v[184:187], v[124:127], v[80:83], v[184:187]
  buffer_load_dwordx4 v15, s[16:19], s35 offen offset:3072 lds
  v_exp_f32 v57, v57
  v_mfma_f32_16x16x32_bf16 v[188:191], v[124:127], v[84:87], v[188:191]
  ds_read_b64_tr_b16 v[120:121], v10 offset:33024
  ds_read_b64_tr_b16 v[122:123], v10 offset:41216
  v_mfma_f32_16x16x32_bf16 a[184:187], v[124:127], v[88:91], a[184:187]
  v_add_u32 v28, 18432, v25
  s_waitcnt lgkmcnt(6)
  v_mfma_f32_16x16x32_bf16 a[188:191], v[124:127], v[92:95], a[188:191]
  v_exp_f32 v58, v58
  v_add_f32 v18, v18, v57
  v_cvt_pk_bf16_f32 v70, v52, v53
  v_mfma_f32_16x16x32_bf16 v[192:195], v[96:99], v[80:83], v[192:195]
  s_add_u32 s35, s35, 28672
  ds_read_b64_tr_b16 v[124:125], v11 offset:33024
  v_mfma_f32_16x16x32_bf16 v[196:199], v[96:99], v[84:87], v[196:199]
  ds_read_b64_tr_b16 v[126:127], v11 offset:41216
  v_add_f32 v18, v18, v58
  v_mfma_f32_16x16x32_bf16 a[192:195], v[96:99], v[88:91], a[192:195]
  v_exp_f32 v59, v59
  v_mfma_f32_16x16x32_bf16 a[196:199], v[96:99], v[92:95], a[196:199]
  v_exp_f32 v60, v60
  v_mfma_f32_16x16x32_bf16 v[200:203], v[100:103], v[80:83], v[200:203]
  v_add_f32 v18, v18, v59
  v_cvt_pk_bf16_f32 v71, v54, v55
  v_mfma_f32_16x16x32_bf16 v[204:207], v[100:103], v[84:87], v[204:207]
  v_add_f32 v19, v19, v60
  v_cvt_pk_bf16_f32 v74, v56, v57
  v_mfma_f32_16x16x32_bf16 a[200:203], v[100:103], v[88:91], a[200:203]
  s_waitcnt vmcnt(17) lgkmcnt(0)
  s_barrier
  v_mfma_f32_16x16x32_bf16 a[204:207], v[100:103], v[92:95], a[204:207]
  v_exp_f32 v61, v61
  v_mfma_f32_16x16x32_bf16 v[208:211], v[104:107], v[80:83], v[208:211]
  s_movk_i32 s38, 0
  ds_read_b128 v[96:99], v0 offset:32768
  v_mfma_f32_16x16x32_bf16 v[212:215], v[104:107], v[84:87], v[212:215]
  ds_read_b128 v[100:103], v1 offset:32768
  s_add_u32 m0, s33, 131072
  v_mfma_f32_16x16x32_bf16 a[208:211], v[104:107], v[88:91], a[208:211]
  v_exp_f32 v62, v62
  v_mfma_f32_16x16x32_bf16 a[212:215], v[104:107], v[92:95], a[212:215]
  ds_read_b128 v[104:107], v2 offset:32768
  v_add_f32 v19, v19, v61
  v_mfma_f32_16x16x32_bf16 v[216:219], v[108:111], v[80:83], v[216:219]
  buffer_load_dwordx4 v25, s[20:23], s38 offen offset:0 lds
  v_mfma_f32_16x16x32_bf16 v[220:223], v[108:111], v[84:87], v[220:223]
  buffer_load_dwordx4 v26, s[20:23], s38 offen offset:1024 lds
  v_mfma_f32_16x16x32_bf16 a[216:219], v[108:111], v[88:91], a[216:219]
  v_exp_f32 v63, v63
  v_add_f32 v19, v19, v62
  v_mfma_f32_16x16x32_bf16 a[220:223], v[108:111], v[92:95], a[220:223]
  buffer_load_dwordx4 v27, s[20:23], s38 offen offset:2048 lds
  v_mfma_f32_16x16x32_bf16 v[224:227], v[112:115], v[80:83], v[224:227]
  v_add_f32 v19, v19, v63
  v_cvt_pk_bf16_f32 v75, v58, v59
  v_mfma_f32_16x16x32_bf16 v[228:231], v[112:115], v[84:87], v[228:231]
  ds_read_b128 v[108:111], v3 offset:32768
  v_cvt_pk_bf16_f32 v78, v60, v61
  v_mfma_f32_16x16x32_bf16 a[224:227], v[112:115], v[88:91], a[224:227]
  buffer_load_dwordx4 v28, s[20:23], s38 offen offset:3072 lds
  v_mfma_f32_16x16x32_bf16 a[228:231], v[112:115], v[92:95], a[228:231]
  s_add_u32 s38, s38, 28672
  ds_read_b128 v[112:115], v0 offset:33024
  v_mfma_f32_16x16x32_bf16 v[232:235], v[116:119], v[80:83], v[232:235]
  s_add_u32 m0, s33, 135168
  v_cvt_pk_bf16_f32 v79, v62, v63
  v_mfma_f32_16x16x32_bf16 v[236:239], v[116:119], v[84:87], v[236:239]
  v_mfma_f32_16x16x32_bf16 a[232:235], v[116:119], v[88:91], a[232:235]
  buffer_load_dwordx4 v25, s[20:23], s38 offen offset:0 lds
  v_mfma_f32_16x16x32_bf16 a[236:239], v[116:119], v[92:95], a[236:239]
  ds_read_b128 v[116:119], v1 offset:33024
  v_mfma_f32_16x16x32_bf16 v[240:243], v[120:123], v[80:83], v[240:243]
  buffer_load_dwordx4 v26, s[20:23], s38 offen offset:1024 lds
  v_mfma_f32_16x16x32_bf16 v[244:247], v[120:123], v[84:87], v[244:247]
  v_mfma_f32_16x16x32_bf16 a[240:243], v[120:123], v[88:91], a[240:243]
  buffer_load_dwordx4 v27, s[20:23], s38 offen offset:2048 lds
  v_mfma_f32_16x16x32_bf16 a[244:247], v[120:123], v[92:95], a[244:247]
  ds_read_b128 v[120:123], v2 offset:33024
  v_mfma_f32_16x16x32_bf16 v[248:251], v[124:127], v[80:83], v[248:251]
  buffer_load_dwordx4 v28, s[20:23], s38 offen offset:3072 lds
  v_mfma_f32_16x16x32_bf16 v[252:255], v[124:127], v[84:87], v[252:255]
  s_waitcnt lgkmcnt(3)
  v_mfma_f32_16x16x32_bf16 a[248:251], v[124:127], v[88:91], a[248:251]
  v_mfma_f32_16x16x32_bf16 a[252:255], v[124:127], v[92:95], a[252:255]
  ds_read_b128 v[124:127], v3 offset:33024
  v_mfma_f32_16x16x32_bf16 v[80:83], v[96:99], a[0:3], v[32:35]
  s_movk_i32 s38, 128
  v_mfma_f32_16x16x32_bf16 v[80:83], v[100:103], a[16:19], v[80:83]
  v_mfma_f32_16x16x32_bf16 v[84:87], v[96:99], a[4:7], v[36:39]
  v_mfma_f32_16x16x32_bf16 v[84:87], v[100:103], a[20:23], v[84:87]
  s_add_u32 m0, s33, 98304
  v_mfma_f32_16x16x32_bf16 v[88:91], v[96:99], a[8:11], v[40:43]
  v_mfma_f32_16x16x32_bf16 v[88:91], v[100:103], a[24:27], v[88:91]
  v_mfma_f32_16x16x32_bf16 v[92:95], v[96:99], a[12:15], v[44:47]
  buffer_load_dwordx4 v25, s[20:23], s38 offen offset:0 lds
  v_mfma_f32_16x16x32_bf16 v[92:95], v[100:103], a[28:31], v[92:95]
  ds_read_b128 v[96:99], v0 offset:40960
  ds_read_b128 v[100:103], v1 offset:40960
  v_mfma_f32_16x16x32_bf16 v[80:83], v[104:107], a[32:35], v[80:83]
  v_mfma_f32_16x16x32_bf16 v[80:83], v[108:111], a[48:51], v[80:83]
  buffer_load_dwordx4 v26, s[20:23], s38 offen offset:1024 lds
  v_mfma_f32_16x16x32_bf16 v[84:87], v[104:107], a[36:39], v[84:87]
  v_mfma_f32_16x16x32_bf16 v[84:87], v[108:111], a[52:55], v[84:87]
  v_mfma_f32_16x16x32_bf16 v[88:91], v[104:107], a[40:43], v[88:91]
  buffer_load_dwordx4 v27, s[20:23], s38 offen offset:2048 lds
  v_mfma_f32_16x16x32_bf16 v[88:91], v[108:111], a[56:59], v[88:91]
  s_waitcnt lgkmcnt(2)
  v_mfma_f32_16x16x32_bf16 v[92:95], v[104:107], a[44:47], v[92:95]
  v_mfma_f32_16x16x32_bf16 v[92:95], v[108:111], a[60:63], v[92:95]
  buffer_load_dwordx4 v28, s[20:23], s38 offen offset:3072 lds
  v_mfma_f32_16x16x32_bf16 v[80:83], v[112:115], a[64:67], v[80:83]
  ds_read_b128 v[104:107], v2 offset:40960
  ds_read_b128 v[108:111], v3 offset:40960
  v_mfma_f32_16x16x32_bf16 v[80:83], v[116:119], a[80:83], v[80:83]
  v_mfma_f32_16x16x32_bf16 v[84:87], v[112:115], a[68:71], v[84:87]
  s_add_u32 s38, s38, 28672
  v_mfma_f32_16x16x32_bf16 v[84:87], v[116:119], a[84:87], v[84:87]
  v_mfma_f32_16x16x32_bf16 v[88:91], v[112:115], a[72:75], v[88:91]
  v_mfma_f32_16x16x32_bf16 v[88:91], v[116:119], a[88:91], v[88:91]
  s_add_u32 m0, s33, 102400
  v_mfma_f32_16x16x32_bf16 v[92:95], v[112:115], a[76:79], v[92:95]
  v_mfma_f32_16x16x32_bf16 v[92:95], v[116:119], a[92:95], v[92:95]
  ds_read_b128 v[112:115], v0 offset:41216
  ds_read_b128 v[116:119], v1 offset:41216
  v_mfma_f32_16x16x32_bf16 v[80:83], v[120:123], a[96:99], v[80:83]
  buffer_load_dwordx4 v25, s[20:23], s38 offen offset:0 lds
  v_mfma_f32_16x16x32_bf16 v[80:83], v[124:127], a[112:115], v[80:83]
  v_mfma_f32_16x16x32_bf16 v[84:87], v[120:123], a[100:103], v[84:87]
  v_mfma_f32_16x16x32_bf16 v[84:87], v[124:127], a[116:119], v[84:87]
  buffer_load_dwordx4 v26, s[20:23], s38 offen offset:1024 lds
  v_mfma_f32_16x16x32_bf16 v[88:91], v[120:123], a[104:107], v[88:91]
  v_mfma_f32_16x16x32_bf16 v[88:91], v[124:127], a[120:123], v[88:91]
  s_waitcnt lgkmcnt(2)
  v_mfma_f32_16x16x32_bf16 v[92:95], v[120:123], a[108:111], v[92:95]
  buffer_load_dwordx4 v27, s[20:23], s38 offen offset:2048 lds
  v_mfma_f32_16x16x32_bf16 v[92:95], v[124:127], a[124:127], v[92:95]
  v_exp_f32 v80, v80
  v_mfma_f32_16x16x32_bf16 v[48:51], v[96:99], a[0:3], v[32:35]
  ds_read_b128 v[120:123], v2 offset:41216
  ds_read_b128 v[124:127], v3 offset:41216
  v_mfma_f32_16x16x32_bf16 v[48:51], v[100:103], a[16:19], v[48:51]
  v_exp_f32 v81, v81
  v_mfma_f32_16x16x32_bf16 v[52:55], v[96:99], a[4:7], v[36:39]
  buffer_load_dwordx4 v28, s[20:23], s38 offen offset:3072 lds
  v_mfma_f32_16x16x32_bf16 v[52:55], v[100:103], a[20:23], v[52:55]
  v_add_f32 v16, v16, v80
  v_add_f32 v16, v16, v81
  v_mfma_f32_16x16x32_bf16 v[56:59], v[96:99], a[8:11], v[40:43]
  v_exp_f32 v82, v82
  v_mfma_f32_16x16x32_bf16 v[56:59], v[100:103], a[24:27], v[56:59]
  v_exp_f32 v83, v83
  v_mfma_f32_16x16x32_bf16 v[60:63], v[96:99], a[12:15], v[44:47]
  s_waitcnt vmcnt(25) lgkmcnt(0)
  s_barrier
  v_mfma_f32_16x16x32_bf16 v[60:63], v[100:103], a[28:31], v[60:63]
  v_add_f32 v16, v16, v82
  v_add_f32 v16, v16, v83
  v_mfma_f32_16x16x32_bf16 v[48:51], v[104:107], a[32:35], v[48:51]
  v_exp_f32 v84, v84
  v_mfma_f32_16x16x32_bf16 v[48:51], v[108:111], a[48:51], v[48:51]
  ds_read_b64_tr_b16 v[96:97], v4 offset:0
  ds_read_b64_tr_b16 v[98:99], v4 offset:8192
  v_mfma_f32_16x16x32_bf16 v[52:55], v[104:107], a[36:39], v[52:55]
  ds_read_b64_tr_b16 v[100:101], v5 offset:0
  ds_read_b64_tr_b16 v[102:103], v5 offset:8192
  v_exp_f32 v85, v85
  v_mfma_f32_16x16x32_bf16 v[52:55], v[108:111], a[52:55], v[52:55]
  s_movk_i32 s38, 256
  v_add_f32 v17, v17, v84
  v_mfma_f32_16x16x32_bf16 v[56:59], v[104:107], a[40:43], v[56:59]
  v_exp_f32 v86, v86
  v_mfma_f32_16x16x32_bf16 v[56:59], v[108:111], a[56:59], v[56:59]
  v_add_f32 v17, v17, v85
  v_lshrrev_b32 v29, 2, v24
  v_mfma_f32_16x16x32_bf16 v[60:63], v[104:107], a[44:47], v[60:63]
  v_exp_f32 v87, v87
  v_mfma_f32_16x16x32_bf16 v[60:63], v[108:111], a[60:63], v[60:63]
  s_add_u32 m0, s33, 32768
  v_add_f32 v17, v17, v86
  v_mfma_f32_16x16x32_bf16 v[48:51], v[112:115], a[64:67], v[48:51]
  v_lshlrev_b32 v30, 7, v29
  v_exp_f32 v88, v88
  v_mfma_f32_16x16x32_bf16 v[48:51], v[116:119], a[80:83], v[48:51]
  v_add_f32 v17, v17, v87
  v_cvt_pk_bf16_f32 v80, v80, v81
  v_mfma_f32_16x16x32_bf16 v[52:55], v[112:115], a[68:71], v[52:55]
  ds_read_b64_tr_b16 v[104:105], v6 offset:0
  ds_read_b64_tr_b16 v[106:107], v6 offset:8192
  ds_read_b64_tr_b16 v[108:109], v7 offset:0
  ds_read_b64_tr_b16 v[110:111], v7 offset:8192
  v_exp_f32 v89, v89
  v_mfma_f32_16x16x32_bf16 v[52:55], v[116:119], a[84:87], v[52:55]
  v_and_b32 v31, 1, v24
  v_add_f32 v18, v18, v88
  v_mfma_f32_16x16x32_bf16 v[56:59], v[112:115], a[72:75], v[56:59]
  buffer_load_dwordx4 v25, s[20:23], s38 offen offset:0 lds
  v_exp_f32 v90, v90
  v_mfma_f32_16x16x32_bf16 v[56:59], v[116:119], a[88:91], v[56:59]
  v_add_f32 v18, v18, v89
  v_cvt_pk_bf16_f32 v81, v82, v83
  v_mfma_f32_16x16x32_bf16 v[60:63], v[112:115], a[76:79], v[60:63]
  v_lshl_add_u32 v30, v31, 4, v30
  v_exp_f32 v91, v91
  v_mfma_f32_16x16x32_bf16 v[60:63], v[116:119], a[92:95], v[60:63]
  v_add_f32 v18, v18, v90
  v_bfe_u32 v31, v24, 1, 1
  v_mfma_f32_16x16x32_bf16 v[48:51], v[120:123], a[96:99], v[48:51]
  v_exp_f32 v92, v92
  v_mfma_f32_16x16x32_bf16 v[48:51], v[124:127], a[112:115], v[48:51]
  buffer_load_dwordx4 v26, s[20:23], s38 offen offset:1024 lds
  v_add_f32 v18, v18, v91
  v_cvt_pk_bf16_f32 v84, v84, v85
  v_mfma_f32_16x16x32_bf16 v[52:55], v[120:123], a[100:103], v[52:55]
  ds_read_b64_tr_b16 v[112:113], v8 offset:0
  ds_read_b64_tr_b16 v[114:115], v8 offset:8192
  ds_read_b64_tr_b16 v[116:117], v9 offset:0
  ds_read_b64_tr_b16 v[118:119], v9 offset:8192
  v_exp_f32 v93, v93
  v_mfma_f32_16x16x32_bf16 v[52:55], v[124:127], a[116:119], v[52:55]
  v_add_f32 v19, v19, v92
  v_lshl_add_u32 v30, v31, 3, v30
  v_mfma_f32_16x16x32_bf16 v[56:59], v[120:123], a[104:107], v[56:59]
  v_exp_f32 v94, v94
  v_mfma_f32_16x16x32_bf16 v[56:59], v[124:127], a[120:123], v[56:59]
  v_add_f32 v19, v19, v93
  v_cvt_pk_bf16_f32 v85, v86, v87
  v_mfma_f32_16x16x32_bf16 v[60:63], v[120:123], a[108:111], v[60:63]
  buffer_load_dwordx4 v27, s[20:23], s38 offen offset:2048 lds
  v_exp_f32 v95, v95
  v_mfma_f32_16x16x32_bf16 v[60:63], v[124:127], a[124:127], v[60:63]
  s_waitcnt lgkmcnt(4)
  v_add_u32 v30, 131072, v30
  v_add_f32 v19, v19, v94
  v_mfma_f32_16x16x32_bf16 v[128:131], v[96:99], v[64:67], v[128:131]
  v_exp_f32 v48, v48
  v_mfma_f32_16x16x32_bf16 v[132:135], v[96:99], v[68:71], v[132:135]
  v_add_f32 v19, v19, v95
  v_cvt_pk_bf16_f32 v88, v88, v89
  v_mfma_f32_16x16x32_bf16 a[128:131], v[96:99], v[72:75], a[128:131]
  ds_read_b64_tr_b16 v[120:121], v10 offset:0
  ds_read_b64_tr_b16 v[122:123], v10 offset:8192
  ds_read_b64_tr_b16 v[124:125], v11 offset:0
  ds_read_b64_tr_b16 v[126:127], v11 offset:8192
  v_bfe_u32 v31, v29, 1, 2
  v_mfma_f32_16x16x32_bf16 a[132:135], v[96:99], v[76:79], a[132:135]
  buffer_load_dwordx4 v28, s[20:23], s38 offen offset:3072 lds
  v_mfma_f32_16x16x32_bf16 v[136:139], v[100:103], v[64:67], v[136:139]
  v_exp_f32 v49, v49
  v_add_f32 v16, v16, v48
  v_mfma_f32_16x16x32_bf16 v[140:143], v[100:103], v[68:71], v[140:143]
  v_xor_b32 v29, 0, v31
  v_cvt_pk_bf16_f32 v89, v90, v91
  v_mfma_f32_16x16x32_bf16 a[136:139], v[100:103], v[72:75], a[136:139]
  ds_read_b64_tr_b16 v[96:97], v4 offset:256
  ds_read_b64_tr_b16 v[98:99], v4 offset:8448
  v_mfma_f32_16x16x32_bf16 a[140:143], v[100:103], v[76:79], a[140:143]
  v_lshl_add_u32 v0, v29, 5, v30
  v_exp_f32 v50, v50
  v_add_f32 v16, v16, v49
  v_mfma_f32_16x16x32_bf16 v[144:147], v[104:107], v[64:67], v[144:147]
  s_add_u32 s38, s38, 28672
  v_cvt_pk_bf16_f32 v92, v92, v93
  v_mfma_f32_16x16x32_bf16 v[148:151], v[104:107], v[68:71], v[148:151]
  ds_read_b64_tr_b16 v[100:101], v5 offset:256
  ds_read_b64_tr_b16 v[102:103], v5 offset:8448
  v_mfma_f32_16x16x32_bf16 a[144:147], v[104:107], v[72:75], a[144:147]
  v_xor_b32 v29, 1, v31
  v_exp_f32 v51, v51
  v_add_f32 v16, v16, v50
  v_mfma_f32_16x16x32_bf16 a[148:151], v[104:107], v[76:79], a[148:151]
  s_add_u32 m0, s33, 36864
  v_lshl_add_u32 v1, v29, 5, v30
  v_mfma_f32_16x16x32_bf16 v[152:155], v[108:111], v[64:67], v[152:155]
  v_exp_f32 v52, v52
  v_mfma_f32_16x16x32_bf16 v[156:159], v[108:111], v[68:71], v[156:159]
  v_add_f32 v16, v16, v51
  v_cvt_pk_bf16_f32 v93, v94, v95
  v_mfma_f32_16x16x32_bf16 a[152:155], v[108:111], v[72:75], a[152:155]
  ds_read_b64_tr_b16 v[104:105], v6 offset:256
  ds_read_b64_tr_b16 v[106:107], v6 offset:8448
  v_mfma_f32_16x16x32_bf16 a[156:159], v[108:111], v[76:79], a[156:159]
  s_waitcnt lgkmcnt(6)
  v_xor_b32 v29, 2, v31
  v_mfma_f32_16x16x32_bf16 v[160:163], v[112:115], v[64:67], v[160:163]
  v_exp_f32 v53, v53
  v_add_f32 v17, v17, v52
  v_mfma_f32_16x16x32_bf16 v[164:167], v[112:115], v[68:71], v[164:167]
  ds_read_b64_tr_b16 v[108:109], v7 offset:256
  ds_read_b64_tr_b16 v[110:111], v7 offset:8448
  v_mfma_f32_16x16x32_bf16 a[160:163], v[112:115], v[72:75], a[160:163]
  buffer_load_dwordx4 v25, s[20:23], s38 offen offset:0 lds
  v_mfma_f32_16x16x32_bf16 a[164:167], v[112:115], v[76:79], a[164:167]
  v_lshl_add_u32 v2, v29, 5, v30
  v_exp_f32 v54, v54
  v_add_f32 v17, v17, v53
  v_cvt_pk_bf16_f32 v82, v48, v49
  v_mfma_f32_16x16x32_bf16 v[168:171], v[116:119], v[64:67], v[168:171]
  ds_read_b64_tr_b16 v[112:113], v8 offset:256
  ds_read_b64_tr_b16 v[114:115], v8 offset:8448
  v_mfma_f32_16x16x32_bf16 v[172:175], v[116:119], v[68:71], v[172:175]
  v_xor_b32 v29, 3, v31
  v_add_f32 v17, v17, v54
  v_mfma_f32_16x16x32_bf16 a[168:171], v[116:119], v[72:75], a[168:171]
  v_exp_f32 v55, v55
  v_mfma_f32_16x16x32_bf16 a[172:175], v[116:119], v[76:79], a[172:175]
  buffer_load_dwordx4 v26, s[20:23], s38 offen offset:1024 lds
  v_mfma_f32_16x16x32_bf16 v[176:179], v[120:123], v[64:67], v[176:179]
  v_lshl_add_u32 v3, v29, 5, v30
  v_add_f32 v17, v17, v55
  v_mfma_f32_16x16x32_bf16 v[180:183], v[120:123], v[68:71], v[180:183]
  v_exp_f32 v56, v56
  v_cvt_pk_bf16_f32 v83, v50, v51
  v_mfma_f32_16x16x32_bf16 a[176:179], v[120:123], v[72:75], a[176:179]
  ds_read_b64_tr_b16 v[116:117], v9 offset:256
  ds_read_b64_tr_b16 v[118:119], v9 offset:8448
  v_mfma_f32_16x16x32_bf16 a[180:183], v[120:123], v[76:79], a[180:183]
  buffer_load_dwordx4 v27, s[20:23], s38 offen offset:2048 lds
  v_mfma_f32_16x16x32_bf16 v[184:187], v[124:127], v[64:67], v[184:187]
  v_exp_f32 v57, v57
  v_add_f32 v18, v18, v56
  v_mfma_f32_16x16x32_bf16 v[188:191], v[124:127], v[68:71], v[188:191]
  ds_read_b64_tr_b16 v[120:121], v10 offset:256
  ds_read_b64_tr_b16 v[122:123], v10 offset:8448
  v_mfma_f32_16x16x32_bf16 a[184:187], v[124:127], v[72:75], a[184:187]
  s_waitcnt lgkmcnt(6)
  v_add_f32 v18, v18, v57
  v_mfma_f32_16x16x32_bf16 a[188:191], v[124:127], v[76:79], a[188:191]
  v_exp_f32 v58, v58
  v_cvt_pk_bf16_f32 v86, v52, v53
  v_mfma_f32_16x16x32_bf16 v[192:195], v[96:99], v[64:67], v[192:195]
  buffer_load_dwordx4 v28, s[20:23], s38 offen offset:3072 lds
  v_mfma_f32_16x16x32_bf16 v[196:199], v[96:99], v[68:71], v[196:199]
  ds_read_b64_tr_b16 v[124:125], v11 offset:256
  ds_read_b64_tr_b16 v[126:127], v11 offset:8448
  v_mfma_f32_16x16x32_bf16 a[192:195], v[96:99], v[72:75], a[192:195]
  v_exp_f32 v59, v59
  v_add_f32 v18, v18, v58
  v_mfma_f32_16x16x32_bf16 a[196:199], v[96:99], v[76:79], a[196:199]
  v_exp_f32 v60, v60
  v_mfma_f32_16x16x32_bf16 v[200:203], v[100:103], v[64:67], v[200:203]
  v_add_f32 v18, v18, v59
  v_cvt_pk_bf16_f32 v87, v54, v55
  v_mfma_f32_16x16x32_bf16 v[204:207], v[100:103], v[68:71], v[204:207]
  v_subrev_u32 v4, 65536, v4
  v_subrev_u32 v5, 65536, v5
  v_mfma_f32_16x16x32_bf16 a[200:203], v[100:103], v[72:75], a[200:203]
  v_subrev_u32 v6, 65536, v6
  v_subrev_u32 v7, 65536, v7
  v_subrev_u32 v8, 65536, v8
  v_subrev_u32 v9, 65536, v9
  v_subrev_u32 v10, 65536, v10
  v_subrev_u32 v11, 65536, v11
  s_waitcnt vmcnt(24) lgkmcnt(0)
  s_barrier
  v_mfma_f32_16x16x32_bf16 a[204:207], v[100:103], v[76:79], a[204:207]
  v_exp_f32 v61, v61
  v_mfma_f32_16x16x32_bf16 v[208:211], v[104:107], v[64:67], v[208:211]
  ds_read_b64_tr_b16 a[0:1], v4 offset:0
  v_add_f32 v19, v19, v60
  v_mfma_f32_16x16x32_bf16 v[212:215], v[104:107], v[68:71], v[212:215]
  ds_read_b64_tr_b16 a[2:3], v4 offset:8192
  ds_read_b64_tr_b16 a[4:5], v5 offset:0
  v_mfma_f32_16x16x32_bf16 a[208:211], v[104:107], v[72:75], a[208:211]
  v_exp_f32 v62, v62
  v_mfma_f32_16x16x32_bf16 a[212:215], v[104:107], v[76:79], a[212:215]
  v_add_f32 v19, v19, v61
  v_cvt_pk_bf16_f32 v90, v56, v57
  v_mfma_f32_16x16x32_bf16 v[216:219], v[108:111], v[64:67], v[216:219]
  ds_read_b64_tr_b16 a[6:7], v5 offset:8192
  ds_read_b64_tr_b16 a[8:9], v6 offset:0
  v_mfma_f32_16x16x32_bf16 v[220:223], v[108:111], v[68:71], v[220:223]
  ds_read_b64_tr_b16 a[10:11], v6 offset:8192
  v_add_f32 v19, v19, v62
  v_mfma_f32_16x16x32_bf16 a[216:219], v[108:111], v[72:75], a[216:219]
  v_exp_f32 v63, v63
  v_mfma_f32_16x16x32_bf16 a[220:223], v[108:111], v[76:79], a[220:223]
  ds_read_b64_tr_b16 a[12:13], v7 offset:0
  ds_read_b64_tr_b16 a[14:15], v7 offset:8192
  v_mfma_f32_16x16x32_bf16 v[224:227], v[112:115], v[64:67], v[224:227]
  v_add_f32 v19, v19, v63
  v_cvt_pk_bf16_f32 v91, v58, v59
  v_mfma_f32_16x16x32_bf16 v[228:231], v[112:115], v[68:71], v[228:231]
  ds_read_b64_tr_b16 a[16:17], v8 offset:0
  ds_read_b64_tr_b16 a[18:19], v8 offset:8192
  v_mfma_f32_16x16x32_bf16 a[224:227], v[112:115], v[72:75], a[224:227]
  ds_read_b64_tr_b16 a[20:21], v9 offset:0
  v_cvt_pk_bf16_f32 v94, v60, v61
  v_mfma_f32_16x16x32_bf16 a[228:231], v[112:115], v[76:79], a[228:231]
  v_cvt_pk_bf16_f32 v95, v62, v63
  v_mfma_f32_16x16x32_bf16 v[232:235], v[116:119], v[64:67], v[232:235]
  ds_read_b64_tr_b16 a[22:23], v9 offset:8192
  v_mfma_f32_16x16x32_bf16 v[236:239], v[116:119], v[68:71], v[236:239]
  ds_read_b64_tr_b16 a[24:25], v10 offset:0
  v_mfma_f32_16x16x32_bf16 a[232:235], v[116:119], v[72:75], a[232:235]
  ds_read_b64_tr_b16 a[26:27], v10 offset:8192
  v_mfma_f32_16x16x32_bf16 a[236:239], v[116:119], v[76:79], a[236:239]
  ds_read_b64_tr_b16 a[28:29], v11 offset:0
  v_mfma_f32_16x16x32_bf16 v[240:243], v[120:123], v[64:67], v[240:243]
  ds_read_b64_tr_b16 a[30:31], v11 offset:8192
  v_mfma_f32_16x16x32_bf16 v[244:247], v[120:123], v[68:71], v[244:247]
  v_mfma_f32_16x16x32_bf16 a[240:243], v[120:123], v[72:75], a[240:243]
  v_mfma_f32_16x16x32_bf16 a[244:247], v[120:123], v[76:79], a[244:247]
  v_mfma_f32_16x16x32_bf16 v[248:251], v[124:127], v[64:67], v[248:251]
  v_mfma_f32_16x16x32_bf16 v[252:255], v[124:127], v[68:71], v[252:255]
  s_waitcnt lgkmcnt(0)
  v_mfma_f32_16x16x32_bf16 a[248:251], v[124:127], v[72:75], a[248:251]
  v_mfma_f32_16x16x32_bf16 a[252:255], v[124:127], v[76:79], a[252:255]
  v_mfma_f32_16x16x32_bf16 a[128:131], a[0:3], v[88:91], a[128:131]
  ds_read_b64_tr_b16 a[32:33], v4 offset:256
  ds_read_b64_tr_b16 a[34:35], v4 offset:8448
  v_mfma_f32_16x16x32_bf16 a[132:135], a[0:3], v[92:95], a[132:135]
  buffer_load_dword v12, v22, s[20:23], 0 offen
  v_mfma_f32_16x16x32_bf16 a[136:139], a[4:7], v[88:91], a[136:139]
  ds_read_b64_tr_b16 a[36:37], v5 offset:256
  ds_read_b64_tr_b16 a[38:39], v5 offset:8448
  v_mfma_f32_16x16x32_bf16 a[140:143], a[4:7], v[92:95], a[140:143]
  s_lshl_b32 s56, s32, 11
  ds_read_b64_tr_b16 a[40:41], v6 offset:256
  v_mfma_f32_16x16x32_bf16 a[144:147], a[8:11], v[88:91], a[144:147]
  ds_read_b64_tr_b16 a[42:43], v6 offset:8448
  s_add_u32 s56, s56, 65536
  v_mfma_f32_16x16x32_bf16 a[148:151], a[8:11], v[92:95], a[148:151]
  ds_read_b64_tr_b16 a[44:45], v7 offset:256
  ds_read_b64_tr_b16 a[46:47], v7 offset:8448
  v_add_u32 v29, s56, v20
  v_mfma_f32_16x16x32_bf16 a[152:155], a[12:15], v[88:91], a[152:155]
  ds_read_b64_tr_b16 a[48:49], v8 offset:256
  ds_read_b64_tr_b16 a[50:51], v8 offset:8448
  buffer_load_dword v12, v21, s[8:11], 0 offen
  v_xor_b32 v30, 4096, v29
  v_mfma_f32_16x16x32_bf16 a[156:159], a[12:15], v[92:95], a[156:159]
  ds_read_b64_tr_b16 a[52:53], v9 offset:256
  ds_read_b64_tr_b16 a[54:55], v9 offset:8448
  v_add_u32 v31, 65536, v20
  v_mfma_f32_16x16x32_bf16 a[160:163], a[16:19], v[88:91], a[160:163]
  ds_read_b64_tr_b16 a[56:57], v10 offset:256
  ds_read_b64_tr_b16 a[58:59], v10 offset:8448
  v_mov_b32 v33, v36
  v_mov_b32 v34, v40
  v_mov_b32 v35, v44
  v_mfma_f32_16x16x32_bf16 a[164:167], a[16:19], v[92:95], a[164:167]
  ds_read_b64_tr_b16 a[60:61], v11 offset:256
  ds_read_b64_tr_b16 a[62:63], v11 offset:8448
  v_mfma_f32_16x16x32_bf16 a[168:171], a[20:23], v[88:91], a[168:171]
  buffer_load_dword v12, v21, s[40:43], 0 offen
  ds_write_b128 v29, v[32:35] offset:1024
  v_mfma_f32_16x16x32_bf16 a[172:175], a[20:23], v[92:95], a[172:175]
  v_mov_b32 v48, v16
  v_mov_b32 v49, v17
  v_mfma_f32_16x16x32_bf16 a[176:179], a[24:27], v[88:91], a[176:179]
  v_mov_b32 v50, v18
  v_mov_b32 v51, v19
  v_permlane16_swap_b32 v16, v48
  v_permlane16_swap_b32 v17, v49
  v_permlane16_swap_b32 v18, v50
  v_permlane16_swap_b32 v19, v51
  v_add_f32 v16, v16, v48
  v_add_f32 v17, v17, v49
  v_add_f32 v18, v18, v50
  v_add_f32 v19, v19, v51
  v_mov_b32 v48, v16
  v_mov_b32 v49, v17
  v_mov_b32 v50, v18
  v_mov_b32 v51, v19
  v_permlane32_swap_b32 v16, v48
  v_permlane32_swap_b32 v17, v49
  v_permlane32_swap_b32 v18, v50
  v_permlane32_swap_b32 v19, v51
  v_add_f32 v16, v16, v48
  v_add_f32 v17, v17, v49
  v_add_f32 v18, v18, v50
  v_add_f32 v19, v19, v51
  v_mfma_f32_16x16x32_bf16 a[180:183], a[24:27], v[92:95], a[180:183]
  ds_write_b128 v29, v[16:19]
  v_mov_b32 v52, 0x39800000
  v_mfma_f32_16x16x32_bf16 a[184:187], a[28:31], v[88:91], a[184:187]
  buffer_load_dword v12, v22, s[44:47], 0 offen
  v_mfma_f32_16x16x32_bf16 a[188:191], a[28:31], v[92:95], a[188:191]
  s_waitcnt lgkmcnt(2)
  s_waitcnt lgkmcnt(0)
  s_barrier
  v_mfma_f32_16x16x32_bf16 a[192:195], a[32:35], v[88:91], a[192:195]
  ds_read_b128 v[56:59], v30
  ds_read_b128 v[36:39], v30 offset:1024
  v_mfma_f32_16x16x32_bf16 a[196:199], a[32:35], v[92:95], a[196:199]
  ds_read_b128 v[64:67], v31 offset:0
  ds_read_b128 v[68:71], v31 offset:2048
  v_mfma_f32_16x16x32_bf16 a[200:203], a[36:39], v[88:91], a[200:203]
  ds_read_b128 v[72:75], v31 offset:4096
  ds_read_b128 v[76:79], v31 offset:6144
  v_mfma_f32_16x16x32_bf16 a[204:207], a[36:39], v[92:95], a[204:207]
  v_mfma_f32_16x16x32_bf16 a[208:211], a[40:43], v[88:91], a[208:211]
  v_bfe_u32 v23, v24, 3, 1
  v_mul_u32_u24 v23, 114688, v23
  v_mfma_f32_16x16x32_bf16 a[212:215], a[40:43], v[92:95], a[212:215]
  v_lshrrev_b32 v21, 4, v24
  v_lshl_add_u32 v23, v21, 7, v23
  v_mfma_f32_16x16x32_bf16 a[216:219], a[44:47], v[88:91], a[216:219]
  v_and_b32 v21, 7, v24
  v_lshl_add_u32 v23, v21, 4, v23
  v_mfma_f32_16x16x32_bf16 a[220:223], a[44:47], v[92:95], a[220:223]
  s_lshl_b32 s56, s52, 14
  s_lshl_b32 s57, s53, 16
  v_mfma_f32_16x16x32_bf16 a[224:227], a[48:51], v[88:91], a[224:227]
  s_waitcnt lgkmcnt(4)
  v_min_f32 v48, v32, v38
  v_sub_f32 v40, v48, v32
  v_mfma_f32_16x16x32_bf16 a[228:231], a[48:51], v[92:95], a[228:231]
  s_add_u32 s56, s56, s57
  v_add_u32 v29, s56, v20
  v_mfma_f32_16x16x32_bf16 a[232:235], a[52:55], v[88:91], a[232:235]
  v_xor_b32 v30, 65536, v29
  v_sub_f32 v42, v48, v38
  v_mfma_f32_16x16x32_bf16 a[236:239], a[52:55], v[92:95], a[236:239]
  s_waitcnt vmcnt(20) lgkmcnt(0)
  s_barrier
  v_mfma_f32_16x16x32_bf16 a[240:243], a[56:59], v[88:91], a[240:243]
  v_exp_f32 v40, v40
  v_mfma_f32_16x16x32_bf16 a[244:247], a[56:59], v[92:95], a[244:247]
  v_exp_f32 v42, v42
  v_mfma_f32_16x16x32_bf16 a[248:251], a[60:63], v[88:91], a[248:251]
  ds_read_b64_tr_b16 a[64:65], v0 offset:0
  ds_read_b64_tr_b16 a[66:67], v0 offset:2048
  v_min_f32 v49, v33, v39
  v_mfma_f32_16x16x32_bf16 a[252:255], a[60:63], v[92:95], a[252:255]
  ds_read_b64_tr_b16 a[68:69], v0 offset:4096
  v_sub_f32 v44, v49, v33
  v_mfma_f32_16x16x32_bf16 v[128:131], a[0:3], v[80:83], v[128:131]
  ds_write_b128 v29, a[128:131] offset:0
  ds_read_b64_tr_b16 a[70:71], v0 offset:6144
  v_sub_f32 v46, v49, v39
  v_mfma_f32_16x16x32_bf16 v[132:135], a[0:3], v[84:87], v[132:135]
  ds_read_b64_tr_b16 a[72:73], v1 offset:0
  v_exp_f32 v44, v44
  v_mfma_f32_16x16x32_bf16 v[136:139], a[4:7], v[80:83], v[136:139]
  ds_read_b64_tr_b16 a[74:75], v1 offset:2048
  v_exp_f32 v46, v46
  v_mfma_f32_16x16x32_bf16 v[140:143], a[4:7], v[84:87], v[140:143]
  ds_write_b128 v29, a[132:135] offset:1024
  ds_read_b64_tr_b16 a[76:77], v1 offset:4096
  v_mul_f32 v16, v16, v40
  v_fmac_f32 v16, v58, v42
  v_mfma_f32_16x16x32_bf16 v[144:147], a[8:11], v[80:83], v[144:147]
  ds_read_b64_tr_b16 a[78:79], v1 offset:6144
  v_mul_f32 v17, v17, v44
  v_mfma_f32_16x16x32_bf16 v[148:151], a[8:11], v[84:87], v[148:151]
  ds_read_b64_tr_b16 a[80:81], v2 offset:0
  v_fmac_f32 v17, v59, v46
  v_mfma_f32_16x16x32_bf16 v[152:155], a[12:15], v[80:83], v[152:155]
  ds_read_b64_tr_b16 a[82:83], v2 offset:2048
  v_rcp_f32 v16, v16
  v_mfma_f32_16x16x32_bf16 v[156:159], a[12:15], v[84:87], v[156:159]
  ds_write_b128 v29, a[136:139] offset:2048
  ds_read_b64_tr_b16 a[84:85], v2 offset:4096
  v_rcp_f32 v17, v17
  v_mfma_f32_16x16x32_bf16 v[160:163], a[16:19], v[80:83], v[160:163]
  ds_read_b64_tr_b16 a[86:87], v2 offset:6144
  v_add_f32 v64, v64, v65
  v_mfma_f32_16x16x32_bf16 v[164:167], a[16:19], v[84:87], v[164:167]
  ds_read_b64_tr_b16 a[88:89], v3 offset:0
  v_add_f32 v64, v64, v66
  v_mfma_f32_16x16x32_bf16 v[168:171], a[20:23], v[80:83], v[168:171]
  ds_read_b64_tr_b16 a[90:91], v3 offset:2048
  v_add_f32 v64, v64, v67
  v_mfma_f32_16x16x32_bf16 v[172:175], a[20:23], v[84:87], v[172:175]
  ds_write_b128 v29, a[140:143] offset:3072
  ds_read_b64_tr_b16 a[92:93], v3 offset:4096
  v_add_f32 v64, v64, v68
  v_mfma_f32_16x16x32_bf16 v[176:179], a[24:27], v[80:83], v[176:179]
  ds_read_b64_tr_b16 a[94:95], v3 offset:6144
  v_add_f32 v64, v64, v69
  v_add_f32 v64, v64, v70
  v_mfma_f32_16x16x32_bf16 v[180:183], a[24:27], v[84:87], v[180:183]
  ds_read_b64_tr_b16 a[96:97], v0 offset:8192
  ds_read_b64_tr_b16 a[98:99], v0 offset:10240
  v_add_f32 v64, v64, v71
  v_mfma_f32_16x16x32_bf16 v[184:187], a[28:31], v[80:83], v[184:187]
  ds_read_b64_tr_b16 a[100:101], v0 offset:12288
  v_add_f32 v64, v64, v72
  v_mfma_f32_16x16x32_bf16 v[188:191], a[28:31], v[84:87], v[188:191]
  ds_write_b128 v29, a[144:147] offset:4096
  ds_read_b64_tr_b16 a[102:103], v0 offset:14336
  v_add_f32 v64, v64, v73
  v_mfma_f32_16x16x32_bf16 v[192:195], a[32:35], v[80:83], v[192:195]
  ds_read_b64_tr_b16 a[104:105], v1 offset:8192
  v_add_f32 v64, v64, v74
  v_mfma_f32_16x16x32_bf16 v[196:199], a[32:35], v[84:87], v[196:199]
  ds_read_b64_tr_b16 a[106:107], v1 offset:10240
  v_add_f32 v64, v64, v75
  v_mfma_f32_16x16x32_bf16 v[200:203], a[36:39], v[80:83], v[200:203]
  ds_write_b128 v29, a[148:151] offset:5120
  ds_read_b64_tr_b16 a[108:109], v1 offset:12288
  v_add_f32 v64, v64, v76
  v_mfma_f32_16x16x32_bf16 v[204:207], a[36:39], v[84:87], v[204:207]
  ds_read_b64_tr_b16 a[110:111], v1 offset:14336
  v_add_f32 v64, v64, v77
  v_mfma_f32_16x16x32_bf16 v[208:211], a[40:43], v[80:83], v[208:211]
  ds_read_b64_tr_b16 a[112:113], v2 offset:8192
  v_add_f32 v64, v64, v78
  v_mfma_f32_16x16x32_bf16 v[212:215], a[40:43], v[84:87], v[212:215]
  ds_read_b64_tr_b16 a[114:115], v2 offset:10240
  v_add_f32 v64, v64, v79
  v_cmp_nlt_f32 vcc, v64, v52
  v_mfma_f32_16x16x32_bf16 v[216:219], a[44:47], v[80:83], v[216:219]
  ds_write_b128 v29, a[152:155] offset:6144
  ds_read_b64_tr_b16 a[116:117], v2 offset:12288
  v_mul_f32 v40, v40, v16
  v_mfma_f32_16x16x32_bf16 v[220:223], a[44:47], v[84:87], v[220:223]
  ds_read_b64_tr_b16 a[118:119], v2 offset:14336
  v_mul_f32 v42, v42, v16
  v_mfma_f32_16x16x32_bf16 v[224:227], a[48:51], v[80:83], v[224:227]
  ds_read_b64_tr_b16 a[120:121], v3 offset:8192
  v_mov_b32 v41, v40
  v_mfma_f32_16x16x32_bf16 v[228:231], a[48:51], v[84:87], v[228:231]
  ds_read_b64_tr_b16 a[122:123], v3 offset:10240
  v_mov_b32 v43, v42
  v_mfma_f32_16x16x32_bf16 v[232:235], a[52:55], v[80:83], v[232:235]
  ds_write_b128 v29, a[156:159] offset:7168
  ds_read_b64_tr_b16 a[124:125], v3 offset:12288
  v_mul_f32 v44, v44, v17
  v_mfma_f32_16x16x32_bf16 v[236:239], a[52:55], v[84:87], v[236:239]
  ds_read_b64_tr_b16 a[126:127], v3 offset:14336
  v_mul_f32 v46, v46, v17
  v_mfma_f32_16x16x32_bf16 v[240:243], a[56:59], v[80:83], v[240:243]
  v_mov_b32 v45, v44
  v_mov_b32 v47, v46
  v_mfma_f32_16x16x32_bf16 v[244:247], a[56:59], v[84:87], v[244:247]
  v_mfma_f32_16x16x32_bf16 v[248:251], a[60:63], v[80:83], v[248:251]
  v_mfma_f32_16x16x32_bf16 v[252:255], a[60:63], v[84:87], v[252:255]
  s_waitcnt lgkmcnt(0)
  s_barrier
  s_cmp_lg_u32 s37, 0
  s_cbranch_scc1 L_k2_ok
  s_cbranch_vccnz L_k2_fallback
L_k2_ok:
  ds_read_b128 v[96:99], v30 offset:0
  ds_read_b128 v[100:103], v30 offset:1024
  ds_read_b128 v[104:107], v30 offset:2048
  ds_read_b128 v[108:111], v30 offset:3072
  ds_read_b128 v[112:115], v30 offset:4096
  ds_read_b128 v[116:119], v30 offset:5120
  ds_read_b128 v[120:123], v30 offset:6144
  ds_read_b128 v[124:127], v30 offset:7168
  ds_write_b128 v29, a[160:163] offset:8192
  ds_write_b128 v29, a[164:167] offset:9216
  v_pk_mul_f32 v[128:129], v[128:129], v[40:41]
  v_pk_mul_f32 v[130:131], v[130:131], v[40:41]
  s_waitcnt lgkmcnt(9)
  v_pk_fma_f32 v[128:129], v[96:97], v[42:43], v[128:129]
  v_pk_fma_f32 v[130:131], v[98:99], v[42:43], v[130:131]
  v_cvt_pk_bf16_f32 v128, v128, v129
  v_cvt_pk_bf16_f32 v129, v130, v131
  v_pk_mul_f32 v[136:137], v[136:137], v[40:41]
  ds_write_b128 v29, a[168:171] offset:10240
  v_pk_mul_f32 v[138:139], v[138:139], v[40:41]
  s_waitcnt lgkmcnt(8)
  v_pk_fma_f32 v[136:137], v[104:105], v[42:43], v[136:137]
  v_pk_fma_f32 v[138:139], v[106:107], v[42:43], v[138:139]
  v_cvt_pk_bf16_f32 v130, v136, v137
  v_cvt_pk_bf16_f32 v131, v138, v139
  v_pk_mul_f32 v[132:133], v[132:133], v[44:45]
  v_pk_mul_f32 v[134:135], v[134:135], v[44:45]
  ds_write_b128 v29, a[172:175] offset:11264
  v_pk_fma_f32 v[132:133], v[100:101], v[46:47], v[132:133]
  v_pk_fma_f32 v[134:135], v[102:103], v[46:47], v[134:135]
  v_cvt_pk_bf16_f32 v132, v132, v133
  v_cvt_pk_bf16_f32 v133, v134, v135
  v_pk_mul_f32 v[140:141], v[140:141], v[44:45]
  v_pk_mul_f32 v[142:143], v[142:143], v[44:45]
  s_waitcnt lgkmcnt(8)
  v_pk_fma_f32 v[140:141], v[108:109], v[46:47], v[140:141]
  ds_write_b128 v29, a[176:179] offset:12288
  v_pk_fma_f32 v[142:143], v[110:111], v[46:47], v[142:143]
  v_cvt_pk_bf16_f32 v134, v140, v141
  v_cvt_pk_bf16_f32 v135, v142, v143
  v_pk_mul_f32 v[144:145], v[144:145], v[40:41]
  v_pk_mul_f32 v[146:147], v[146:147], v[40:41]
  s_waitcnt lgkmcnt(8)
  v_pk_fma_f32 v[144:145], v[112:113], v[42:43], v[144:145]
  v_pk_fma_f32 v[146:147], v[114:115], v[42:43], v[146:147]
  ds_write_b128 v29, a[180:183] offset:13312
  v_cvt_pk_bf16_f32 v144, v144, v145
  v_cvt_pk_bf16_f32 v145, v146, v147
  v_pk_mul_f32 v[152:153], v[152:153], v[40:41]
  v_pk_mul_f32 v[154:155], v[154:155], v[40:41]
  s_waitcnt lgkmcnt(7)
  v_pk_fma_f32 v[152:153], v[120:121], v[42:43], v[152:153]
  v_pk_fma_f32 v[154:155], v[122:123], v[42:43], v[154:155]
  v_cvt_pk_bf16_f32 v146, v152, v153
  ds_write_b128 v29, a[184:187] offset:14336
  v_cvt_pk_bf16_f32 v147, v154, v155
  v_pk_mul_f32 v[148:149], v[148:149], v[44:45]
  v_pk_mul_f32 v[150:151], v[150:151], v[44:45]
  v_pk_fma_f32 v[148:149], v[116:117], v[46:47], v[148:149]
  v_pk_fma_f32 v[150:151], v[118:119], v[46:47], v[150:151]
  v_cvt_pk_bf16_f32 v148, v148, v149
  v_cvt_pk_bf16_f32 v149, v150, v151
  ds_write_b128 v29, a[188:191] offset:15360
  v_pk_mul_f32 v[156:157], v[156:157], v[44:45]
  v_pk_mul_f32 v[158:159], v[158:159], v[44:45]
  s_waitcnt lgkmcnt(8)
  v_pk_fma_f32 v[156:157], v[124:125], v[46:47], v[156:157]
  v_pk_fma_f32 v[158:159], v[126:127], v[46:47], v[158:159]
  v_cvt_pk_bf16_f32 v150, v156, v157
  v_cvt_pk_bf16_f32 v151, v158, v159
  s_waitcnt lgkmcnt(0)
  s_barrier
  ds_read_b128 v[64:67], v30 offset:8192
  ds_read_b128 v[68:71], v30 offset:9216
  ds_read_b128 v[72:75], v30 offset:10240
  ds_read_b128 v[76:79], v30 offset:11264
  ds_read_b128 v[80:83], v30 offset:12288
  ds_read_b128 v[84:87], v30 offset:13312
  ds_read_b128 v[88:91], v30 offset:14336
  ds_read_b128 v[92:95], v30 offset:15360
  ds_write_b128 v29, a[192:195] offset:0
  ds_write_b128 v29, a[196:199] offset:1024
  v_pk_mul_f32 v[160:161], v[160:161], v[40:41]
  v_pk_mul_f32 v[162:163], v[162:163], v[40:41]
  s_waitcnt lgkmcnt(9)
  v_pk_fma_f32 v[160:161], v[64:65], v[42:43], v[160:161]
  v_pk_fma_f32 v[162:163], v[66:67], v[42:43], v[162:163]
  v_cvt_pk_bf16_f32 v160, v160, v161
  v_cvt_pk_bf16_f32 v161, v162, v163
  v_pk_mul_f32 v[168:169], v[168:169], v[40:41]
  ds_write_b128 v29, a[200:203] offset:2048
  v_pk_mul_f32 v[170:171], v[170:171], v[40:41]
  s_waitcnt lgkmcnt(8)
  v_pk_fma_f32 v[168:169], v[72:73], v[42:43], v[168:169]
  v_pk_fma_f32 v[170:171], v[74:75], v[42:43], v[170:171]
  v_cvt_pk_bf16_f32 v162, v168, v169
  v_cvt_pk_bf16_f32 v163, v170, v171
  v_pk_mul_f32 v[164:165], v[164:165], v[44:45]
  v_pk_mul_f32 v[166:167], v[166:167], v[44:45]
  ds_write_b128 v29, a[204:207] offset:3072
  v_pk_fma_f32 v[164:165], v[68:69], v[46:47], v[164:165]
  v_pk_fma_f32 v[166:167], v[70:71], v[46:47], v[166:167]
  v_cvt_pk_bf16_f32 v164, v164, v165
  v_cvt_pk_bf16_f32 v165, v166, v167
  v_pk_mul_f32 v[172:173], v[172:173], v[44:45]
  v_pk_mul_f32 v[174:175], v[174:175], v[44:45]
  s_waitcnt lgkmcnt(8)
  v_pk_fma_f32 v[172:173], v[76:77], v[46:47], v[172:173]
  ds_write_b128 v29, a[208:211] offset:4096
  v_pk_fma_f32 v[174:175], v[78:79], v[46:47], v[174:175]
  v_cvt_pk_bf16_f32 v166, v172, v173
  v_cvt_pk_bf16_f32 v167, v174, v175
  v_pk_mul_f32 v[176:177], v[176:177], v[40:41]
  v_pk_mul_f32 v[178:179], v[178:179], v[40:41]
  s_waitcnt lgkmcnt(8)
  v_pk_fma_f32 v[176:177], v[80:81], v[42:43], v[176:177]
  v_pk_fma_f32 v[178:179], v[82:83], v[42:43], v[178:179]
  ds_write_b128 v29, a[212:215] offset:5120
  v_cvt_pk_bf16_f32 v176, v176, v177
  v_cvt_pk_bf16_f32 v177, v178, v179
  v_pk_mul_f32 v[184:185], v[184:185], v[40:41]
  v_pk_mul_f32 v[186:187], v[186:187], v[40:41]
  s_waitcnt lgkmcnt(7)
  v_pk_fma_f32 v[184:185], v[88:89], v[42:43], v[184:185]
  v_pk_fma_f32 v[186:187], v[90:91], v[42:43], v[186:187]
  v_cvt_pk_bf16_f32 v178, v184, v185
  ds_write_b128 v29, a[216:219] offset:6144
  v_cvt_pk_bf16_f32 v179, v186, v187
  v_pk_mul_f32 v[180:181], v[180:181], v[44:45]
  v_pk_mul_f32 v[182:183], v[182:183], v[44:45]
  v_pk_fma_f32 v[180:181], v[84:85], v[46:47], v[180:181]
  v_pk_fma_f32 v[182:183], v[86:87], v[46:47], v[182:183]
  v_cvt_pk_bf16_f32 v180, v180, v181
  v_cvt_pk_bf16_f32 v181, v182, v183
  ds_write_b128 v29, a[220:223] offset:7168
  v_pk_mul_f32 v[188:189], v[188:189], v[44:45]
  v_pk_mul_f32 v[190:191], v[190:191], v[44:45]
  s_waitcnt lgkmcnt(8)
  v_pk_fma_f32 v[188:189], v[92:93], v[46:47], v[188:189]
  v_pk_fma_f32 v[190:191], v[94:95], v[46:47], v[190:191]
  v_cvt_pk_bf16_f32 v182, v188, v189
  v_cvt_pk_bf16_f32 v183, v190, v191
  s_load_dwordx4 s[4:7], s[0:1], 48
  s_load_dwordx2 s[28:29], s[0:1], 64
  s_load_dwordx2 s[18:19], s[0:1], 0
  s_waitcnt lgkmcnt(0)
  s_barrier
  ds_read_b128 v[96:99], v30 offset:0
  ds_read_b128 v[100:103], v30 offset:1024
  ds_read_b128 v[104:107], v30 offset:2048
  ds_read_b128 v[108:111], v30 offset:3072
  ds_read_b128 v[112:115], v30 offset:4096
  ds_read_b128 v[116:119], v30 offset:5120
  ds_read_b128 v[120:123], v30 offset:6144
  ds_read_b128 v[124:127], v30 offset:7168
  ds_write_b128 v29, a[224:227] offset:8192
  ds_write_b128 v29, a[228:231] offset:9216
  v_pk_mul_f32 v[192:193], v[192:193], v[40:41]
  v_pk_mul_f32 v[194:195], v[194:195], v[40:41]
  s_waitcnt lgkmcnt(9)
  v_pk_fma_f32 v[192:193], v[96:97], v[42:43], v[192:193]
  v_pk_fma_f32 v[194:195], v[98:99], v[42:43], v[194:195]
  v_cvt_pk_bf16_f32 v192, v192, v193
  v_cvt_pk_bf16_f32 v193, v194, v195
  v_pk_mul_f32 v[200:201], v[200:201], v[40:41]
  ds_write_b128 v29, a[232:235] offset:10240
  v_pk_mul_f32 v[202:203], v[202:203], v[40:41]
  s_waitcnt lgkmcnt(8)
  v_pk_fma_f32 v[200:201], v[104:105], v[42:43], v[200:201]
  v_pk_fma_f32 v[202:203], v[106:107], v[42:43], v[202:203]
  v_cvt_pk_bf16_f32 v194, v200, v201
  v_cvt_pk_bf16_f32 v195, v202, v203
  v_pk_mul_f32 v[196:197], v[196:197], v[44:45]
  v_pk_mul_f32 v[198:199], v[198:199], v[44:45]
  ds_write_b128 v29, a[236:239] offset:11264
  v_pk_fma_f32 v[196:197], v[100:101], v[46:47], v[196:197]
  v_pk_fma_f32 v[198:199], v[102:103], v[46:47], v[198:199]
  v_cvt_pk_bf16_f32 v196, v196, v197
  v_cvt_pk_bf16_f32 v197, v198, v199
  v_pk_mul_f32 v[204:205], v[204:205], v[44:45]
  v_pk_mul_f32 v[206:207], v[206:207], v[44:45]
  s_waitcnt lgkmcnt(8)
  v_pk_fma_f32 v[204:205], v[108:109], v[46:47], v[204:205]
  ds_write_b128 v29, a[240:243] offset:12288
  v_pk_fma_f32 v[206:207], v[110:111], v[46:47], v[206:207]
  v_cvt_pk_bf16_f32 v198, v204, v205
  v_cvt_pk_bf16_f32 v199, v206, v207
  v_pk_mul_f32 v[208:209], v[208:209], v[40:41]
  v_pk_mul_f32 v[210:211], v[210:211], v[40:41]
  s_waitcnt lgkmcnt(8)
  v_pk_fma_f32 v[208:209], v[112:113], v[42:43], v[208:209]
  v_pk_fma_f32 v[210:211], v[114:115], v[42:43], v[210:211]
  ds_write_b128 v29, a[244:247] offset:13312
  v_cvt_pk_bf16_f32 v208, v208, v209
  v_cvt_pk_bf16_f32 v209, v210, v211
  v_pk_mul_f32 v[216:217], v[216:217], v[40:41]
  v_pk_mul_f32 v[218:219], v[218:219], v[40:41]
  s_waitcnt lgkmcnt(7)
  v_pk_fma_f32 v[216:217], v[120:121], v[42:43], v[216:217]
  v_pk_fma_f32 v[218:219], v[122:123], v[42:43], v[218:219]
  v_cvt_pk_bf16_f32 v210, v216, v217
  ds_write_b128 v29, a[248:251] offset:14336
  v_cvt_pk_bf16_f32 v211, v218, v219
  v_pk_mul_f32 v[212:213], v[212:213], v[44:45]
  v_pk_mul_f32 v[214:215], v[214:215], v[44:45]
  v_pk_fma_f32 v[212:213], v[116:117], v[46:47], v[212:213]
  v_pk_fma_f32 v[214:215], v[118:119], v[46:47], v[214:215]
  v_cvt_pk_bf16_f32 v212, v212, v213
  v_cvt_pk_bf16_f32 v213, v214, v215
  ds_write_b128 v29, a[252:255] offset:15360
  v_pk_mul_f32 v[220:221], v[220:221], v[44:45]
  v_pk_mul_f32 v[222:223], v[222:223], v[44:45]
  s_waitcnt lgkmcnt(8)
  v_pk_fma_f32 v[220:221], v[124:125], v[46:47], v[220:221]
  v_pk_fma_f32 v[222:223], v[126:127], v[46:47], v[222:223]
  v_cvt_pk_bf16_f32 v214, v220, v221
  v_cvt_pk_bf16_f32 v215, v222, v223
  s_waitcnt lgkmcnt(0)
  s_barrier
  ds_read_b128 v[64:67], v30 offset:8192
  ds_read_b128 v[68:71], v30 offset:9216
  ds_read_b128 v[72:75], v30 offset:10240
  ds_read_b128 v[76:79], v30 offset:11264
  ds_read_b128 v[80:83], v30 offset:12288
  ds_read_b128 v[84:87], v30 offset:13312
  ds_read_b128 v[88:91], v30 offset:14336
  ds_read_b128 v[92:95], v30 offset:15360
  v_mfma_f32_16x16x32_bf16 v[96:99], a[64:67], v[128:131], 0
  v_mfma_f32_16x16x32_bf16 v[96:99], a[68:71], v[144:147], v[96:99]
  v_mfma_f32_16x16x32_bf16 v[100:103], a[64:67], v[132:135], 0
  v_mul_f32 v224, v224, v40
  v_mul_f32 v225, v225, v40
  v_mfma_f32_16x16x32_bf16 v[100:103], a[68:71], v[148:151], v[100:103]
  v_mul_f32 v226, v226, v40
  v_mul_f32 v227, v227, v40
  v_mfma_f32_16x16x32_bf16 v[104:107], a[72:75], v[128:131], 0
  s_waitcnt lgkmcnt(7)
  v_fmac_f32 v224, v64, v42
  v_fmac_f32 v225, v65, v42
  v_mfma_f32_16x16x32_bf16 v[104:107], a[76:79], v[144:147], v[104:107]
  v_fmac_f32 v226, v66, v42
  v_fmac_f32 v227, v67, v42
  v_mfma_f32_16x16x32_bf16 v[108:111], a[72:75], v[132:135], 0
  s_waitcnt lgkmcnt(0)
  s_barrier
  v_mfma_f32_16x16x32_bf16 v[108:111], a[76:79], v[148:151], v[108:111]
  s_movk_i32 s38, 384
  s_add_u32 m0, s33, 0
  s_nop 0
  buffer_load_dwordx4 v25, s[20:23], s38 offen offset:0 lds
  v_mfma_f32_16x16x32_bf16 v[112:115], a[80:83], v[128:131], 0
  ds_read_b64_tr_b16 a[64:65], v0 offset:16384
  ds_read_b64_tr_b16 a[66:67], v0 offset:18432
  v_mfma_f32_16x16x32_bf16 v[112:115], a[84:87], v[144:147], v[112:115]
  ds_read_b64_tr_b16 a[68:69], v0 offset:20480
  ds_read_b64_tr_b16 a[70:71], v0 offset:22528
  v_mfma_f32_16x16x32_bf16 v[116:119], a[80:83], v[132:135], 0
  ds_read_b64_tr_b16 a[72:73], v1 offset:16384
  ds_read_b64_tr_b16 a[74:75], v1 offset:18432
  ds_read_b64_tr_b16 a[76:77], v1 offset:20480
  ds_read_b64_tr_b16 a[78:79], v1 offset:22528
  v_mfma_f32_16x16x32_bf16 v[116:119], a[84:87], v[148:151], v[116:119]
  buffer_load_dwordx4 v26, s[20:23], s38 offen offset:1024 lds
  v_mfma_f32_16x16x32_bf16 v[120:123], a[88:91], v[128:131], 0
  ds_read_b64_tr_b16 a[80:81], v2 offset:16384
  ds_read_b64_tr_b16 a[82:83], v2 offset:18432
  v_mfma_f32_16x16x32_bf16 v[120:123], a[92:95], v[144:147], v[120:123]
  ds_read_b64_tr_b16 a[84:85], v2 offset:20480
  ds_read_b64_tr_b16 a[86:87], v2 offset:22528
  v_mfma_f32_16x16x32_bf16 v[124:127], a[88:91], v[132:135], 0
  v_cvt_pk_bf16_f32 v224, v224, v225
  v_cvt_pk_bf16_f32 v225, v226, v227
  v_mfma_f32_16x16x32_bf16 v[124:127], a[92:95], v[148:151], v[124:127]
  buffer_load_dwordx4 v27, s[20:23], s38 offen offset:2048 lds
  v_mfma_f32_16x16x32_bf16 v[96:99], a[96:99], v[160:163], v[96:99]
  ds_read_b64_tr_b16 a[88:89], v3 offset:16384
  ds_read_b64_tr_b16 a[90:91], v3 offset:18432
  v_mfma_f32_16x16x32_bf16 v[96:99], a[100:103], v[176:179], v[96:99]
  ds_read_b64_tr_b16 a[92:93], v3 offset:20480
  ds_read_b64_tr_b16 a[94:95], v3 offset:22528
  v_mfma_f32_16x16x32_bf16 v[100:103], a[96:99], v[164:167], v[100:103]
  v_mul_f32 v232, v232, v40
  v_mul_f32 v233, v233, v40
  v_mfma_f32_16x16x32_bf16 v[100:103], a[100:103], v[180:183], v[100:103]
  buffer_load_dwordx4 v28, s[20:23], s38 offen offset:3072 lds
  s_add_u32 s38, s38, 28672
  s_add_u32 m0, s33, 4096
  v_mfma_f32_16x16x32_bf16 v[104:107], a[104:107], v[160:163], v[104:107]
  ds_read_b64_tr_b16 a[96:97], v0 offset:24576
  ds_read_b64_tr_b16 a[98:99], v0 offset:26624
  v_mfma_f32_16x16x32_bf16 v[104:107], a[108:111], v[176:179], v[104:107]
  ds_read_b64_tr_b16 a[100:101], v0 offset:28672
  ds_read_b64_tr_b16 a[102:103], v0 offset:30720
  v_mfma_f32_16x16x32_bf16 v[108:111], a[104:107], v[164:167], v[108:111]
  v_mul_f32 v234, v234, v40
  v_mul_f32 v235, v235, v40
  v_mfma_f32_16x16x32_bf16 v[108:111], a[108:111], v[180:183], v[108:111]
  buffer_load_dwordx4 v25, s[20:23], s38 offen offset:0 lds
  v_mfma_f32_16x16x32_bf16 v[112:115], a[112:115], v[160:163], v[112:115]
  ds_read_b64_tr_b16 a[104:105], v1 offset:24576
  ds_read_b64_tr_b16 a[106:107], v1 offset:26624
  v_mfma_f32_16x16x32_bf16 v[112:115], a[116:119], v[176:179], v[112:115]
  ds_read_b64_tr_b16 a[108:109], v1 offset:28672
  ds_read_b64_tr_b16 a[110:111], v1 offset:30720
  v_mfma_f32_16x16x32_bf16 v[116:119], a[112:115], v[164:167], v[116:119]
  v_fmac_f32 v232, v72, v42
  v_fmac_f32 v233, v73, v42
  v_mfma_f32_16x16x32_bf16 v[116:119], a[116:119], v[180:183], v[116:119]
  buffer_load_dwordx4 v26, s[20:23], s38 offen offset:1024 lds
  v_mfma_f32_16x16x32_bf16 v[120:123], a[120:123], v[160:163], v[120:123]
  ds_read_b64_tr_b16 a[112:113], v2 offset:24576
  ds_read_b64_tr_b16 a[114:115], v2 offset:26624
  v_mfma_f32_16x16x32_bf16 v[120:123], a[124:127], v[176:179], v[120:123]
  ds_read_b64_tr_b16 a[116:117], v2 offset:28672
  ds_read_b64_tr_b16 a[118:119], v2 offset:30720
  v_mfma_f32_16x16x32_bf16 v[124:127], a[120:123], v[164:167], v[124:127]
  s_waitcnt lgkmcnt(12)
  v_fmac_f32 v234, v74, v42
  v_mfma_f32_16x16x32_bf16 v[124:127], a[124:127], v[180:183], v[124:127]
  buffer_load_dwordx4 v27, s[20:23], s38 offen offset:2048 lds
  v_mfma_f32_16x16x32_bf16 v[96:99], a[64:67], v[192:195], v[96:99]
  ds_read_b64_tr_b16 a[120:121], v3 offset:24576
  ds_read_b64_tr_b16 a[122:123], v3 offset:26624
  v_mfma_f32_16x16x32_bf16 v[96:99], a[68:71], v[208:211], v[96:99]
  ds_read_b64_tr_b16 a[124:125], v3 offset:28672
  ds_read_b64_tr_b16 a[126:127], v3 offset:30720
  v_mfma_f32_16x16x32_bf16 v[100:103], a[64:67], v[196:199], v[100:103]
  v_add_u32 v0, 4294934528, v0
  v_add_u32 v1, 4294934528, v1
  v_mfma_f32_16x16x32_bf16 v[100:103], a[68:71], v[212:215], v[100:103]
  buffer_load_dwordx4 v28, s[20:23], s38 offen offset:3072 lds
  s_movk_i32 s38, 512
  s_add_u32 m0, s33, 65536
  v_mfma_f32_16x16x32_bf16 v[104:107], a[72:75], v[192:195], v[104:107]
  v_add_u32 v2, 4294934528, v2
  v_add_u32 v3, 4294934528, v3
  v_mfma_f32_16x16x32_bf16 v[104:107], a[76:79], v[208:211], v[104:107]
  v_fmac_f32 v235, v75, v42
  v_cvt_pk_bf16_f32 v226, v232, v233
  v_mfma_f32_16x16x32_bf16 v[108:111], a[72:75], v[196:199], v[108:111]
  v_cvt_pk_bf16_f32 v227, v234, v235
  v_mul_f32 v228, v228, v44
  v_mfma_f32_16x16x32_bf16 v[108:111], a[76:79], v[212:215], v[108:111]
  buffer_load_dwordx4 v25, s[20:23], s38 offen offset:0 lds
  s_waitcnt vmcnt(21) lgkmcnt(0)
  s_barrier
  v_mfma_f32_16x16x32_bf16 v[112:115], a[80:83], v[192:195], v[112:115]
  ds_read_b64_tr_b16 a[64:65], v0 offset:0
  ds_read_b64_tr_b16 a[66:67], v0 offset:2048
  v_mfma_f32_16x16x32_bf16 v[112:115], a[84:87], v[208:211], v[112:115]
  ds_read_b64_tr_b16 a[68:69], v0 offset:4096
  ds_read_b64_tr_b16 a[70:71], v0 offset:6144
  v_mfma_f32_16x16x32_bf16 v[116:119], a[80:83], v[196:199], v[116:119]
  ds_read_b64_tr_b16 a[72:73], v1 offset:0
  ds_read_b64_tr_b16 a[74:75], v1 offset:2048
  v_mfma_f32_16x16x32_bf16 v[116:119], a[84:87], v[212:215], v[116:119]
  buffer_load_dwordx4 v26, s[20:23], s38 offen offset:1024 lds
  ds_read_b64_tr_b16 a[76:77], v1 offset:4096
  ds_read_b64_tr_b16 a[78:79], v1 offset:6144
  v_mfma_f32_16x16x32_bf16 v[120:123], a[88:91], v[192:195], v[120:123]
  v_mul_f32 v229, v229, v44
  v_mul_f32 v230, v230, v44
  v_mul_f32 v231, v231, v44
  v_fmac_f32 v228, v68, v46
  v_fmac_f32 v229, v69, v46
  v_fmac_f32 v230, v70, v46
  v_fmac_f32 v231, v71, v46
  v_cvt_pk_bf16_f32 v228, v228, v229
  v_cvt_pk_bf16_f32 v229, v230, v231
  v_mul_f32 v236, v236, v44
  v_mul_f32 v237, v237, v44
  v_mul_f32 v238, v238, v44
  v_mul_f32 v239, v239, v44
  v_fmac_f32 v236, v76, v46
  v_fmac_f32 v237, v77, v46
  v_fmac_f32 v238, v78, v46
  v_fmac_f32 v239, v79, v46
  v_cvt_pk_bf16_f32 v230, v236, v237
  v_cvt_pk_bf16_f32 v231, v238, v239
  v_mul_f32 v240, v240, v40
  v_mul_f32 v241, v241, v40
  v_mul_f32 v242, v242, v40
  v_mul_f32 v243, v243, v40
  v_fmac_f32 v240, v80, v42
  v_fmac_f32 v241, v81, v42
  v_fmac_f32 v242, v82, v42
  v_fmac_f32 v243, v83, v42
  v_cvt_pk_bf16_f32 v240, v240, v241
  v_cvt_pk_bf16_f32 v241, v242, v243
  v_mul_f32 v248, v248, v40
  v_mul_f32 v249, v249, v40
  v_mul_f32 v250, v250, v40
  v_mul_f32 v251, v251, v40
  v_fmac_f32 v248, v88, v42
  v_fmac_f32 v249, v89, v42
  v_fmac_f32 v250, v90, v42
  v_fmac_f32 v251, v91, v42
  v_cvt_pk_bf16_f32 v242, v248, v249
  v_cvt_pk_bf16_f32 v243, v250, v251
  v_mul_f32 v244, v244, v44
  v_mul_f32 v245, v245, v44
  v_mul_f32 v246, v246, v44
  v_mul_f32 v247, v247, v44
  v_fmac_f32 v244, v84, v46
  v_fmac_f32 v245, v85, v46
  v_fmac_f32 v246, v86, v46
  v_fmac_f32 v247, v87, v46
  v_cvt_pk_bf16_f32 v244, v244, v245
  v_cvt_pk_bf16_f32 v245, v246, v247
  v_mul_f32 v252, v252, v44
  v_mul_f32 v253, v253, v44
  v_mul_f32 v254, v254, v44
  v_mul_f32 v255, v255, v44
  v_fmac_f32 v252, v92, v46
  v_fmac_f32 v253, v93, v46
  v_fmac_f32 v254, v94, v46
  v_fmac_f32 v255, v95, v46
  v_cvt_pk_bf16_f32 v246, v252, v253
  v_cvt_pk_bf16_f32 v247, v254, v255
  v_mfma_f32_16x16x32_bf16 v[120:123], a[92:95], v[208:211], v[120:123]
  ds_read_b64_tr_b16 a[80:81], v2 offset:0
  ds_read_b64_tr_b16 a[82:83], v2 offset:2048
  v_mfma_f32_16x16x32_bf16 v[124:127], a[88:91], v[196:199], v[124:127]
  ds_read_b64_tr_b16 a[84:85], v2 offset:4096
  ds_read_b64_tr_b16 a[86:87], v2 offset:6144
  v_mfma_f32_16x16x32_bf16 v[124:127], a[92:95], v[212:215], v[124:127]
  buffer_load_dwordx4 v27, s[20:23], s38 offen offset:2048 lds
  v_mfma_f32_16x16x32_bf16 v[96:99], a[96:99], v[224:227], v[96:99]
  ds_read_b64_tr_b16 a[88:89], v3 offset:0
  ds_read_b64_tr_b16 a[90:91], v3 offset:2048
  v_mfma_f32_16x16x32_bf16 v[96:99], a[100:103], v[240:243], v[96:99]
  ds_read_b64_tr_b16 a[92:93], v3 offset:4096
  ds_read_b64_tr_b16 a[94:95], v3 offset:6144
  v_mfma_f32_16x16x32_bf16 v[100:103], a[96:99], v[228:231], v[100:103]
  v_mfma_f32_16x16x32_bf16 v[100:103], a[100:103], v[244:247], v[100:103]
  buffer_load_dwordx4 v28, s[20:23], s38 offen offset:3072 lds
  s_add_u32 s38, s38, 28672
  s_add_u32 m0, s33, 69632
  v_mfma_f32_16x16x32_bf16 v[104:107], a[104:107], v[224:227], v[104:107]
  ds_read_b64_tr_b16 a[96:97], v0 offset:8192
  ds_read_b64_tr_b16 a[98:99], v0 offset:10240
  v_mfma_f32_16x16x32_bf16 v[104:107], a[108:111], v[240:243], v[104:107]
  ds_read_b64_tr_b16 a[100:101], v0 offset:12288
  ds_read_b64_tr_b16 a[102:103], v0 offset:14336
  v_mfma_f32_16x16x32_bf16 v[108:111], a[104:107], v[228:231], v[108:111]
  v_mfma_f32_16x16x32_bf16 v[108:111], a[108:111], v[244:247], v[108:111]
  buffer_load_dwordx4 v25, s[20:23], s38 offen offset:0 lds
  v_mfma_f32_16x16x32_bf16 v[112:115], a[112:115], v[224:227], v[112:115]
  ds_read_b64_tr_b16 a[104:105], v1 offset:8192
  ds_read_b64_tr_b16 a[106:107], v1 offset:10240
  v_mfma_f32_16x16x32_bf16 v[112:115], a[116:119], v[240:243], v[112:115]
  ds_read_b64_tr_b16 a[108:109], v1 offset:12288
  ds_read_b64_tr_b16 a[110:111], v1 offset:14336
  v_mfma_f32_16x16x32_bf16 v[116:119], a[112:115], v[228:231], v[116:119]
  v_mfma_f32_16x16x32_bf16 v[116:119], a[116:119], v[244:247], v[116:119]
  buffer_load_dwordx4 v26, s[20:23], s38 offen offset:1024 lds
  v_mfma_f32_16x16x32_bf16 v[120:123], a[120:123], v[224:227], v[120:123]
  ds_read_b64_tr_b16 a[112:113], v2 offset:8192
  ds_read_b64_tr_b16 a[114:115], v2 offset:10240
  v_mfma_f32_16x16x32_bf16 v[120:123], a[124:127], v[240:243], v[120:123]
  ds_read_b64_tr_b16 a[116:117], v2 offset:12288
  ds_read_b64_tr_b16 a[118:119], v2 offset:14336
  v_mfma_f32_16x16x32_bf16 v[124:127], a[120:123], v[228:231], v[124:127]
  s_waitcnt lgkmcnt(12)
  v_mfma_f32_16x16x32_bf16 v[124:127], a[124:127], v[244:247], v[124:127]
  buffer_load_dwordx4 v27, s[20:23], s38 offen offset:2048 lds
  v_mfma_f32_16x16x32_bf16 v[64:67], a[64:67], v[128:131], 0
  ds_read_b64_tr_b16 a[120:121], v3 offset:8192
  ds_read_b64_tr_b16 a[122:123], v3 offset:10240
  v_mfma_f32_16x16x32_bf16 v[64:67], a[68:71], v[144:147], v[64:67]
  ds_read_b64_tr_b16 a[124:125], v3 offset:12288
  ds_read_b64_tr_b16 a[126:127], v3 offset:14336
  v_mfma_f32_16x16x32_bf16 v[68:71], a[64:67], v[132:135], 0
  v_mfma_f32_16x16x32_bf16 v[68:71], a[68:71], v[148:151], v[68:71]
  buffer_load_dwordx4 v28, s[20:23], s38 offen offset:3072 lds
  s_movk_i32 s38, 640
  s_add_u32 m0, s33, 131072
  v_mfma_f32_16x16x32_bf16 v[72:75], a[72:75], v[128:131], 0
  ds_read_b64_tr_b16 a[64:65], v0 offset:16384
  ds_read_b64_tr_b16 a[66:67], v0 offset:18432
  v_mfma_f32_16x16x32_bf16 v[72:75], a[76:79], v[144:147], v[72:75]
  ds_read_b64_tr_b16 a[68:69], v0 offset:20480
  ds_read_b64_tr_b16 a[70:71], v0 offset:22528
  v_mfma_f32_16x16x32_bf16 v[76:79], a[72:75], v[132:135], 0
  v_cvt_pk_bf16_f32 v96, v96, v97
  v_cvt_pk_bf16_f32 v97, v98, v99
  v_mfma_f32_16x16x32_bf16 v[76:79], a[76:79], v[148:151], v[76:79]
  buffer_load_dwordx4 v25, s[20:23], s38 offen offset:0 lds
  v_mfma_f32_16x16x32_bf16 v[80:83], a[80:83], v[128:131], 0
  ds_read_b64_tr_b16 a[72:73], v1 offset:16384
  v_cvt_pk_bf16_f32 v98, v104, v105
  v_mfma_f32_16x16x32_bf16 v[80:83], a[84:87], v[144:147], v[80:83]
  ds_read_b64_tr_b16 a[74:75], v1 offset:18432
  ds_read_b64_tr_b16 a[76:77], v1 offset:20480
  v_mfma_f32_16x16x32_bf16 v[84:87], a[80:83], v[132:135], 0
  ds_read_b64_tr_b16 a[78:79], v1 offset:22528
  v_cvt_pk_bf16_f32 v99, v106, v107
  v_mfma_f32_16x16x32_bf16 v[84:87], a[84:87], v[148:151], v[84:87]
  buffer_load_dwordx4 v26, s[20:23], s38 offen offset:1024 lds
  v_mfma_f32_16x16x32_bf16 v[88:91], a[88:91], v[128:131], 0
  ds_read_b64_tr_b16 a[80:81], v2 offset:16384
  v_permlane32_swap_b32 v96, v98
  v_mfma_f32_16x16x32_bf16 v[88:91], a[92:95], v[144:147], v[88:91]
  ds_read_b64_tr_b16 a[82:83], v2 offset:18432
  ds_read_b64_tr_b16 a[84:85], v2 offset:20480
  v_mfma_f32_16x16x32_bf16 v[92:95], a[88:91], v[132:135], 0
  ds_read_b64_tr_b16 a[86:87], v2 offset:22528
  v_permlane32_swap_b32 v97, v99
  v_mfma_f32_16x16x32_bf16 v[92:95], a[92:95], v[148:151], v[92:95]
  buffer_load_dwordx4 v27, s[20:23], s38 offen offset:2048 lds
  s_waitcnt lgkmcnt(12)
  v_mfma_f32_16x16x32_bf16 v[64:67], a[96:99], v[160:163], v[64:67]
  buffer_store_dwordx4 v[96:99], v23, s[24:27], s60 offen offset:0 sc1
  v_mfma_f32_16x16x32_bf16 v[64:67], a[100:103], v[176:179], v[64:67]
  ds_read_b64_tr_b16 a[88:89], v3 offset:16384
  ds_read_b64_tr_b16 a[90:91], v3 offset:18432
  v_mfma_f32_16x16x32_bf16 v[68:71], a[96:99], v[164:167], v[68:71]
  ds_read_b64_tr_b16 a[92:93], v3 offset:20480
  ds_read_b64_tr_b16 a[94:95], v3 offset:22528
  v_cvt_pk_bf16_f32 v112, v112, v113
  v_mfma_f32_16x16x32_bf16 v[68:71], a[100:103], v[180:183], v[68:71]
  buffer_load_dwordx4 v28, s[20:23], s38 offen offset:3072 lds
  s_add_u32 s38, s38, 28672
  s_add_u32 m0, s33, 135168
  v_mfma_f32_16x16x32_bf16 v[72:75], a[104:107], v[160:163], v[72:75]
  ds_read_b64_tr_b16 a[96:97], v0 offset:24576
  v_cvt_pk_bf16_f32 v113, v114, v115
  v_mfma_f32_16x16x32_bf16 v[72:75], a[108:111], v[176:179], v[72:75]
  ds_read_b64_tr_b16 a[98:99], v0 offset:26624
  ds_read_b64_tr_b16 a[100:101], v0 offset:28672
  v_mfma_f32_16x16x32_bf16 v[76:79], a[104:107], v[164:167], v[76:79]
  ds_read_b64_tr_b16 a[102:103], v0 offset:30720
  v_cvt_pk_bf16_f32 v114, v120, v121
  v_mfma_f32_16x16x32_bf16 v[76:79], a[108:111], v[180:183], v[76:79]
  buffer_load_dwordx4 v25, s[20:23], s38 offen offset:0 lds
  v_cvt_pk_bf16_f32 v115, v122, v123
  v_mfma_f32_16x16x32_bf16 v[80:83], a[112:115], v[160:163], v[80:83]
  ds_read_b64_tr_b16 a[104:105], v1 offset:24576
  v_permlane32_swap_b32 v112, v114
  v_mfma_f32_16x16x32_bf16 v[80:83], a[116:119], v[176:179], v[80:83]
  ds_read_b64_tr_b16 a[106:107], v1 offset:26624
  ds_read_b64_tr_b16 a[108:109], v1 offset:28672
  v_mfma_f32_16x16x32_bf16 v[84:87], a[112:115], v[164:167], v[84:87]
  ds_read_b64_tr_b16 a[110:111], v1 offset:30720
  v_permlane32_swap_b32 v113, v115
  v_mfma_f32_16x16x32_bf16 v[84:87], a[116:119], v[180:183], v[84:87]
  buffer_load_dwordx4 v26, s[20:23], s38 offen offset:1024 lds
  v_mfma_f32_16x16x32_bf16 v[88:91], a[120:123], v[160:163], v[88:91]
  buffer_store_dwordx4 v[112:115], v23, s[24:27], s60 offen offset:512 sc1
  v_mfma_f32_16x16x32_bf16 v[88:91], a[124:127], v[176:179], v[88:91]
  ds_read_b64_tr_b16 a[112:113], v2 offset:24576
  ds_read_b64_tr_b16 a[114:115], v2 offset:26624
  v_mfma_f32_16x16x32_bf16 v[92:95], a[120:123], v[164:167], v[92:95]
  ds_read_b64_tr_b16 a[116:117], v2 offset:28672
  ds_read_b64_tr_b16 a[118:119], v2 offset:30720
  v_mfma_f32_16x16x32_bf16 v[92:95], a[124:127], v[180:183], v[92:95]
  buffer_load_dwordx4 v27, s[20:23], s38 offen offset:2048 lds
  s_waitcnt lgkmcnt(12)
  v_cvt_pk_bf16_f32 v100, v100, v101
  v_mfma_f32_16x16x32_bf16 v[64:67], a[64:67], v[192:195], v[64:67]
  ds_read_b64_tr_b16 a[120:121], v3 offset:24576
  v_cvt_pk_bf16_f32 v101, v102, v103
  v_mfma_f32_16x16x32_bf16 v[64:67], a[68:71], v[208:211], v[64:67]
  ds_read_b64_tr_b16 a[122:123], v3 offset:26624
  ds_read_b64_tr_b16 a[124:125], v3 offset:28672
  v_mfma_f32_16x16x32_bf16 v[68:71], a[64:67], v[196:199], v[68:71]
  ds_read_b64_tr_b16 a[126:127], v3 offset:30720
  v_cvt_pk_bf16_f32 v102, v108, v109
  v_mfma_f32_16x16x32_bf16 v[68:71], a[68:71], v[212:215], v[68:71]
  buffer_load_dwordx4 v28, s[20:23], s38 offen offset:3072 lds
  v_mfma_f32_16x16x32_bf16 v[72:75], a[72:75], v[192:195], v[72:75]
  v_cvt_pk_bf16_f32 v103, v110, v111
  v_add_u32 v0, 4294901760, v0
  v_mfma_f32_16x16x32_bf16 v[72:75], a[76:79], v[208:211], v[72:75]
  v_permlane32_swap_b32 v100, v102
  v_add_u32 v1, 4294901760, v1
  v_mfma_f32_16x16x32_bf16 v[76:79], a[72:75], v[196:199], v[76:79]
  v_add_u32 v2, 4294901760, v2
  v_add_u32 v3, 4294901760, v3
  v_mfma_f32_16x16x32_bf16 v[76:79], a[76:79], v[212:215], v[76:79]
  s_waitcnt vmcnt(30) lgkmcnt(0)
  s_barrier
  v_mfma_f32_16x16x32_bf16 v[80:83], a[80:83], v[192:195], v[80:83]
  s_movk_i32 s38, 768
  s_add_u32 m0, s33, 98304
  v_permlane32_swap_b32 v101, v103
  v_mfma_f32_16x16x32_bf16 v[80:83], a[84:87], v[208:211], v[80:83]
  buffer_store_dwordx4 v[100:103], v23, s[24:27], s61 offen offset:0 sc1
  v_mfma_f32_16x16x32_bf16 v[84:87], a[80:83], v[196:199], v[84:87]
  ds_read_b64_tr_b16 a[64:65], v0 offset:0
  ds_read_b64_tr_b16 a[66:67], v0 offset:2048
  v_mfma_f32_16x16x32_bf16 v[84:87], a[84:87], v[212:215], v[84:87]
  buffer_load_dwordx4 v25, s[20:23], s38 offen offset:0 lds
  ds_read_b64_tr_b16 a[68:69], v0 offset:4096
  ds_read_b64_tr_b16 a[70:71], v0 offset:6144
  ds_read_b64_tr_b16 a[72:73], v1 offset:0
  ds_read_b64_tr_b16 a[74:75], v1 offset:2048
  ds_read_b64_tr_b16 a[76:77], v1 offset:4096
  ds_read_b64_tr_b16 a[78:79], v1 offset:6144
  v_cvt_pk_bf16_f32 v116, v116, v117
  v_mfma_f32_16x16x32_bf16 v[88:91], a[88:91], v[192:195], v[88:91]
  ds_read_b64_tr_b16 a[80:81], v2 offset:0
  v_cvt_pk_bf16_f32 v117, v118, v119
  v_mfma_f32_16x16x32_bf16 v[88:91], a[92:95], v[208:211], v[88:91]
  ds_read_b64_tr_b16 a[82:83], v2 offset:2048
  ds_read_b64_tr_b16 a[84:85], v2 offset:4096
  v_mfma_f32_16x16x32_bf16 v[92:95], a[88:91], v[196:199], v[92:95]
  ds_read_b64_tr_b16 a[86:87], v2 offset:6144
  v_cvt_pk_bf16_f32 v118, v124, v125
  v_mfma_f32_16x16x32_bf16 v[92:95], a[92:95], v[212:215], v[92:95]
  buffer_load_dwordx4 v26, s[20:23], s38 offen offset:1024 lds
  v_mfma_f32_16x16x32_bf16 v[64:67], a[96:99], v[224:227], v[64:67]
  ds_read_b64_tr_b16 a[88:89], v3 offset:0
  v_cvt_pk_bf16_f32 v119, v126, v127
  v_mfma_f32_16x16x32_bf16 v[64:67], a[100:103], v[240:243], v[64:67]
  ds_read_b64_tr_b16 a[90:91], v3 offset:2048
  ds_read_b64_tr_b16 a[92:93], v3 offset:4096
  v_mfma_f32_16x16x32_bf16 v[68:71], a[96:99], v[228:231], v[68:71]
  ds_read_b64_tr_b16 a[94:95], v3 offset:6144
  v_permlane32_swap_b32 v116, v118
  v_mfma_f32_16x16x32_bf16 v[68:71], a[100:103], v[244:247], v[68:71]
  buffer_load_dwordx4 v27, s[20:23], s38 offen offset:2048 lds
  v_mfma_f32_16x16x32_bf16 v[72:75], a[104:107], v[224:227], v[72:75]
  ds_read_b64_tr_b16 a[96:97], v0 offset:8192
  v_permlane32_swap_b32 v117, v119
  v_mfma_f32_16x16x32_bf16 v[72:75], a[108:111], v[240:243], v[72:75]
  ds_read_b64_tr_b16 a[98:99], v0 offset:10240
  ds_read_b64_tr_b16 a[100:101], v0 offset:12288
  v_mfma_f32_16x16x32_bf16 v[76:79], a[104:107], v[228:231], v[76:79]
  ds_read_b64_tr_b16 a[102:103], v0 offset:14336
  buffer_store_dwordx4 v[116:119], v23, s[24:27], s61 offen offset:512 sc1
  v_mfma_f32_16x16x32_bf16 v[76:79], a[108:111], v[244:247], v[76:79]
  buffer_load_dwordx4 v28, s[20:23], s38 offen offset:3072 lds
  s_add_u32 s38, s38, 28672
  s_add_u32 m0, s33, 102400
  v_mfma_f32_16x16x32_bf16 v[80:83], a[112:115], v[224:227], v[80:83]
  ds_read_b64_tr_b16 a[104:105], v1 offset:8192
  v_add_u32 v23, 1024, v23
  v_mfma_f32_16x16x32_bf16 v[80:83], a[116:119], v[240:243], v[80:83]
  ds_read_b64_tr_b16 a[106:107], v1 offset:10240
  ds_read_b64_tr_b16 a[108:109], v1 offset:12288
  v_mfma_f32_16x16x32_bf16 v[84:87], a[112:115], v[228:231], v[84:87]
  ds_read_b64_tr_b16 a[110:111], v1 offset:14336
  v_mfma_f32_16x16x32_bf16 v[84:87], a[116:119], v[244:247], v[84:87]
  buffer_load_dwordx4 v25, s[20:23], s38 offen offset:0 lds
  v_mfma_f32_16x16x32_bf16 v[88:91], a[120:123], v[224:227], v[88:91]
  ds_read_b64_tr_b16 a[112:113], v2 offset:8192
  ds_read_b64_tr_b16 a[114:115], v2 offset:10240
  v_mfma_f32_16x16x32_bf16 v[88:91], a[124:127], v[240:243], v[88:91]
  ds_read_b64_tr_b16 a[116:117], v2 offset:12288
  ds_read_b64_tr_b16 a[118:119], v2 offset:14336
  v_mfma_f32_16x16x32_bf16 v[92:95], a[120:123], v[228:231], v[92:95]
  s_waitcnt lgkmcnt(12)
  v_mfma_f32_16x16x32_bf16 v[92:95], a[124:127], v[244:247], v[92:95]
  buffer_load_dwordx4 v26, s[20:23], s38 offen offset:1024 lds
  v_mfma_f32_16x16x32_bf16 v[96:99], a[64:67], v[128:131], 0
  ds_read_b64_tr_b16 a[120:121], v3 offset:8192
  ds_read_b64_tr_b16 a[122:123], v3 offset:10240
  v_mfma_f32_16x16x32_bf16 v[96:99], a[68:71], v[144:147], v[96:99]
  ds_read_b64_tr_b16 a[124:125], v3 offset:12288
  ds_read_b64_tr_b16 a[126:127], v3 offset:14336
  v_mfma_f32_16x16x32_bf16 v[100:103], a[64:67], v[132:135], 0
  v_mfma_f32_16x16x32_bf16 v[100:103], a[68:71], v[148:151], v[100:103]
  buffer_load_dwordx4 v27, s[20:23], s38 offen offset:2048 lds
  v_mfma_f32_16x16x32_bf16 v[104:107], a[72:75], v[128:131], 0
  ds_read_b64_tr_b16 a[64:65], v0 offset:16384
  ds_read_b64_tr_b16 a[66:67], v0 offset:18432
  v_mfma_f32_16x16x32_bf16 v[104:107], a[76:79], v[144:147], v[104:107]
  ds_read_b64_tr_b16 a[68:69], v0 offset:20480
  ds_read_b64_tr_b16 a[70:71], v0 offset:22528
  v_mfma_f32_16x16x32_bf16 v[108:111], a[72:75], v[132:135], 0
  v_cvt_pk_bf16_f32 v64, v64, v65
  v_cvt_pk_bf16_f32 v65, v66, v67
  v_mfma_f32_16x16x32_bf16 v[108:111], a[76:79], v[148:151], v[108:111]
  buffer_load_dwordx4 v28, s[20:23], s38 offen offset:3072 lds
  v_mfma_f32_16x16x32_bf16 v[112:115], a[80:83], v[128:131], 0
  ds_read_b64_tr_b16 a[72:73], v1 offset:16384
  v_cvt_pk_bf16_f32 v66, v72, v73
  v_mfma_f32_16x16x32_bf16 v[112:115], a[84:87], v[144:147], v[112:115]
  ds_read_b64_tr_b16 a[74:75], v1 offset:18432
  ds_read_b64_tr_b16 a[76:77], v1 offset:20480
  v_mfma_f32_16x16x32_bf16 v[116:119], a[80:83], v[132:135], 0
  ds_read_b64_tr_b16 a[78:79], v1 offset:22528
  v_cvt_pk_bf16_f32 v67, v74, v75
  v_mfma_f32_16x16x32_bf16 v[116:119], a[84:87], v[148:151], v[116:119]
  ds_read_b64_tr_b16 a[80:81], v2 offset:16384
  v_permlane32_swap_b32 v64, v66
  v_mfma_f32_16x16x32_bf16 v[120:123], a[88:91], v[128:131], 0
  ds_read_b64_tr_b16 a[82:83], v2 offset:18432
  ds_read_b64_tr_b16 a[84:85], v2 offset:20480
  v_mfma_f32_16x16x32_bf16 v[120:123], a[92:95], v[144:147], v[120:123]
  ds_read_b64_tr_b16 a[86:87], v2 offset:22528
  v_permlane32_swap_b32 v65, v67
  v_mfma_f32_16x16x32_bf16 v[124:127], a[88:91], v[132:135], 0
  s_waitcnt lgkmcnt(12)
  v_mfma_f32_16x16x32_bf16 v[124:127], a[92:95], v[148:151], v[124:127]
  buffer_store_dwordx4 v[64:67], v23, s[24:27], s60 offen offset:0 sc1
  v_mfma_f32_16x16x32_bf16 v[96:99], a[96:99], v[160:163], v[96:99]
  ds_read_b64_tr_b16 a[88:89], v3 offset:16384
  ds_read_b64_tr_b16 a[90:91], v3 offset:18432
  v_mfma_f32_16x16x32_bf16 v[96:99], a[100:103], v[176:179], v[96:99]
  ds_read_b64_tr_b16 a[92:93], v3 offset:20480
  ds_read_b64_tr_b16 a[94:95], v3 offset:22528
  v_mfma_f32_16x16x32_bf16 v[100:103], a[96:99], v[164:167], v[100:103]
  v_cvt_pk_bf16_f32 v80, v80, v81
  v_cvt_pk_bf16_f32 v81, v82, v83
  v_mfma_f32_16x16x32_bf16 v[100:103], a[100:103], v[180:183], v[100:103]
  ds_read_b64_tr_b16 a[96:97], v0 offset:24576
  ds_read_b64_tr_b16 a[98:99], v0 offset:26624
  v_mfma_f32_16x16x32_bf16 v[104:107], a[104:107], v[160:163], v[104:107]
  ds_read_b64_tr_b16 a[100:101], v0 offset:28672
  ds_read_b64_tr_b16 a[102:103], v0 offset:30720
  v_mfma_f32_16x16x32_bf16 v[104:107], a[108:111], v[176:179], v[104:107]
  v_cvt_pk_bf16_f32 v82, v88, v89
  v_cvt_pk_bf16_f32 v83, v90, v91
  v_mfma_f32_16x16x32_bf16 v[108:111], a[104:107], v[164:167], v[108:111]
  v_mfma_f32_16x16x32_bf16 v[108:111], a[108:111], v[180:183], v[108:111]
  ds_read_b64_tr_b16 a[104:105], v1 offset:24576
  v_permlane32_swap_b32 v80, v82
  v_mfma_f32_16x16x32_bf16 v[112:115], a[112:115], v[160:163], v[112:115]
  ds_read_b64_tr_b16 a[106:107], v1 offset:26624
  ds_read_b64_tr_b16 a[108:109], v1 offset:28672
  v_mfma_f32_16x16x32_bf16 v[112:115], a[116:119], v[176:179], v[112:115]
  ds_read_b64_tr_b16 a[110:111], v1 offset:30720
  v_permlane32_swap_b32 v81, v83
  v_mfma_f32_16x16x32_bf16 v[116:119], a[112:115], v[164:167], v[116:119]
  v_mfma_f32_16x16x32_bf16 v[116:119], a[116:119], v[180:183], v[116:119]
  buffer_store_dwordx4 v[80:83], v23, s[24:27], s60 offen offset:512 sc1
  v_mfma_f32_16x16x32_bf16 v[120:123], a[120:123], v[160:163], v[120:123]
  ds_read_b64_tr_b16 a[112:113], v2 offset:24576
  ds_read_b64_tr_b16 a[114:115], v2 offset:26624
  v_mfma_f32_16x16x32_bf16 v[120:123], a[124:127], v[176:179], v[120:123]
  ds_read_b64_tr_b16 a[116:117], v2 offset:28672
  ds_read_b64_tr_b16 a[118:119], v2 offset:30720
  v_mfma_f32_16x16x32_bf16 v[124:127], a[120:123], v[164:167], v[124:127]
  s_waitcnt lgkmcnt(12)
  v_cvt_pk_bf16_f32 v68, v68, v69
  v_mfma_f32_16x16x32_bf16 v[124:127], a[124:127], v[180:183], v[124:127]
  ds_read_b64_tr_b16 a[120:121], v3 offset:24576
  v_cvt_pk_bf16_f32 v69, v70, v71
  v_mfma_f32_16x16x32_bf16 v[96:99], a[64:67], v[192:195], v[96:99]
  ds_read_b64_tr_b16 a[122:123], v3 offset:26624
  ds_read_b64_tr_b16 a[124:125], v3 offset:28672
  v_mfma_f32_16x16x32_bf16 v[96:99], a[68:71], v[208:211], v[96:99]
  ds_read_b64_tr_b16 a[126:127], v3 offset:30720
  v_cvt_pk_bf16_f32 v70, v76, v77
  v_mfma_f32_16x16x32_bf16 v[100:103], a[64:67], v[196:199], v[100:103]
  v_cvt_pk_bf16_f32 v71, v78, v79
  v_add_u32 v0, 4294934528, v0
  v_mfma_f32_16x16x32_bf16 v[100:103], a[68:71], v[212:215], v[100:103]
  v_add_u32 v1, 4294934528, v1
  v_add_u32 v2, 4294934528, v2
  v_mfma_f32_16x16x32_bf16 v[104:107], a[72:75], v[192:195], v[104:107]
  v_permlane32_swap_b32 v68, v70
  v_add_u32 v3, 4294934528, v3
  v_mfma_f32_16x16x32_bf16 v[104:107], a[76:79], v[208:211], v[104:107]
  v_mfma_f32_16x16x32_bf16 v[108:111], a[72:75], v[196:199], v[108:111]
  v_permlane32_swap_b32 v69, v71
  v_mfma_f32_16x16x32_bf16 v[108:111], a[76:79], v[212:215], v[108:111]
  s_waitcnt vmcnt(30) lgkmcnt(0)
  s_barrier
  v_mfma_f32_16x16x32_bf16 v[112:115], a[80:83], v[192:195], v[112:115]
  buffer_store_dwordx4 v[68:71], v23, s[24:27], s61 offen offset:0 sc1
  v_mfma_f32_16x16x32_bf16 v[112:115], a[84:87], v[208:211], v[112:115]
  ds_read_b64_tr_b16 a[64:65], v0 offset:0
  ds_read_b64_tr_b16 a[66:67], v0 offset:2048
  v_mfma_f32_16x16x32_bf16 v[116:119], a[80:83], v[196:199], v[116:119]
  ds_read_b64_tr_b16 a[68:69], v0 offset:4096
  ds_read_b64_tr_b16 a[70:71], v0 offset:6144
  v_mfma_f32_16x16x32_bf16 v[116:119], a[84:87], v[212:215], v[116:119]
  ds_read_b64_tr_b16 a[72:73], v1 offset:0
  ds_read_b64_tr_b16 a[74:75], v1 offset:2048
  ds_read_b64_tr_b16 a[76:77], v1 offset:4096
  ds_read_b64_tr_b16 a[78:79], v1 offset:6144
  v_cvt_pk_bf16_f32 v84, v84, v85
  v_mfma_f32_16x16x32_bf16 v[120:123], a[88:91], v[192:195], v[120:123]
  ds_read_b64_tr_b16 a[80:81], v2 offset:0
  v_cvt_pk_bf16_f32 v85, v86, v87
  v_mfma_f32_16x16x32_bf16 v[120:123], a[92:95], v[208:211], v[120:123]
  ds_read_b64_tr_b16 a[82:83], v2 offset:2048
  ds_read_b64_tr_b16 a[84:85], v2 offset:4096
  v_mfma_f32_16x16x32_bf16 v[124:127], a[88:91], v[196:199], v[124:127]
  ds_read_b64_tr_b16 a[86:87], v2 offset:6144
  v_cvt_pk_bf16_f32 v86, v92, v93
  v_mfma_f32_16x16x32_bf16 v[124:127], a[92:95], v[212:215], v[124:127]
  ds_read_b64_tr_b16 a[88:89], v3 offset:0
  v_cvt_pk_bf16_f32 v87, v94, v95
  v_mfma_f32_16x16x32_bf16 v[96:99], a[96:99], v[224:227], v[96:99]
  ds_read_b64_tr_b16 a[90:91], v3 offset:2048
  ds_read_b64_tr_b16 a[92:93], v3 offset:4096
  v_mfma_f32_16x16x32_bf16 v[96:99], a[100:103], v[240:243], v[96:99]
  ds_read_b64_tr_b16 a[94:95], v3 offset:6144
  v_permlane32_swap_b32 v84, v86
  v_mfma_f32_16x16x32_bf16 v[100:103], a[96:99], v[228:231], v[100:103]
  v_permlane32_swap_b32 v85, v87
  v_mfma_f32_16x16x32_bf16 v[100:103], a[100:103], v[244:247], v[100:103]
  ds_read_b64_tr_b16 a[96:97], v0 offset:8192
  ds_read_b64_tr_b16 a[98:99], v0 offset:10240
  v_mfma_f32_16x16x32_bf16 v[104:107], a[104:107], v[224:227], v[104:107]
  ds_read_b64_tr_b16 a[100:101], v0 offset:12288
  ds_read_b64_tr_b16 a[102:103], v0 offset:14336
  v_mfma_f32_16x16x32_bf16 v[104:107], a[108:111], v[240:243], v[104:107]
  buffer_store_dwordx4 v[84:87], v23, s[24:27], s61 offen offset:512 sc1
  v_mfma_f32_16x16x32_bf16 v[108:111], a[104:107], v[228:231], v[108:111]
  s_nop 0
  v_add_u32 v23, 1024, v23
  v_mfma_f32_16x16x32_bf16 v[108:111], a[108:111], v[244:247], v[108:111]
  ds_read_b64_tr_b16 a[104:105], v1 offset:8192
  ds_read_b64_tr_b16 a[106:107], v1 offset:10240
  v_mfma_f32_16x16x32_bf16 v[112:115], a[112:115], v[224:227], v[112:115]
  ds_read_b64_tr_b16 a[108:109], v1 offset:12288
  ds_read_b64_tr_b16 a[110:111], v1 offset:14336
  v_mfma_f32_16x16x32_bf16 v[112:115], a[116:119], v[240:243], v[112:115]
  v_mfma_f32_16x16x32_bf16 v[116:119], a[112:115], v[228:231], v[116:119]
  v_mfma_f32_16x16x32_bf16 v[116:119], a[116:119], v[244:247], v[116:119]
  ds_read_b64_tr_b16 a[112:113], v2 offset:8192
  ds_read_b64_tr_b16 a[114:115], v2 offset:10240
  v_mfma_f32_16x16x32_bf16 v[120:123], a[120:123], v[224:227], v[120:123]
  ds_read_b64_tr_b16 a[116:117], v2 offset:12288
  ds_read_b64_tr_b16 a[118:119], v2 offset:14336
  v_mfma_f32_16x16x32_bf16 v[120:123], a[124:127], v[240:243], v[120:123]
  s_waitcnt lgkmcnt(12)
  v_mfma_f32_16x16x32_bf16 v[124:127], a[120:123], v[228:231], v[124:127]
  v_mfma_f32_16x16x32_bf16 v[124:127], a[124:127], v[244:247], v[124:127]
  ds_read_b64_tr_b16 a[120:121], v3 offset:8192
  ds_read_b64_tr_b16 a[122:123], v3 offset:10240
  v_mfma_f32_16x16x32_bf16 v[64:67], a[64:67], v[128:131], 0
  ds_read_b64_tr_b16 a[124:125], v3 offset:12288
  ds_read_b64_tr_b16 a[126:127], v3 offset:14336
  v_mfma_f32_16x16x32_bf16 v[64:67], a[68:71], v[144:147], v[64:67]
  v_mfma_f32_16x16x32_bf16 v[68:71], a[64:67], v[132:135], 0
  v_mfma_f32_16x16x32_bf16 v[68:71], a[68:71], v[148:151], v[68:71]
  ds_read_b64_tr_b16 a[64:65], v0 offset:16384
  ds_read_b64_tr_b16 a[66:67], v0 offset:18432
  v_mfma_f32_16x16x32_bf16 v[72:75], a[72:75], v[128:131], 0
  ds_read_b64_tr_b16 a[68:69], v0 offset:20480
  ds_read_b64_tr_b16 a[70:71], v0 offset:22528
  v_mfma_f32_16x16x32_bf16 v[72:75], a[76:79], v[144:147], v[72:75]
  v_cvt_pk_bf16_f32 v96, v96, v97
  v_cvt_pk_bf16_f32 v97, v98, v99
  v_mfma_f32_16x16x32_bf16 v[76:79], a[72:75], v[132:135], 0
  v_mfma_f32_16x16x32_bf16 v[76:79], a[76:79], v[148:151], v[76:79]
  ds_read_b64_tr_b16 a[72:73], v1 offset:16384
  v_cvt_pk_bf16_f32 v98, v104, v105
  v_mfma_f32_16x16x32_bf16 v[80:83], a[80:83], v[128:131], 0
  ds_read_b64_tr_b16 a[74:75], v1 offset:18432
  ds_read_b64_tr_b16 a[76:77], v1 offset:20480
  v_mfma_f32_16x16x32_bf16 v[80:83], a[84:87], v[144:147], v[80:83]
  ds_read_b64_tr_b16 a[78:79], v1 offset:22528
  v_cvt_pk_bf16_f32 v99, v106, v107
  v_mfma_f32_16x16x32_bf16 v[84:87], a[80:83], v[132:135], 0
  s_lshl_b32 s3, s51, 4
  s_add_u32 s3, s3, s50
  v_mfma_f32_16x16x32_bf16 v[84:87], a[84:87], v[148:151], v[84:87]
  ds_read_b64_tr_b16 a[80:81], v2 offset:16384
  v_permlane32_swap_b32 v96, v98
  v_mfma_f32_16x16x32_bf16 v[88:91], a[88:91], v[128:131], 0
  ds_read_b64_tr_b16 a[82:83], v2 offset:18432
  ds_read_b64_tr_b16 a[84:85], v2 offset:20480
  v_mfma_f32_16x16x32_bf16 v[88:91], a[92:95], v[144:147], v[88:91]
  ds_read_b64_tr_b16 a[86:87], v2 offset:22528
  v_permlane32_swap_b32 v97, v99
  v_mfma_f32_16x16x32_bf16 v[92:95], a[88:91], v[132:135], 0
  s_waitcnt lgkmcnt(12)
  s_lshl_b32 s3, s3, 7
  v_mfma_f32_16x16x32_bf16 v[92:95], a[92:95], v[148:151], v[92:95]
  buffer_store_dwordx4 v[96:99], v23, s[24:27], s60 offen offset:0 sc1
  v_mfma_f32_16x16x32_bf16 v[64:67], a[96:99], v[160:163], v[64:67]
  ds_read_b64_tr_b16 a[88:89], v3 offset:16384
  ds_read_b64_tr_b16 a[90:91], v3 offset:18432
  v_mfma_f32_16x16x32_bf16 v[64:67], a[100:103], v[176:179], v[64:67]
  ds_read_b64_tr_b16 a[92:93], v3 offset:20480
  ds_read_b64_tr_b16 a[94:95], v3 offset:22528
  v_mfma_f32_16x16x32_bf16 v[68:71], a[96:99], v[164:167], v[68:71]
  v_cvt_pk_bf16_f32 v112, v112, v113
  v_cvt_pk_bf16_f32 v113, v114, v115
  v_mfma_f32_16x16x32_bf16 v[68:71], a[100:103], v[180:183], v[68:71]
  ds_read_b64_tr_b16 a[96:97], v0 offset:24576
  ds_read_b64_tr_b16 a[98:99], v0 offset:26624
  v_mfma_f32_16x16x32_bf16 v[72:75], a[104:107], v[160:163], v[72:75]
  ds_read_b64_tr_b16 a[100:101], v0 offset:28672
  ds_read_b64_tr_b16 a[102:103], v0 offset:30720
  v_mfma_f32_16x16x32_bf16 v[72:75], a[108:111], v[176:179], v[72:75]
  v_cvt_pk_bf16_f32 v114, v120, v121
  v_cvt_pk_bf16_f32 v115, v122, v123
  v_mfma_f32_16x16x32_bf16 v[76:79], a[104:107], v[164:167], v[76:79]
  s_add_u32 s3, s3, 2113536
  v_mfma_f32_16x16x32_bf16 v[76:79], a[108:111], v[180:183], v[76:79]
  ds_read_b64_tr_b16 a[104:105], v1 offset:24576
  v_permlane32_swap_b32 v112, v114
  v_mfma_f32_16x16x32_bf16 v[80:83], a[112:115], v[160:163], v[80:83]
  ds_read_b64_tr_b16 a[106:107], v1 offset:26624
  ds_read_b64_tr_b16 a[108:109], v1 offset:28672
  v_mfma_f32_16x16x32_bf16 v[80:83], a[116:119], v[176:179], v[80:83]
  ds_read_b64_tr_b16 a[110:111], v1 offset:30720
  v_permlane32_swap_b32 v113, v115
  v_mfma_f32_16x16x32_bf16 v[84:87], a[112:115], v[164:167], v[84:87]
  s_cmp_eq_u32 s89, 0
  s_cselect_b32 s3, s3, 2211840
  v_mfma_f32_16x16x32_bf16 v[84:87], a[116:119], v[180:183], v[84:87]
  buffer_store_dwordx4 v[112:115], v23, s[24:27], s60 offen offset:512 sc1
  v_mfma_f32_16x16x32_bf16 v[88:91], a[120:123], v[160:163], v[88:91]
  ds_read_b64_tr_b16 a[112:113], v2 offset:24576
  ds_read_b64_tr_b16 a[114:115], v2 offset:26624
  v_mfma_f32_16x16x32_bf16 v[88:91], a[124:127], v[176:179], v[88:91]
  ds_read_b64_tr_b16 a[116:117], v2 offset:28672
  ds_read_b64_tr_b16 a[118:119], v2 offset:30720
  v_mfma_f32_16x16x32_bf16 v[92:95], a[120:123], v[164:167], v[92:95]
  s_waitcnt lgkmcnt(12)
  v_cvt_pk_bf16_f32 v100, v100, v101
  v_mfma_f32_16x16x32_bf16 v[92:95], a[124:127], v[180:183], v[92:95]
  ds_read_b64_tr_b16 a[120:121], v3 offset:24576
  v_cvt_pk_bf16_f32 v101, v102, v103
  v_mfma_f32_16x16x32_bf16 v[64:67], a[64:67], v[192:195], v[64:67]
  ds_read_b64_tr_b16 a[122:123], v3 offset:26624
  ds_read_b64_tr_b16 a[124:125], v3 offset:28672
  v_mfma_f32_16x16x32_bf16 v[64:67], a[68:71], v[208:211], v[64:67]
  ds_read_b64_tr_b16 a[126:127], v3 offset:30720
  v_cvt_pk_bf16_f32 v102, v108, v109
  v_mfma_f32_16x16x32_bf16 v[68:71], a[64:67], v[196:199], v[68:71]
  v_cvt_pk_bf16_f32 v103, v110, v111
  v_add_u32 v0, 65536, v0
  v_mfma_f32_16x16x32_bf16 v[68:71], a[68:71], v[212:215], v[68:71]
  v_add_u32 v1, 65536, v1
  v_add_u32 v2, 65536, v2
  v_mfma_f32_16x16x32_bf16 v[72:75], a[72:75], v[192:195], v[72:75]
  v_permlane32_swap_b32 v100, v102
  v_add_u32 v3, 65536, v3
  v_mfma_f32_16x16x32_bf16 v[72:75], a[76:79], v[208:211], v[72:75]
  v_mov_b32 v48, 1
  v_mfma_f32_16x16x32_bf16 v[76:79], a[72:75], v[196:199], v[76:79]
  v_permlane32_swap_b32 v101, v103
  v_mfma_f32_16x16x32_bf16 v[76:79], a[76:79], v[212:215], v[76:79]
  s_waitcnt vmcnt(26) lgkmcnt(0)
  s_barrier
  v_mfma_f32_16x16x32_bf16 v[80:83], a[80:83], v[192:195], v[80:83]
  buffer_store_dwordx4 v[100:103], v23, s[24:27], s61 offen offset:0 sc1
  v_mfma_f32_16x16x32_bf16 v[80:83], a[84:87], v[208:211], v[80:83]
  ds_read_b64_tr_b16 a[64:65], v0 offset:0
  ds_read_b64_tr_b16 a[66:67], v0 offset:2048
  v_mfma_f32_16x16x32_bf16 v[84:87], a[80:83], v[196:199], v[84:87]
  ds_read_b64_tr_b16 a[68:69], v0 offset:4096
  ds_read_b64_tr_b16 a[70:71], v0 offset:6144
  v_mfma_f32_16x16x32_bf16 v[84:87], a[84:87], v[212:215], v[84:87]
  ds_read_b64_tr_b16 a[72:73], v1 offset:0
  ds_read_b64_tr_b16 a[74:75], v1 offset:2048
  ds_read_b64_tr_b16 a[76:77], v1 offset:4096
  ds_read_b64_tr_b16 a[78:79], v1 offset:6144
  v_cvt_pk_bf16_f32 v116, v116, v117
  v_mfma_f32_16x16x32_bf16 v[88:91], a[88:91], v[192:195], v[88:91]
  ds_read_b64_tr_b16 a[80:81], v2 offset:0
  v_cvt_pk_bf16_f32 v117, v118, v119
  v_mfma_f32_16x16x32_bf16 v[88:91], a[92:95], v[208:211], v[88:91]
  ds_read_b64_tr_b16 a[82:83], v2 offset:2048
  ds_read_b64_tr_b16 a[84:85], v2 offset:4096
  v_mfma_f32_16x16x32_bf16 v[92:95], a[88:91], v[196:199], v[92:95]
  ds_read_b64_tr_b16 a[86:87], v2 offset:6144
  v_cvt_pk_bf16_f32 v118, v124, v125
  v_mfma_f32_16x16x32_bf16 v[92:95], a[92:95], v[212:215], v[92:95]
  ds_read_b64_tr_b16 a[88:89], v3 offset:0
  v_cvt_pk_bf16_f32 v119, v126, v127
  v_mfma_f32_16x16x32_bf16 v[64:67], a[96:99], v[224:227], v[64:67]
  ds_read_b64_tr_b16 a[90:91], v3 offset:2048
  ds_read_b64_tr_b16 a[92:93], v3 offset:4096
  v_mfma_f32_16x16x32_bf16 v[64:67], a[100:103], v[240:243], v[64:67]
  ds_read_b64_tr_b16 a[94:95], v3 offset:6144
  v_permlane32_swap_b32 v116, v118
  v_mfma_f32_16x16x32_bf16 v[68:71], a[96:99], v[228:231], v[68:71]
  v_permlane32_swap_b32 v117, v119
  v_mfma_f32_16x16x32_bf16 v[68:71], a[100:103], v[244:247], v[68:71]
  ds_read_b64_tr_b16 a[96:97], v0 offset:8192
  ds_read_b64_tr_b16 a[98:99], v0 offset:10240
  v_mfma_f32_16x16x32_bf16 v[72:75], a[104:107], v[224:227], v[72:75]
  ds_read_b64_tr_b16 a[100:101], v0 offset:12288
  ds_read_b64_tr_b16 a[102:103], v0 offset:14336
  v_mfma_f32_16x16x32_bf16 v[72:75], a[108:111], v[240:243], v[72:75]
  buffer_store_dwordx4 v[116:119], v23, s[24:27], s61 offen offset:512 sc1
  v_mfma_f32_16x16x32_bf16 v[76:79], a[104:107], v[228:231], v[76:79]
  s_nop 0
  v_add_u32 v23, 1024, v23
  v_mfma_f32_16x16x32_bf16 v[76:79], a[108:111], v[244:247], v[76:79]
  ds_read_b64_tr_b16 a[104:105], v1 offset:8192
  ds_read_b64_tr_b16 a[106:107], v1 offset:10240
  v_mfma_f32_16x16x32_bf16 v[80:83], a[112:115], v[224:227], v[80:83]
  ds_read_b64_tr_b16 a[108:109], v1 offset:12288
  ds_read_b64_tr_b16 a[110:111], v1 offset:14336
  v_mfma_f32_16x16x32_bf16 v[80:83], a[116:119], v[240:243], v[80:83]
  s_cmp_eq_u32 s32, 0
  s_cselect_b64 s[92:93], 1, 0
  v_mfma_f32_16x16x32_bf16 v[84:87], a[112:115], v[228:231], v[84:87]
  v_mfma_f32_16x16x32_bf16 v[84:87], a[116:119], v[244:247], v[84:87]
  ds_read_b64_tr_b16 a[112:113], v2 offset:8192
  ds_read_b64_tr_b16 a[114:115], v2 offset:10240
  v_mfma_f32_16x16x32_bf16 v[88:91], a[120:123], v[224:227], v[88:91]
  ds_read_b64_tr_b16 a[116:117], v2 offset:12288
  ds_read_b64_tr_b16 a[118:119], v2 offset:14336
  v_mfma_f32_16x16x32_bf16 v[88:91], a[124:127], v[240:243], v[88:91]
  s_waitcnt lgkmcnt(12)
  v_mfma_f32_16x16x32_bf16 v[92:95], a[120:123], v[228:231], v[92:95]
  v_mfma_f32_16x16x32_bf16 v[92:95], a[124:127], v[244:247], v[92:95]
  ds_read_b64_tr_b16 a[120:121], v3 offset:8192
  ds_read_b64_tr_b16 a[122:123], v3 offset:10240
  v_mfma_f32_16x16x32_bf16 v[96:99], a[64:67], v[128:131], 0
  ds_read_b64_tr_b16 a[124:125], v3 offset:12288
  ds_read_b64_tr_b16 a[126:127], v3 offset:14336
  v_mfma_f32_16x16x32_bf16 v[96:99], a[68:71], v[144:147], v[96:99]
  v_mfma_f32_16x16x32_bf16 v[100:103], a[64:67], v[132:135], 0
  v_mfma_f32_16x16x32_bf16 v[100:103], a[68:71], v[148:151], v[100:103]
  ds_read_b64_tr_b16 a[64:65], v0 offset:16384
  ds_read_b64_tr_b16 a[66:67], v0 offset:18432
  v_mfma_f32_16x16x32_bf16 v[104:107], a[72:75], v[128:131], 0
  ds_read_b64_tr_b16 a[68:69], v0 offset:20480
  ds_read_b64_tr_b16 a[70:71], v0 offset:22528
  v_mfma_f32_16x16x32_bf16 v[104:107], a[76:79], v[144:147], v[104:107]
  v_cvt_pk_bf16_f32 v64, v64, v65
  v_cvt_pk_bf16_f32 v65, v66, v67
  v_mfma_f32_16x16x32_bf16 v[108:111], a[72:75], v[132:135], 0
  v_mfma_f32_16x16x32_bf16 v[108:111], a[76:79], v[148:151], v[108:111]
  ds_read_b64_tr_b16 a[72:73], v1 offset:16384
  v_cvt_pk_bf16_f32 v66, v72, v73
  v_mfma_f32_16x16x32_bf16 v[112:115], a[80:83], v[128:131], 0
  ds_read_b64_tr_b16 a[74:75], v1 offset:18432
  ds_read_b64_tr_b16 a[76:77], v1 offset:20480
  v_mfma_f32_16x16x32_bf16 v[112:115], a[84:87], v[144:147], v[112:115]
  ds_read_b64_tr_b16 a[78:79], v1 offset:22528
  v_cvt_pk_bf16_f32 v67, v74, v75
  v_mfma_f32_16x16x32_bf16 v[116:119], a[80:83], v[132:135], 0
  v_mfma_f32_16x16x32_bf16 v[116:119], a[84:87], v[148:151], v[116:119]
  ds_read_b64_tr_b16 a[80:81], v2 offset:16384
  v_permlane32_swap_b32 v64, v66
  v_mfma_f32_16x16x32_bf16 v[120:123], a[88:91], v[128:131], 0
  ds_read_b64_tr_b16 a[82:83], v2 offset:18432
  ds_read_b64_tr_b16 a[84:85], v2 offset:20480
  v_mfma_f32_16x16x32_bf16 v[120:123], a[92:95], v[144:147], v[120:123]
  ds_read_b64_tr_b16 a[86:87], v2 offset:22528
  v_permlane32_swap_b32 v65, v67
  v_mfma_f32_16x16x32_bf16 v[124:127], a[88:91], v[132:135], 0
  s_waitcnt lgkmcnt(12)
  v_mfma_f32_16x16x32_bf16 v[124:127], a[92:95], v[148:151], v[124:127]
  buffer_store_dwordx4 v[64:67], v23, s[24:27], s60 offen offset:0 sc1
  v_mfma_f32_16x16x32_bf16 v[96:99], a[96:99], v[160:163], v[96:99]
  ds_read_b64_tr_b16 a[88:89], v3 offset:16384
  ds_read_b64_tr_b16 a[90:91], v3 offset:18432
  v_mfma_f32_16x16x32_bf16 v[96:99], a[100:103], v[176:179], v[96:99]
  ds_read_b64_tr_b16 a[92:93], v3 offset:20480
  ds_read_b64_tr_b16 a[94:95], v3 offset:22528
  v_mfma_f32_16x16x32_bf16 v[100:103], a[96:99], v[164:167], v[100:103]
  v_cvt_pk_bf16_f32 v80, v80, v81
  v_cvt_pk_bf16_f32 v81, v82, v83
  v_mfma_f32_16x16x32_bf16 v[100:103], a[100:103], v[180:183], v[100:103]
  ds_read_b64_tr_b16 a[96:97], v0 offset:24576
  ds_read_b64_tr_b16 a[98:99], v0 offset:26624
  v_mfma_f32_16x16x32_bf16 v[104:107], a[104:107], v[160:163], v[104:107]
  ds_read_b64_tr_b16 a[100:101], v0 offset:28672
  ds_read_b64_tr_b16 a[102:103], v0 offset:30720
  v_mfma_f32_16x16x32_bf16 v[104:107], a[108:111], v[176:179], v[104:107]
  v_cvt_pk_bf16_f32 v82, v88, v89
  v_cvt_pk_bf16_f32 v83, v90, v91
  v_mfma_f32_16x16x32_bf16 v[108:111], a[104:107], v[164:167], v[108:111]
  v_mfma_f32_16x16x32_bf16 v[108:111], a[108:111], v[180:183], v[108:111]
  ds_read_b64_tr_b16 a[104:105], v1 offset:24576
  v_permlane32_swap_b32 v80, v82
  v_mfma_f32_16x16x32_bf16 v[112:115], a[112:115], v[160:163], v[112:115]
  ds_read_b64_tr_b16 a[106:107], v1 offset:26624
  ds_read_b64_tr_b16 a[108:109], v1 offset:28672
  v_mfma_f32_16x16x32_bf16 v[112:115], a[116:119], v[176:179], v[112:115]
  ds_read_b64_tr_b16 a[110:111], v1 offset:30720
  v_permlane32_swap_b32 v81, v83
  v_mfma_f32_16x16x32_bf16 v[116:119], a[112:115], v[164:167], v[116:119]
  v_mfma_f32_16x16x32_bf16 v[116:119], a[116:119], v[180:183], v[116:119]
  buffer_store_dwordx4 v[80:83], v23, s[24:27], s60 offen offset:512 sc1
  v_mfma_f32_16x16x32_bf16 v[120:123], a[120:123], v[160:163], v[120:123]
  ds_read_b64_tr_b16 a[112:113], v2 offset:24576
  ds_read_b64_tr_b16 a[114:115], v2 offset:26624
  v_mfma_f32_16x16x32_bf16 v[120:123], a[124:127], v[176:179], v[120:123]
  ds_read_b64_tr_b16 a[116:117], v2 offset:28672
  ds_read_b64_tr_b16 a[118:119], v2 offset:30720
  v_mfma_f32_16x16x32_bf16 v[124:127], a[120:123], v[164:167], v[124:127]
  s_waitcnt lgkmcnt(12)
  v_cvt_pk_bf16_f32 v68, v68, v69
  v_mfma_f32_16x16x32_bf16 v[124:127], a[124:127], v[180:183], v[124:127]
  ds_read_b64_tr_b16 a[120:121], v3 offset:24576
  v_cvt_pk_bf16_f32 v69, v70, v71
  v_mfma_f32_16x16x32_bf16 v[96:99], a[64:67], v[192:195], v[96:99]
  ds_read_b64_tr_b16 a[122:123], v3 offset:26624
  ds_read_b64_tr_b16 a[124:125], v3 offset:28672
  v_mfma_f32_16x16x32_bf16 v[96:99], a[68:71], v[208:211], v[96:99]
  ds_read_b64_tr_b16 a[126:127], v3 offset:30720
  v_cvt_pk_bf16_f32 v70, v76, v77
  v_mfma_f32_16x16x32_bf16 v[100:103], a[64:67], v[196:199], v[100:103]
  v_cvt_pk_bf16_f32 v71, v78, v79
  v_add_u32 v0, 65536, v0
  v_mfma_f32_16x16x32_bf16 v[100:103], a[68:71], v[212:215], v[100:103]
  v_add_u32 v1, 65536, v1
  v_add_u32 v2, 65536, v2
  v_mfma_f32_16x16x32_bf16 v[104:107], a[72:75], v[192:195], v[104:107]
  v_permlane32_swap_b32 v68, v70
  v_add_u32 v3, 65536, v3
  v_mfma_f32_16x16x32_bf16 v[104:107], a[76:79], v[208:211], v[104:107]
  v_mfma_f32_16x16x32_bf16 v[108:111], a[72:75], v[196:199], v[108:111]
  v_permlane32_swap_b32 v69, v71
  v_mfma_f32_16x16x32_bf16 v[108:111], a[76:79], v[212:215], v[108:111]
  s_waitcnt vmcnt(20) lgkmcnt(0)
  s_barrier
  v_mfma_f32_16x16x32_bf16 v[112:115], a[80:83], v[192:195], v[112:115]
  buffer_store_dwordx4 v[68:71], v23, s[24:27], s61 offen offset:0 sc1
  v_mfma_f32_16x16x32_bf16 v[112:115], a[84:87], v[208:211], v[112:115]
  ds_read_b64_tr_b16 a[64:65], v0 offset:0
  ds_read_b64_tr_b16 a[66:67], v0 offset:2048
  v_mfma_f32_16x16x32_bf16 v[116:119], a[80:83], v[196:199], v[116:119]
  ds_read_b64_tr_b16 a[68:69], v0 offset:4096
  ds_read_b64_tr_b16 a[70:71], v0 offset:6144
  v_mfma_f32_16x16x32_bf16 v[116:119], a[84:87], v[212:215], v[116:119]
  ds_read_b64_tr_b16 a[72:73], v1 offset:0
  ds_read_b64_tr_b16 a[74:75], v1 offset:2048
  ds_read_b64_tr_b16 a[76:77], v1 offset:4096
  ds_read_b64_tr_b16 a[78:79], v1 offset:6144
  v_cvt_pk_bf16_f32 v84, v84, v85
  v_mfma_f32_16x16x32_bf16 v[120:123], a[88:91], v[192:195], v[120:123]
  ds_read_b64_tr_b16 a[80:81], v2 offset:0
  v_cvt_pk_bf16_f32 v85, v86, v87
  v_mfma_f32_16x16x32_bf16 v[120:123], a[92:95], v[208:211], v[120:123]
  ds_read_b64_tr_b16 a[82:83], v2 offset:2048
  ds_read_b64_tr_b16 a[84:85], v2 offset:4096
  v_mfma_f32_16x16x32_bf16 v[124:127], a[88:91], v[196:199], v[124:127]
  ds_read_b64_tr_b16 a[86:87], v2 offset:6144
  v_cvt_pk_bf16_f32 v86, v92, v93
  v_mfma_f32_16x16x32_bf16 v[124:127], a[92:95], v[212:215], v[124:127]
  ds_read_b64_tr_b16 a[88:89], v3 offset:0
  v_cvt_pk_bf16_f32 v87, v94, v95
  v_mfma_f32_16x16x32_bf16 v[96:99], a[96:99], v[224:227], v[96:99]
  ds_read_b64_tr_b16 a[90:91], v3 offset:2048
  ds_read_b64_tr_b16 a[92:93], v3 offset:4096
  v_mfma_f32_16x16x32_bf16 v[96:99], a[100:103], v[240:243], v[96:99]
  ds_read_b64_tr_b16 a[94:95], v3 offset:6144
  v_permlane32_swap_b32 v84, v86
  v_mfma_f32_16x16x32_bf16 v[100:103], a[96:99], v[228:231], v[100:103]
  v_permlane32_swap_b32 v85, v87
  v_mfma_f32_16x16x32_bf16 v[100:103], a[100:103], v[244:247], v[100:103]
  ds_read_b64_tr_b16 a[96:97], v0 offset:8192
  ds_read_b64_tr_b16 a[98:99], v0 offset:10240
  v_mfma_f32_16x16x32_bf16 v[104:107], a[104:107], v[224:227], v[104:107]
  ds_read_b64_tr_b16 a[100:101], v0 offset:12288
  ds_read_b64_tr_b16 a[102:103], v0 offset:14336
  v_mfma_f32_16x16x32_bf16 v[104:107], a[108:111], v[240:243], v[104:107]
  buffer_store_dwordx4 v[84:87], v23, s[24:27], s61 offen offset:512 sc1
  v_mfma_f32_16x16x32_bf16 v[108:111], a[104:107], v[228:231], v[108:111]
  s_nop 0
  v_add_u32 v23, 1024, v23
  v_mfma_f32_16x16x32_bf16 v[108:111], a[108:111], v[244:247], v[108:111]
  ds_read_b64_tr_b16 a[104:105], v1 offset:8192
  ds_read_b64_tr_b16 a[106:107], v1 offset:10240
  v_mfma_f32_16x16x32_bf16 v[112:115], a[112:115], v[224:227], v[112:115]
  ds_read_b64_tr_b16 a[108:109], v1 offset:12288
  ds_read_b64_tr_b16 a[110:111], v1 offset:14336
  v_mfma_f32_16x16x32_bf16 v[112:115], a[116:119], v[240:243], v[112:115]
  v_mfma_f32_16x16x32_bf16 v[116:119], a[112:115], v[228:231], v[116:119]
  v_mfma_f32_16x16x32_bf16 v[116:119], a[116:119], v[244:247], v[116:119]
  ds_read_b64_tr_b16 a[112:113], v2 offset:8192
  ds_read_b64_tr_b16 a[114:115], v2 offset:10240
  v_mfma_f32_16x16x32_bf16 v[120:123], a[120:123], v[224:227], v[120:123]
  ds_read_b64_tr_b16 a[116:117], v2 offset:12288
  ds_read_b64_tr_b16 a[118:119], v2 offset:14336
  v_mfma_f32_16x16x32_bf16 v[120:123], a[124:127], v[240:243], v[120:123]
  s_waitcnt lgkmcnt(12)
  v_mfma_f32_16x16x32_bf16 v[124:127], a[120:123], v[228:231], v[124:127]
  v_mfma_f32_16x16x32_bf16 v[124:127], a[124:127], v[244:247], v[124:127]
  ds_read_b64_tr_b16 a[120:121], v3 offset:8192
  ds_read_b64_tr_b16 a[122:123], v3 offset:10240
  v_mfma_f32_16x16x32_bf16 v[64:67], a[64:67], v[128:131], 0
  ds_read_b64_tr_b16 a[124:125], v3 offset:12288
  ds_read_b64_tr_b16 a[126:127], v3 offset:14336
  v_mfma_f32_16x16x32_bf16 v[64:67], a[68:71], v[144:147], v[64:67]
  v_mfma_f32_16x16x32_bf16 v[68:71], a[64:67], v[132:135], 0
  v_mfma_f32_16x16x32_bf16 v[68:71], a[68:71], v[148:151], v[68:71]
  ds_read_b64_tr_b16 a[64:65], v0 offset:16384
  ds_read_b64_tr_b16 a[66:67], v0 offset:18432
  v_mfma_f32_16x16x32_bf16 v[72:75], a[72:75], v[128:131], 0
  ds_read_b64_tr_b16 a[68:69], v0 offset:20480
  ds_read_b64_tr_b16 a[70:71], v0 offset:22528
  v_mfma_f32_16x16x32_bf16 v[72:75], a[76:79], v[144:147], v[72:75]
  v_cvt_pk_bf16_f32 v96, v96, v97
  v_cvt_pk_bf16_f32 v97, v98, v99
  v_mfma_f32_16x16x32_bf16 v[76:79], a[72:75], v[132:135], 0
  v_mfma_f32_16x16x32_bf16 v[76:79], a[76:79], v[148:151], v[76:79]
  ds_read_b64_tr_b16 a[72:73], v1 offset:16384
  v_cvt_pk_bf16_f32 v98, v104, v105
  v_mfma_f32_16x16x32_bf16 v[80:83], a[80:83], v[128:131], 0
  ds_read_b64_tr_b16 a[74:75], v1 offset:18432
  ds_read_b64_tr_b16 a[76:77], v1 offset:20480
  v_mfma_f32_16x16x32_bf16 v[80:83], a[84:87], v[144:147], v[80:83]
  ds_read_b64_tr_b16 a[78:79], v1 offset:22528
  v_cvt_pk_bf16_f32 v99, v106, v107
  v_mfma_f32_16x16x32_bf16 v[84:87], a[80:83], v[132:135], 0
  s_and_b32 s33, s2, 6
  v_mfma_f32_16x16x32_bf16 v[84:87], a[84:87], v[148:151], v[84:87]
  ds_read_b64_tr_b16 a[80:81], v2 offset:16384
  v_permlane32_swap_b32 v96, v98
  v_mfma_f32_16x16x32_bf16 v[88:91], a[88:91], v[128:131], 0
  ds_read_b64_tr_b16 a[82:83], v2 offset:18432
  ds_read_b64_tr_b16 a[84:85], v2 offset:20480
  v_mfma_f32_16x16x32_bf16 v[88:91], a[92:95], v[144:147], v[88:91]
  ds_read_b64_tr_b16 a[86:87], v2 offset:22528
  v_permlane32_swap_b32 v97, v99
  v_mfma_f32_16x16x32_bf16 v[92:95], a[88:91], v[132:135], 0
  s_waitcnt lgkmcnt(12)
  s_lshr_b32 s34, s2, 7
  v_mfma_f32_16x16x32_bf16 v[92:95], a[92:95], v[148:151], v[92:95]
  buffer_store_dwordx4 v[96:99], v23, s[24:27], s60 offen offset:0 sc1
  v_mfma_f32_16x16x32_bf16 v[64:67], a[96:99], v[160:163], v[64:67]
  ds_read_b64_tr_b16 a[88:89], v3 offset:16384
  ds_read_b64_tr_b16 a[90:91], v3 offset:18432
  v_mfma_f32_16x16x32_bf16 v[64:67], a[100:103], v[176:179], v[64:67]
  ds_read_b64_tr_b16 a[92:93], v3 offset:20480
  ds_read_b64_tr_b16 a[94:95], v3 offset:22528
  v_mfma_f32_16x16x32_bf16 v[68:71], a[96:99], v[164:167], v[68:71]
  v_cvt_pk_bf16_f32 v112, v112, v113
  v_cvt_pk_bf16_f32 v113, v114, v115
  v_mfma_f32_16x16x32_bf16 v[68:71], a[100:103], v[180:183], v[68:71]
  s_add_u32 s33, s33, s34
  s_bfe_u32 s34, s2, 0x40003
  v_mfma_f32_16x16x32_bf16 v[72:75], a[104:107], v[160:163], v[72:75]
  ds_read_b64_tr_b16 a[96:97], v0 offset:24576
  ds_read_b64_tr_b16 a[98:99], v0 offset:26624
  v_mfma_f32_16x16x32_bf16 v[72:75], a[108:111], v[176:179], v[72:75]
  ds_read_b64_tr_b16 a[100:101], v0 offset:28672
  ds_read_b64_tr_b16 a[102:103], v0 offset:30720
  v_mfma_f32_16x16x32_bf16 v[76:79], a[104:107], v[164:167], v[76:79]
  v_cvt_pk_bf16_f32 v114, v120, v121
  s_and_b32 s35, s2, 1
  v_mfma_f32_16x16x32_bf16 v[76:79], a[108:111], v[180:183], v[76:79]
  v_cvt_pk_bf16_f32 v115, v122, v123
  s_lshl_b32 s35, s35, 4
  v_mfma_f32_16x16x32_bf16 v[80:83], a[112:115], v[160:163], v[80:83]
  v_permlane32_swap_b32 v112, v114
  s_add_u32 s34, s34, s35
  v_mfma_f32_16x16x32_bf16 v[80:83], a[116:119], v[176:179], v[80:83]
  ds_read_b64_tr_b16 a[104:105], v1 offset:24576
  ds_read_b64_tr_b16 a[106:107], v1 offset:26624
  v_mfma_f32_16x16x32_bf16 v[84:87], a[112:115], v[164:167], v[84:87]
  ds_read_b64_tr_b16 a[108:109], v1 offset:28672
  ds_read_b64_tr_b16 a[110:111], v1 offset:30720
  s_and_b32 s36, s2, 6
  v_mfma_f32_16x16x32_bf16 v[84:87], a[116:119], v[180:183], v[84:87]
  v_permlane32_swap_b32 v113, v115
  s_mul_i32 s36, s36, 14
  v_mfma_f32_16x16x32_bf16 v[88:91], a[120:123], v[160:163], v[88:91]
  s_lshr_b32 s38, s2, 3
  ds_read_b64_tr_b16 a[112:113], v2 offset:24576
  v_mfma_f32_16x16x32_bf16 v[88:91], a[124:127], v[176:179], v[88:91]
  buffer_store_dwordx4 v[112:115], v23, s[24:27], s60 offen offset:512 sc1
  v_mfma_f32_16x16x32_bf16 v[92:95], a[120:123], v[164:167], v[92:95]
  ds_read_b64_tr_b16 a[114:115], v2 offset:26624
  ds_read_b64_tr_b16 a[116:117], v2 offset:28672
  ds_read_b64_tr_b16 a[118:119], v2 offset:30720
  s_add_u32 s36, s36, s38
  v_mfma_f32_16x16x32_bf16 v[92:95], a[124:127], v[180:183], v[92:95]
  s_waitcnt lgkmcnt(12)
  v_cvt_pk_bf16_f32 v100, v100, v101
  s_and_b32 s38, s36, 15
  v_mfma_f32_16x16x32_bf16 v[64:67], a[64:67], v[192:195], v[64:67]
  v_cvt_pk_bf16_f32 v101, v102, v103
  s_add_u32 s38, s38, s35
  v_mfma_f32_16x16x32_bf16 v[64:67], a[68:71], v[208:211], v[64:67]
  s_lshr_b32 s36, s36, 4
  ds_read_b64_tr_b16 a[120:121], v3 offset:24576
  v_mfma_f32_16x16x32_bf16 v[68:71], a[64:67], v[196:199], v[68:71]
  ds_read_b64_tr_b16 a[122:123], v3 offset:26624
  ds_read_b64_tr_b16 a[124:125], v3 offset:28672
  ds_read_b64_tr_b16 a[126:127], v3 offset:30720
  v_cvt_pk_bf16_f32 v102, v108, v109
  s_cmp_ge_u32 s2, 224
  s_cselect_b32 s36, 7, s36
  v_mfma_f32_16x16x32_bf16 v[68:71], a[68:71], v[212:215], v[68:71]
  v_cvt_pk_bf16_f32 v103, v110, v111
  v_add_u32 v0, 4294934528, v0
  v_mfma_f32_16x16x32_bf16 v[72:75], a[72:75], v[192:195], v[72:75]
  s_cmp_eq_u32 s89, 0
  s_cselect_b32 s33, s36, s33
  s_cselect_b32 s34, s38, s34
  v_mfma_f32_16x16x32_bf16 v[72:75], a[76:79], v[208:211], v[72:75]
  s_and_b32 s95, s88, 7
  v_permlane32_swap_b32 v100, v102
  v_mfma_f32_16x16x32_bf16 v[76:79], a[72:75], v[196:199], v[76:79]
  s_lshl_b32 s95, s95, 5
  v_add_u32 v1, 4294934528, v1
  v_mfma_f32_16x16x32_bf16 v[76:79], a[76:79], v[212:215], v[76:79]
  v_add_u32 v2, 4294934528, v2
  v_add_u32 v3, 4294934528, v3
  s_lshr_b32 s31, s88, 3
  s_waitcnt vmcnt(14) lgkmcnt(0)
  s_barrier
  v_mfma_f32_16x16x32_bf16 v[80:83], a[80:83], v[192:195], v[80:83]
  v_permlane32_swap_b32 v101, v103
  s_add_u32 s95, s95, s31
  v_mfma_f32_16x16x32_bf16 v[80:83], a[84:87], v[208:211], v[80:83]
  buffer_store_dwordx4 v[100:103], v23, s[24:27], s61 offen offset:0 sc1
  v_mfma_f32_16x16x32_bf16 v[84:87], a[80:83], v[196:199], v[84:87]
  s_mul_i32 s56, s95, 7168
  ds_read_b64_tr_b16 a[64:65], v0 offset:0
  v_mfma_f32_16x16x32_bf16 v[84:87], a[84:87], v[212:215], v[84:87]
  ds_read_b64_tr_b16 a[66:67], v0 offset:2048
  ds_read_b64_tr_b16 a[68:69], v0 offset:4096
  ds_read_b64_tr_b16 a[70:71], v0 offset:6144
  ds_read_b64_tr_b16 a[72:73], v1 offset:0
  ds_read_b64_tr_b16 a[74:75], v1 offset:2048
  ds_read_b64_tr_b16 a[76:77], v1 offset:4096
  ds_read_b64_tr_b16 a[78:79], v1 offset:6144
  v_cvt_pk_bf16_f32 v116, v116, v117
  s_add_u32 s50, s56, 3145728
  v_mfma_f32_16x16x32_bf16 v[88:91], a[88:91], v[192:195], v[88:91]
  s_mul_i32 s54, s95, 114688
  v_cvt_pk_bf16_f32 v117, v118, v119
  v_mfma_f32_16x16x32_bf16 v[88:91], a[92:95], v[208:211], v[88:91]
  s_add_u32 s54, s54, 8388608
  ds_read_b64_tr_b16 a[80:81], v2 offset:0
  v_mfma_f32_16x16x32_bf16 v[92:95], a[88:91], v[196:199], v[92:95]
  ds_read_b64_tr_b16 a[82:83], v2 offset:2048
  ds_read_b64_tr_b16 a[84:85], v2 offset:4096
  ds_read_b64_tr_b16 a[86:87], v2 offset:6144
  v_mfma_f32_16x16x32_bf16 v[92:95], a[92:95], v[212:215], v[92:95]
  v_cvt_pk_bf16_f32 v118, v124, v125
  v_and_b32 v40, 7, v24
  v_mfma_f32_16x16x32_bf16 v[64:67], a[96:99], v[224:227], v[64:67]
  v_lshrrev_b32 v41, 3, v24
  v_cvt_pk_bf16_f32 v119, v126, v127
  v_mfma_f32_16x16x32_bf16 v[64:67], a[100:103], v[240:243], v[64:67]
  s_lshl_b32 s52, s32, 3
  ds_read_b64_tr_b16 a[88:89], v3 offset:0
  v_mfma_f32_16x16x32_bf16 v[68:71], a[96:99], v[228:231], v[68:71]
  ds_read_b64_tr_b16 a[90:91], v3 offset:2048
  ds_read_b64_tr_b16 a[92:93], v3 offset:4096
  ds_read_b64_tr_b16 a[94:95], v3 offset:6144
  v_permlane32_swap_b32 v116, v118
  v_add_u32 v41, s52, v41
  v_mfma_f32_16x16x32_bf16 v[68:71], a[100:103], v[244:247], v[68:71]
  v_mul_u32_u24 v202, 896, v40
  v_permlane32_swap_b32 v117, v119
  v_mfma_f32_16x16x32_bf16 v[72:75], a[104:107], v[224:227], v[72:75]
  ds_read_b64_tr_b16 a[96:97], v0 offset:8192
  v_lshl_add_u32 v202, v41, 4, v202
  v_mfma_f32_16x16x32_bf16 v[72:75], a[108:111], v[240:243], v[72:75]
  ds_read_b64_tr_b16 a[98:99], v0 offset:10240
  ds_read_b64_tr_b16 a[100:101], v0 offset:12288
  v_mfma_f32_16x16x32_bf16 v[76:79], a[104:107], v[228:231], v[76:79]
  ds_read_b64_tr_b16 a[102:103], v0 offset:14336
  buffer_store_dwordx4 v[116:119], v23, s[24:27], s61 offen offset:512 sc1
  v_lshlrev_b32 v6, 5, v41
  v_mfma_f32_16x16x32_bf16 v[76:79], a[108:111], v[244:247], v[76:79]
  v_lshlrev_b32 v32, 8, v41
  v_add_u32 v23, 1024, v23
  v_mfma_f32_16x16x32_bf16 v[80:83], a[112:115], v[224:227], v[80:83]
  v_lshl_add_u32 v32, v40, 4, v32
  v_and_b32 v42, 15, v24
  v_mfma_f32_16x16x32_bf16 v[80:83], a[116:119], v[240:243], v[80:83]
  ds_read_b64_tr_b16 a[104:105], v1 offset:8192
  ds_read_b64_tr_b16 a[106:107], v1 offset:10240
  v_mfma_f32_16x16x32_bf16 v[84:87], a[112:115], v[228:231], v[84:87]
  ds_read_b64_tr_b16 a[108:109], v1 offset:12288
  ds_read_b64_tr_b16 a[110:111], v1 offset:14336
  v_mfma_f32_16x16x32_bf16 v[84:87], a[116:119], v[244:247], v[84:87]
  s_lshl_b32 s52, s32, 10
  v_lshl_add_u32 v200, v42, 4, s52
  v_mfma_f32_16x16x32_bf16 v[88:91], a[120:123], v[224:227], v[88:91]
  s_waitcnt vmcnt(4)
  s_barrier
  s_mov_b64 exec, s[92:93]
  buffer_store_dword v48, off, s[24:27], s3 sc1
  s_mov_b64 exec, -1
  v_mfma_f32_16x16x32_bf16 v[88:91], a[124:127], v[240:243], v[88:91]
  ds_read_b64_tr_b16 a[112:113], v2 offset:8192
  v_bfe_u32 v42, v24, 4, 1
  v_mfma_f32_16x16x32_bf16 v[92:95], a[120:123], v[228:231], v[92:95]
  ds_read_b64_tr_b16 a[114:115], v2 offset:10240
  ds_read_b64_tr_b16 a[116:117], v2 offset:12288
  ds_read_b64_tr_b16 a[118:119], v2 offset:14336
  v_lshl_add_u32 v200, v42, 9, v200
  v_mfma_f32_16x16x32_bf16 v[92:95], a[124:127], v[244:247], v[92:95]
  s_waitcnt lgkmcnt(12)
  v_add_u32 v51, 1, v42
  v_mfma_f32_16x16x32_bf16 v[96:99], a[64:67], v[128:131], 0
  ds_read_b64_tr_b16 a[120:121], v3 offset:8192
  v_lshrrev_b32 v42, 5, v24
  v_mfma_f32_16x16x32_bf16 v[96:99], a[68:71], v[144:147], v[96:99]
  ds_read_b64_tr_b16 a[122:123], v3 offset:10240
  ds_read_b64_tr_b16 a[124:125], v3 offset:12288
  v_mfma_f32_16x16x32_bf16 v[100:103], a[64:67], v[132:135], 0
  ds_read_b64_tr_b16 a[126:127], v3 offset:14336
  v_mul_u32_u24 v42, 7168, v42
  v_mfma_f32_16x16x32_bf16 v[100:103], a[68:71], v[148:151], v[100:103]
  ds_read_b64_tr_b16 a[64:65], v0 offset:16384
  v_add_u32 v200, v200, v42
  v_mfma_f32_16x16x32_bf16 v[104:107], a[72:75], v[128:131], 0
  s_cmp_eq_u32 s32, 3
  s_cselect_b32 s52, 0x80000000, 0
  v_mfma_f32_16x16x32_bf16 v[104:107], a[76:79], v[144:147], v[104:107]
  s_add_u32 s53, s52, 4096
  ds_read_b64_tr_b16 a[66:67], v0 offset:18432
  v_mfma_f32_16x16x32_bf16 v[108:111], a[72:75], v[132:135], 0
  ds_read_b64_tr_b16 a[68:69], v0 offset:20480
  ds_read_b64_tr_b16 a[70:71], v0 offset:22528
  v_cvt_pk_bf16_f32 v64, v64, v65
  v_cvt_pk_bf16_f32 v65, v66, v67
  v_mfma_f32_16x16x32_bf16 v[108:111], a[76:79], v[148:151], v[108:111]
  v_cvt_pk_bf16_f32 v66, v72, v73
  v_add_u32 v201, s53, v200
  v_mfma_f32_16x16x32_bf16 v[112:115], a[80:83], v[128:131], 0
  v_cvt_pk_bf16_f32 v67, v74, v75
  s_add_u32 s53, s52, 512
  v_mfma_f32_16x16x32_bf16 v[112:115], a[84:87], v[144:147], v[112:115]
  v_permlane32_swap_b32 v64, v66
  v_add_u32 v203, s53, v202
  v_mfma_f32_16x16x32_bf16 v[116:119], a[80:83], v[132:135], 0
  ds_read_b64_tr_b16 a[72:73], v1 offset:16384
  ds_read_b64_tr_b16 a[74:75], v1 offset:18432
  ds_read_b64_tr_b16 a[76:77], v1 offset:20480
  ds_read_b64_tr_b16 a[78:79], v1 offset:22528
  v_permlane32_swap_b32 v65, v67
  s_add_u32 s53, s52, 1024
  v_mfma_f32_16x16x32_bf16 v[116:119], a[84:87], v[148:151], v[116:119]
  buffer_store_dwordx4 v[64:67], v23, s[24:27], s60 offen offset:0 sc1
  v_mfma_f32_16x16x32_bf16 v[120:123], a[88:91], v[128:131], 0
  v_cvt_pk_bf16_f32 v80, v80, v81
  v_add_u32 v7, s53, v6
  v_mfma_f32_16x16x32_bf16 v[120:123], a[92:95], v[144:147], v[120:123]
  v_cvt_pk_bf16_f32 v81, v82, v83
  s_add_u32 s53, s52, 8192
  v_mfma_f32_16x16x32_bf16 v[124:127], a[88:91], v[132:135], 0
  ds_read_b64_tr_b16 a[80:81], v2 offset:16384
  ds_read_b64_tr_b16 a[82:83], v2 offset:18432
  ds_read_b64_tr_b16 a[84:85], v2 offset:20480
  ds_read_b64_tr_b16 a[86:87], v2 offset:22528
  v_cvt_pk_bf16_f32 v82, v88, v89
  v_add_u32 v33, s53, v32
  v_mfma_f32_16x16x32_bf16 v[124:127], a[92:95], v[148:151], v[124:127]
  s_waitcnt lgkmcnt(12)
  v_cvt_pk_bf16_f32 v83, v90, v91
  s_cmp_lg_u32 s90, 0
  s_cselect_b32 s52, 0x80000000, 0
  v_mfma_f32_16x16x32_bf16 v[96:99], a[96:99], v[160:163], v[96:99]
  v_permlane32_swap_b32 v80, v82
  v_or_b32 v6, s52, v6
  v_mfma_f32_16x16x32_bf16 v[96:99], a[100:103], v[176:179], v[96:99]
  ds_read_b64_tr_b16 a[88:89], v3 offset:16384
  v_permlane32_swap_b32 v81, v83
  v_mfma_f32_16x16x32_bf16 v[100:103], a[96:99], v[164:167], v[100:103]
  ds_read_b64_tr_b16 a[90:91], v3 offset:18432
  ds_read_b64_tr_b16 a[92:93], v3 offset:20480
  ds_read_b64_tr_b16 a[94:95], v3 offset:22528
  buffer_store_dwordx4 v[80:83], v23, s[24:27], s60 offen offset:512 sc1
  v_or_b32 v7, s52, v7
  v_mfma_f32_16x16x32_bf16 v[100:103], a[100:103], v[180:183], v[100:103]
  v_cvt_pk_bf16_f32 v68, v68, v69
  s_mov_b64 s[20:21], s[18:19]
  v_mfma_f32_16x16x32_bf16 v[104:107], a[104:107], v[160:163], v[104:107]
  v_cvt_pk_bf16_f32 v69, v70, v71
  s_mov_b32 s22, 1835008
  v_mfma_f32_16x16x32_bf16 v[104:107], a[108:111], v[176:179], v[104:107]
  v_cvt_pk_bf16_f32 v70, v76, v77
  s_mov_b32 s23, 0x20000
  v_mfma_f32_16x16x32_bf16 v[108:111], a[104:107], v[164:167], v[108:111]
  ds_read_b64_tr_b16 a[96:97], v0 offset:24576
  ds_read_b64_tr_b16 a[98:99], v0 offset:26624
  ds_read_b64_tr_b16 a[100:101], v0 offset:28672
  ds_read_b64_tr_b16 a[102:103], v0 offset:30720
  v_cvt_pk_bf16_f32 v71, v78, v79
  s_mov_b32 s57, 2101248
  v_mfma_f32_16x16x32_bf16 v[108:111], a[108:111], v[180:183], v[108:111]
  v_permlane32_swap_b32 v68, v70
  v_permlane32_swap_b32 v69, v71
  v_mfma_f32_16x16x32_bf16 v[112:115], a[112:115], v[160:163], v[112:115]
  s_mov_b32 s62, 2103296
  v_bfe_u32 v42, v24, 3, 1
  v_mfma_f32_16x16x32_bf16 v[112:115], a[116:119], v[176:179], v[112:115]
  buffer_store_dwordx4 v[68:71], v23, s[24:27], s61 offen offset:0 sc1
  v_mfma_f32_16x16x32_bf16 v[116:119], a[112:115], v[164:167], v[116:119]
  ds_read_b64_tr_b16 a[104:105], v1 offset:24576
  ds_read_b64_tr_b16 a[106:107], v1 offset:26624
  ds_read_b64_tr_b16 a[108:109], v1 offset:28672
  ds_read_b64_tr_b16 a[110:111], v1 offset:30720
  v_cvt_pk_bf16_f32 v84, v84, v85
  v_lshl_add_u32 v42, v40, 1, v42
  v_mfma_f32_16x16x32_bf16 v[116:119], a[116:119], v[180:183], v[116:119]
  v_cvt_pk_bf16_f32 v85, v86, v87
  s_lshr_b32 s51, s95, 4
  v_mfma_f32_16x16x32_bf16 v[120:123], a[120:123], v[160:163], v[120:123]
  v_cvt_pk_bf16_f32 v86, v92, v93
  s_lshl_b32 s51, s51, 11
  v_mfma_f32_16x16x32_bf16 v[120:123], a[124:127], v[176:179], v[120:123]
  ds_read_b64_tr_b16 a[112:113], v2 offset:24576
  v_cvt_pk_bf16_f32 v87, v94, v95
  v_mfma_f32_16x16x32_bf16 v[124:127], a[120:123], v[164:167], v[124:127]
  ds_read_b64_tr_b16 a[114:115], v2 offset:26624
  ds_read_b64_tr_b16 a[116:117], v2 offset:28672
  ds_read_b64_tr_b16 a[118:119], v2 offset:30720
  v_permlane32_swap_b32 v84, v86
  s_add_u32 s51, s51, 2113536
  v_mfma_f32_16x16x32_bf16 v[124:127], a[124:127], v[180:183], v[124:127]
  s_waitcnt lgkmcnt(12)
  v_permlane32_swap_b32 v85, v87
  v_lshl_add_u32 v50, v42, 7, s51
  v_mfma_f32_16x16x32_bf16 v[96:99], a[64:67], v[192:195], v[96:99]
  buffer_store_dwordx4 v[84:87], v23, s[24:27], s61 offen offset:512 sc1
  s_lshl_b32 s35, s34, 2
  v_mfma_f32_16x16x32_bf16 v[96:99], a[68:71], v[208:211], v[96:99]
  v_add_u32 v23, 1024, v23
  s_add_u32 s35, s35, s32
  v_mfma_f32_16x16x32_bf16 v[100:103], a[64:67], v[196:199], v[100:103]
  ds_read_b64_tr_b16 a[120:121], v3 offset:24576
  ds_read_b64_tr_b16 a[122:123], v3 offset:26624
  ds_read_b64_tr_b16 a[124:125], v3 offset:28672
  ds_read_b64_tr_b16 a[126:127], v3 offset:30720
  s_lshl_b32 s51, s35, 8
  v_mfma_f32_16x16x32_bf16 v[100:103], a[68:71], v[212:215], v[100:103]
  s_add_u32 s51, s51, 2146304
  v_and_b32 v42, 1, v24
  v_mfma_f32_16x16x32_bf16 v[104:107], a[72:75], v[192:195], v[104:107]
  v_lshl_add_u32 v42, v42, 7, s51
  s_mov_b32 s52, 0
  v_mfma_f32_16x16x32_bf16 v[104:107], a[76:79], v[208:211], v[104:107]
  s_mov_b32 s53, -1
  v_cndmask_b32 v50, v50, v42, s[52:53]
  v_mfma_f32_16x16x32_bf16 v[108:111], a[72:75], v[196:199], v[108:111]
  v_cndmask_b32 v51, v51, 1, s[52:53]
  s_mov_b32 s63, 0xff00ff
  v_mfma_f32_16x16x32_bf16 v[108:111], a[76:79], v[212:215], v[108:111]
  s_lshl_b32 s51, s95, 7
  s_add_u32 s51, s51, 2146304
  v_mfma_f32_16x16x32_bf16 v[112:115], a[80:83], v[192:195], v[112:115]
  s_mul_i32 s36, s32, 24576
  v_mfma_f32_16x16x32_bf16 v[112:115], a[84:87], v[208:211], v[112:115]
  s_lshl_b32 s43, s32, 6
  v_mfma_f32_16x16x32_bf16 v[116:119], a[80:83], v[196:199], v[116:119]
  v_lshrrev_b32 v42, 2, v24
  v_mfma_f32_16x16x32_bf16 v[116:119], a[84:87], v[212:215], v[116:119]
  v_and_b32 v43, 3, v24
  v_mfma_f32_16x16x32_bf16 v[120:123], a[88:91], v[192:195], v[120:123]
  v_mfma_f32_16x16x32_bf16 v[120:123], a[92:95], v[208:211], v[120:123]
  s_waitcnt lgkmcnt(0)
  v_mul_u32_u24 v44, 3584, v42
  v_mfma_f32_16x16x32_bf16 v[124:127], a[88:91], v[196:199], v[124:127]
  v_lshl_add_u32 v44, v43, 4, v44
  v_mfma_f32_16x16x32_bf16 v[124:127], a[92:95], v[212:215], v[124:127]
  v_add_u32 v8, s43, v44
  v_mfma_f32_16x16x32_bf16 v[96:99], a[96:99], v[224:227], v[96:99]
  v_add_u32 v9, 56320, v8
  v_mfma_f32_16x16x32_bf16 v[96:99], a[100:103], v[240:243], v[96:99]
  v_add_u32 v10, 112640, v8
  v_mfma_f32_16x16x32_bf16 v[100:103], a[96:99], v[228:231], v[100:103]
  v_mfma_f32_16x16x32_bf16 v[100:103], a[100:103], v[244:247], v[100:103]
  v_add_u32 v11, 168960, v8
  v_mfma_f32_16x16x32_bf16 v[104:107], a[104:107], v[224:227], v[104:107]
  s_lshl_b32 s38, s33, 9
  v_mfma_f32_16x16x32_bf16 v[104:107], a[108:111], v[240:243], v[104:107]
  s_sub_u32 s39, 1605632, s38
  v_mfma_f32_16x16x32_bf16 v[108:111], a[104:107], v[228:231], v[108:111]
  s_add_u32 s8, s4, s38
  s_addc_u32 s9, s5, 0
  v_mfma_f32_16x16x32_bf16 v[108:111], a[108:111], v[244:247], v[108:111]
  s_mov_b32 s10, s39
  v_mfma_f32_16x16x32_bf16 v[112:115], a[112:115], v[224:227], v[112:115]
  v_mfma_f32_16x16x32_bf16 v[112:115], a[116:119], v[240:243], v[112:115]
  s_mov_b32 s11, 0x20000
  v_mfma_f32_16x16x32_bf16 v[116:119], a[112:115], v[228:231], v[116:119]
  s_add_u32 s12, s6, s38
  s_addc_u32 s13, s7, 0
  v_mfma_f32_16x16x32_bf16 v[116:119], a[116:119], v[244:247], v[116:119]
  s_mov_b32 s14, s39
  v_mfma_f32_16x16x32_bf16 v[120:123], a[120:123], v[224:227], v[120:123]
  s_mov_b32 s15, 0x20000
  v_mfma_f32_16x16x32_bf16 v[120:123], a[124:127], v[240:243], v[120:123]
  v_mfma_f32_16x16x32_bf16 v[124:127], a[120:123], v[228:231], v[124:127]
  v_mfma_f32_16x16x32_bf16 v[124:127], a[124:127], v[244:247], v[124:127]
  v_cvt_pk_bf16_f32 v96, v96, v97
  v_cvt_pk_bf16_f32 v97, v98, v99
  v_cvt_pk_bf16_f32 v98, v104, v105
  v_cvt_pk_bf16_f32 v99, v106, v107
  s_nop 0
  v_permlane32_swap_b32 v96, v98
  v_permlane32_swap_b32 v97, v99
  buffer_store_dwordx4 v[96:99], v23, s[24:27], s60 offen offset:0 sc1
  v_cvt_pk_bf16_f32 v112, v112, v113
  v_cvt_pk_bf16_f32 v113, v114, v115
  v_cvt_pk_bf16_f32 v114, v120, v121
  v_cvt_pk_bf16_f32 v115, v122, v123
  s_nop 0
  v_permlane32_swap_b32 v112, v114
  v_permlane32_swap_b32 v113, v115
  buffer_store_dwordx4 v[112:115], v23, s[24:27], s60 offen offset:512 sc1
  v_cvt_pk_bf16_f32 v100, v100, v101
  v_cvt_pk_bf16_f32 v101, v102, v103
  v_cvt_pk_bf16_f32 v102, v108, v109
  v_cvt_pk_bf16_f32 v103, v110, v111
  s_nop 0
  v_permlane32_swap_b32 v100, v102
  v_permlane32_swap_b32 v101, v103
  buffer_store_dwordx4 v[100:103], v23, s[24:27], s61 offen offset:0 sc1
  v_cvt_pk_bf16_f32 v116, v116, v117
  v_cvt_pk_bf16_f32 v117, v118, v119
  v_cvt_pk_bf16_f32 v118, v124, v125
  v_cvt_pk_bf16_f32 v119, v126, v127
  s_nop 0
  v_permlane32_swap_b32 v116, v118
  v_permlane32_swap_b32 v117, v119
  buffer_store_dwordx4 v[116:119], v23, s[24:27], s61 offen offset:512 sc1
  s_nop 1
  v_add_u32 v23, 1024, v23
L_tail:
  s_cmp_lg_u32 s89, 0
  s_cbranch_scc1 L_next
  s_mov_b32 s96, -1
  s_mov_b32 s97, 37748736
  v_mov_b32 v0, v24
  v_mov_b32 v1, s32
  s_mov_b32 s59, s90
  v_mov_b32 v48, 2
  s_mov_b32 s30, 4000
L_r:
  v_bfrev_b32 v80, 1
  v_cndmask_b32 v80, v80, 0, s[92:93]
  buffer_load_dwordx4 v[216:219], v202, s[20:23], s56 offen
  buffer_load_dwordx4 v[128:131], v6, s[24:27], s57 offen offset:0
  buffer_load_dwordx4 v[144:147], v6, s[24:27], s57 offen offset:2048
  buffer_load_dwordx4 v[84:87], v6, s[24:27], s62 offen offset:2048
  buffer_load_dwordx4 v[132:135], v6, s[24:27], s57 offen offset:16
  buffer_load_dwordx4 v[148:151], v6, s[24:27], s57 offen offset:2064
  buffer_load_dwordx4 v[88:91], v6, s[24:27], s62 offen offset:2064
  buffer_load_dwordx4 v[220:223], v203, s[20:23], s56 offen
  buffer_load_dwordx4 v[136:139], v7, s[24:27], s57 offen offset:0
  buffer_load_dwordx4 v[152:155], v7, s[24:27], s57 offen offset:2048
  buffer_load_dwordx4 v[56:59], v7, s[24:27], s62 offen offset:2048
  buffer_load_dwordx4 v[140:143], v7, s[24:27], s57 offen offset:16
  buffer_load_dwordx4 v[156:159], v7, s[24:27], s57 offen offset:2064
  buffer_load_dwordx4 v[60:63], v7, s[24:27], s62 offen offset:2064
  s_add_u32 m0, s36, 0
  s_mov_b32 s42, 0
  buffer_load_dwordx4 v8, s[8:11], s42 offen offset:0 lds
  buffer_load_dwordx4 v9, s[8:11], s42 offen offset:1024 lds
  buffer_load_dwordx4 v10, s[8:11], s42 offen offset:2048 lds
  buffer_load_dwordx4 v11, s[8:11], s42 offen offset:3072 lds
  s_add_u32 m0, s36, 4096
  s_mov_b32 s42, 229376
  buffer_load_dwordx4 v8, s[8:11], s42 offen offset:0 lds
  buffer_load_dwordx4 v9, s[8:11], s42 offen offset:1024 lds
  buffer_load_dwordx4 v10, s[8:11], s42 offen offset:2048 lds
  buffer_load_dwordx4 v11, s[8:11], s42 offen offset:3072 lds
  s_add_u32 m0, s36, 8192
  s_mov_b32 s42, 458752
  buffer_load_dwordx4 v8, s[8:11], s42 offen offset:0 lds
  buffer_load_dwordx4 v9, s[8:11], s42 offen offset:1024 lds
  buffer_load_dwordx4 v10, s[8:11], s42 offen offset:2048 lds
  buffer_load_dwordx4 v11, s[8:11], s42 offen offset:3072 lds
  s_add_u32 m0, s36, 12288
  s_mov_b32 s42, 688128
  buffer_load_dwordx4 v8, s[8:11], s42 offen offset:0 lds
  buffer_load_dwordx4 v9, s[8:11], s42 offen offset:1024 lds
  buffer_load_dwordx4 v10, s[8:11], s42 offen offset:2048 lds
  buffer_load_dwordx4 v11, s[8:11], s42 offen offset:3072 lds
  s_add_u32 m0, s36, 16384
  s_mov_b32 s42, 917504
  buffer_load_dwordx4 v8, s[8:11], s42 offen offset:0 lds
  buffer_load_dwordx4 v9, s[8:11], s42 offen offset:1024 lds
  buffer_load_dwordx4 v10, s[8:11], s42 offen offset:2048 lds
  buffer_load_dwordx4 v11, s[8:11], s42 offen offset:3072 lds
  s_add_u32 m0, s36, 20480
  s_mov_b32 s42, 1146880
  buffer_load_dwordx4 v8, s[8:11], s42 offen offset:0 lds
  buffer_load_dwordx4 v9, s[8:11], s42 offen offset:1024 lds
  buffer_load_dwordx4 v10, s[8:11], s42 offen offset:2048 lds
  buffer_load_dwordx4 v11, s[8:11], s42 offen offset:3072 lds
  s_load_dwordx2 s[20:21], s[0:1], 88
  v_lshrrev_b32 v42, 1, v0
  v_xor_b32 v43, v42, v0
  v_and_b32 v43, 8, v43
  v_and_b32 v42, 3, v42
  v_add_u32 v42, v42, v43
  v_and_b32 v43, 1, v0
  v_lshlrev_b32 v43, 4, v43
  s_movk_i32 s41, 0x3f80
  v_lshlrev_b32 v43, v43, s41
  v_cmp_eq_u32 vcc, 0, v42
  s_nop 1
  v_cndmask_b32 v204, 0, v43, vcc
  v_cmp_eq_u32 vcc, 1, v42
  s_nop 1
  v_cndmask_b32 v205, 0, v43, vcc
  v_cmp_eq_u32 vcc, 2, v42
  s_nop 1
  v_cndmask_b32 v206, 0, v43, vcc
  v_cmp_eq_u32 vcc, 3, v42
  s_nop 1
  v_cndmask_b32 v207, 0, v43, vcc
  v_lshlrev_b32 v39, 3, v40
  v_add_u32 v39, 155648, v39
  v_lshl_add_u32 v38, v1, 6, v39
  s_lshr_b32 s52, s95, 1
  s_and_b32 s53, s95, 1
  s_lshl_b32 s53, s53, 7
  s_mul_i32 s55, s52, 14336
  s_add_u32 s55, s55, s53
  s_add_u32 s55, s55, 5242880
  v_lshlrev_b32 v25, 4, v0
  s_mul_i32 s35, s35, 14336
  s_add_u32 s35, s35, 5242880
  s_mul_i32 s37, s32, 14336
  s_add_u32 s37, s37, 98304
  v_lshlrev_b32 v34, 7, v0
  v_add_u32 v35, 8192, v34
  v_min_u32 v35, 14208, v35
  v_lshrrev_b32 v42, 2, v0
  v_and_b32 v44, 3, v0
  v_mul_u32_u24 v45, 896, v42
  v_lshl_add_u32 v45, v44, 4, v45
  v_add_u32 v12, s43, v45
  s_and_b32 s38, s43, 64
  s_add_u32 s39, s38, 768
  v_add_u32 v16, s39, v45
  v_add_u32 v13, 13312, v12
  v_add_u32 v17, 13312, v16
  v_add_u32 v14, 26624, v12
  v_add_u32 v18, 26624, v16
  v_add_u32 v15, 39936, v12
  v_add_u32 v19, 39936, v16
  v_lshrrev_b32 v45, 5, v0
  v_bfe_u32 v46, v0, 4, 1
  v_and_b32 v42, 3, v42
  v_lshl_add_u32 v42, v42, 1, v46
  v_lshl_add_u32 v42, v42, 5, s36
  v_lshl_add_u32 v43, v45, 9, v42
  v_lshl_add_u32 v20, v44, 3, v43
  v_lshl_add_u32 v42, v45, 8, v42
  v_and_b32 v43, 1, v0
  v_lshl_add_u32 v42, v43, 4, v42
  v_lshrrev_b32 v43, 1, v44
  v_lshl_add_u32 v21, v43, 3, v42
  v_mul_u32_u24 v42, 14080, v46
  v_lshlrev_b32 v43, 8, v45
  v_sub_u32 v42, v42, v43
  v_add_u32 v43, 98304, v25
  v_add_u32 v26, v42, v43
  v_lshl_add_u32 v27, v1, 12, v43
  s_lshr_b32 s39, s32, 1
  v_lshl_add_u32 v22, s39, 11, v43
  v_xor_b32 v23, 2048, v22
  v_bfe_u32 v42, v0, 3, 2
  v_mul_u32_u24 v42, 50176, v42
  v_lshl_add_u32 v42, v40, 4, v42
  v_lshl_add_u32 v42, v45, 7, v42
  v_lshl_add_u32 v28, v1, 9, v42
  s_lshl_b32 s38, s38, 3
  s_add_u32 s38, s38, 6144
  v_add_u32 v29, s38, v42
  s_mul_i32 s44, s34, 56
  s_add_u32 s44, s44, s33
  s_mul_i32 s44, s44, 7168
  s_add_u32 s44, s44, s97
  s_mul_i32 s39, s39, 200704
  s_sub_u32 s45, 200704, s39
  s_add_u32 s45, s45, s44
  s_add_u32 s44, s44, s39
  s_add_u32 s46, s44, 4096
  s_add_u32 s47, s45, 4096
  v_mov_b32 v30, 0xbdd2d3e8
  v_mov_b32 v31, 0xc0135761
  s_mul_i32 s41, s33, 229376
  s_add_u32 s16, s28, s41
  s_addc_u32 s17, s29, 0
  s_mov_b32 s18, 229376
  s_mov_b32 s19, 0x20000
  buffer_load_dword v49, v50, s[24:27], 0 offen sc1
  s_waitcnt vmcnt(39)
  s_barrier
  buffer_store_dword v48, v80, s[24:27], s3 offen sc1
  s_waitcnt vmcnt(18)
  ds_read_b64_tr_b16 a[96:97], v20 offset:0
  ds_read_b64_tr_b16 a[98:99], v20 offset:256
  ds_read_b64_tr_b16 a[100:101], v20 offset:1024
  ds_read_b64_tr_b16 a[102:103], v20 offset:1280
  ds_read_b64_tr_b16 a[104:105], v20 offset:2048
  ds_read_b64_tr_b16 a[106:107], v20 offset:2304
  ds_read_b64_tr_b16 a[108:109], v20 offset:3072
  ds_read_b64_tr_b16 a[110:111], v20 offset:3328
  ds_read_b64_tr_b16 a[112:113], v20 offset:4096
  ds_read_b64_tr_b16 a[114:115], v20 offset:4352
  ds_read_b64_tr_b16 a[116:117], v20 offset:5120
  ds_read_b64_tr_b16 a[118:119], v20 offset:5376
  ds_read_b64_tr_b16 a[120:121], v20 offset:6144
  ds_read_b64_tr_b16 a[122:123], v20 offset:6400
  ds_read_b64_tr_b16 a[124:125], v20 offset:7168
  ds_read_b64_tr_b16 a[126:127], v20 offset:7424
  s_waitcnt vmcnt(10)
  ds_read_b64_tr_b16 v[96:97], v20 offset:8192
  ds_read_b64_tr_b16 v[98:99], v20 offset:8448
  ds_read_b64_tr_b16 v[100:101], v20 offset:9216
  ds_read_b64_tr_b16 v[102:103], v20 offset:9472
  ds_read_b64_tr_b16 v[104:105], v20 offset:10240
  ds_read_b64_tr_b16 v[106:107], v20 offset:10496
  ds_read_b64_tr_b16 v[108:109], v20 offset:11264
  ds_read_b64_tr_b16 v[110:111], v20 offset:11520
  ds_read_b64_tr_b16 v[112:113], v20 offset:12288
  ds_read_b64_tr_b16 v[114:115], v20 offset:12544
  ds_read_b64_tr_b16 v[116:117], v20 offset:13312
  ds_read_b64_tr_b16 v[118:119], v20 offset:13568
  ds_read_b64_tr_b16 v[120:121], v20 offset:14336
  ds_read_b64_tr_b16 v[122:123], v20 offset:14592
  ds_read_b64_tr_b16 v[124:125], v20 offset:15360
  ds_read_b64_tr_b16 v[126:127], v20 offset:15616
  s_waitcnt vmcnt(2)
  ds_read_b64_tr_b16 v[160:161], v20 offset:16384
  ds_read_b64_tr_b16 v[162:163], v20 offset:16640
  ds_read_b64_tr_b16 v[164:165], v20 offset:17408
  ds_read_b64_tr_b16 v[166:167], v20 offset:17664
  ds_read_b64_tr_b16 v[168:169], v20 offset:18432
  ds_read_b64_tr_b16 v[170:171], v20 offset:18688
  ds_read_b64_tr_b16 v[172:173], v20 offset:19456
  ds_read_b64_tr_b16 v[174:175], v20 offset:19712
  ds_read_b64_tr_b16 v[176:177], v20 offset:20480
  ds_read_b64_tr_b16 v[178:179], v20 offset:20736
  ds_read_b64_tr_b16 v[180:181], v20 offset:21504
  ds_read_b64_tr_b16 v[182:183], v20 offset:21760
  ds_read_b64_tr_b16 v[184:185], v20 offset:22528
  ds_read_b64_tr_b16 v[186:187], v20 offset:22784
  ds_read_b64_tr_b16 v[188:189], v20 offset:23552
  ds_read_b64_tr_b16 v[190:191], v20 offset:23808
  s_waitcnt vmcnt(1)
  v_cmp_le_u32 vcc, v51, v49
  s_nop 0
  s_lshr_b32 s31, vcc_lo, 8
  s_and_b32 s31, s31, vcc_lo
  s_and_b32 s31, s31, s63
  s_xor_b32 s63, s63, s31
  s_mov_b32 s94, vcc_hi
  s_mov_b32 s40, s63
  s_and_b32 s41, s31, 983055
  s_cbranch_scc0 L_rg0
  s_bitcmp1_b32 s31, 16
  s_cbranch_scc0 L_r_0_1
  s_add_u32 s41, s54, 0
  buffer_load_dwordx4 a[136:139], v201, s[24:27], s41 offen offset:0 sc1 nt
  buffer_load_dwordx4 a[140:143], v201, s[24:27], s41 offen offset:256 sc1 nt
L_r_0_1:
  s_bitcmp1_b32 s31, 0
  s_cbranch_scc0 L_r_0_0
  s_add_u32 s41, s54, 0
  buffer_load_dwordx4 a[128:131], v200, s[24:27], s41 offen offset:0 sc1 nt
  buffer_load_dwordx4 a[132:135], v200, s[24:27], s41 offen offset:256 sc1 nt
L_r_0_0:
  s_bitcmp1_b32 s31, 17
  s_cbranch_scc0 L_r_1_1
  s_add_u32 s41, s54, 14336
  buffer_load_dwordx4 a[152:155], v201, s[24:27], s41 offen offset:0 sc1 nt
  buffer_load_dwordx4 a[156:159], v201, s[24:27], s41 offen offset:256 sc1 nt
L_r_1_1:
  s_bitcmp1_b32 s31, 1
  s_cbranch_scc0 L_r_1_0
  s_add_u32 s41, s54, 14336
  buffer_load_dwordx4 a[144:147], v200, s[24:27], s41 offen offset:0 sc1 nt
  buffer_load_dwordx4 a[148:151], v200, s[24:27], s41 offen offset:256 sc1 nt
L_r_1_0:
  s_bitcmp1_b32 s31, 18
  s_cbranch_scc0 L_r_2_1
  s_add_u32 s41, s54, 28672
  buffer_load_dwordx4 a[168:171], v201, s[24:27], s41 offen offset:0 sc1 nt
  buffer_load_dwordx4 a[172:175], v201, s[24:27], s41 offen offset:256 sc1 nt
L_r_2_1:
  s_bitcmp1_b32 s31, 2
  s_cbranch_scc0 L_r_2_0
  s_add_u32 s41, s54, 28672
  buffer_load_dwordx4 a[160:163], v200, s[24:27], s41 offen offset:0 sc1 nt
  buffer_load_dwordx4 a[164:167], v200, s[24:27], s41 offen offset:256 sc1 nt
L_r_2_0:
  s_bitcmp1_b32 s31, 19
  s_cbranch_scc0 L_r_3_1
  s_add_u32 s41, s54, 43008
  buffer_load_dwordx4 a[184:187], v201, s[24:27], s41 offen offset:0 sc1 nt
  buffer_load_dwordx4 a[188:191], v201, s[24:27], s41 offen offset:256 sc1 nt
L_r_3_1:
  s_bitcmp1_b32 s31, 3
  s_cbranch_scc0 L_r_3_0
  s_add_u32 s41, s54, 43008
  buffer_load_dwordx4 a[176:179], v200, s[24:27], s41 offen offset:0 sc1 nt
  buffer_load_dwordx4 a[180:183], v200, s[24:27], s41 offen offset:256 sc1 nt
L_r_3_0:
L_rg0:
  s_and_b32 s41, s31, 15728880
  s_cbranch_scc0 L_rg1
  s_bitcmp1_b32 s31, 20
  s_cbranch_scc0 L_r_4_1
  s_add_u32 s41, s54, 57344
  buffer_load_dwordx4 a[200:203], v201, s[24:27], s41 offen offset:0 sc1 nt
  buffer_load_dwordx4 a[204:207], v201, s[24:27], s41 offen offset:256 sc1 nt
L_r_4_1:
  s_bitcmp1_b32 s31, 4
  s_cbranch_scc0 L_r_4_0
  s_add_u32 s41, s54, 57344
  buffer_load_dwordx4 a[192:195], v200, s[24:27], s41 offen offset:0 sc1 nt
  buffer_load_dwordx4 a[196:199], v200, s[24:27], s41 offen offset:256 sc1 nt
L_r_4_0:
  s_bitcmp1_b32 s31, 21
  s_cbranch_scc0 L_r_5_1
  s_add_u32 s41, s54, 71680
  buffer_load_dwordx4 a[216:219], v201, s[24:27], s41 offen offset:0 sc1 nt
  buffer_load_dwordx4 a[220:223], v201, s[24:27], s41 offen offset:256 sc1 nt
L_r_5_1:
  s_bitcmp1_b32 s31, 5
  s_cbranch_scc0 L_r_5_0
  s_add_u32 s41, s54, 71680
  buffer_load_dwordx4 a[208:211], v200, s[24:27], s41 offen offset:0 sc1 nt
  buffer_load_dwordx4 a[212:215], v200, s[24:27], s41 offen offset:256 sc1 nt
L_r_5_0:
  s_bitcmp1_b32 s31, 22
  s_cbranch_scc0 L_r_6_1
  s_add_u32 s41, s54, 86016
  buffer_load_dwordx4 a[232:235], v201, s[24:27], s41 offen offset:0 sc1 nt
  buffer_load_dwordx4 a[236:239], v201, s[24:27], s41 offen offset:256 sc1 nt
L_r_6_1:
  s_bitcmp1_b32 s31, 6
  s_cbranch_scc0 L_r_6_0
  s_add_u32 s41, s54, 86016
  buffer_load_dwordx4 a[224:227], v200, s[24:27], s41 offen offset:0 sc1 nt
  buffer_load_dwordx4 a[228:231], v200, s[24:27], s41 offen offset:256 sc1 nt
L_r_6_0:
  s_bitcmp1_b32 s31, 23
  s_cbranch_scc0 L_r_7_1
  s_add_u32 s41, s54, 100352
  buffer_load_dwordx4 a[248:251], v201, s[24:27], s41 offen offset:0 sc1 nt
  buffer_load_dwordx4 a[252:255], v201, s[24:27], s41 offen offset:256 sc1 nt
L_r_7_1:
  s_bitcmp1_b32 s31, 7
  s_cbranch_scc0 L_r_7_0
  s_add_u32 s41, s54, 100352
  buffer_load_dwordx4 a[240:243], v200, s[24:27], s41 offen offset:0 sc1 nt
  buffer_load_dwordx4 a[244:247], v200, s[24:27], s41 offen offset:256 sc1 nt
L_r_7_0:
L_rg1:
  s_cmp_lg_u32 s40, 0
  s_cbranch_scc1 L_again
L_fin:
  s_mov_b32 s40, 0
  s_waitcnt vmcnt(0)
  v_mfma_f32_16x16x32_bf16 v[72:75], v[204:207], a[136:139], 0
  v_mfma_f32_16x16x32_bf16 v[76:79], v[204:207], a[140:143], 0
  v_mfma_f32_16x16x32_bf16 v[72:75], v[204:207], a[152:155], v[72:75]
  v_mfma_f32_16x16x32_bf16 v[76:79], v[204:207], a[156:159], v[76:79]
  v_mfma_f32_16x16x32_bf16 v[72:75], v[204:207], a[168:171], v[72:75]
  v_mfma_f32_16x16x32_bf16 v[76:79], v[204:207], a[172:175], v[76:79]
  v_mfma_f32_16x16x32_bf16 v[72:75], v[204:207], a[184:187], v[72:75]
  v_mfma_f32_16x16x32_bf16 v[76:79], v[204:207], a[188:191], v[76:79]
  v_mfma_f32_16x16x32_bf16 v[72:75], v[204:207], a[200:203], v[72:75]
  v_mfma_f32_16x16x32_bf16 v[76:79], v[204:207], a[204:207], v[76:79]
  v_mfma_f32_16x16x32_bf16 v[72:75], v[204:207], a[216:219], v[72:75]
  v_mfma_f32_16x16x32_bf16 v[76:79], v[204:207], a[220:223], v[76:79]
  v_mfma_f32_16x16x32_bf16 v[72:75], v[204:207], a[232:235], v[72:75]
  v_mfma_f32_16x16x32_bf16 v[76:79], v[204:207], a[236:239], v[76:79]
  v_mfma_f32_16x16x32_bf16 v[72:75], v[204:207], a[248:251], v[72:75]
  v_mfma_f32_16x16x32_bf16 v[76:79], v[204:207], a[252:255], v[76:79]
  v_mfma_f32_16x16x32_bf16 v[64:67], v[204:207], a[128:131], 0
  v_mfma_f32_16x16x32_bf16 v[68:71], v[204:207], a[132:135], 0
  v_mfma_f32_16x16x32_bf16 v[64:67], v[204:207], a[144:147], v[64:67]
  v_mfma_f32_16x16x32_bf16 v[68:71], v[204:207], a[148:151], v[68:71]
  v_mfma_f32_16x16x32_bf16 v[64:67], v[204:207], a[160:163], v[64:67]
  v_mfma_f32_16x16x32_bf16 v[68:71], v[204:207], a[164:167], v[68:71]
  v_mfma_f32_16x16x32_bf16 v[64:67], v[204:207], a[176:179], v[64:67]
  v_mfma_f32_16x16x32_bf16 v[68:71], v[204:207], a[180:183], v[68:71]
  v_mfma_f32_16x16x32_bf16 v[64:67], v[204:207], a[192:195], v[64:67]
  v_mfma_f32_16x16x32_bf16 v[68:71], v[204:207], a[196:199], v[68:71]
  v_mfma_f32_16x16x32_bf16 v[64:67], v[204:207], a[208:211], v[64:67]
  v_mfma_f32_16x16x32_bf16 v[68:71], v[204:207], a[212:215], v[68:71]
  v_mfma_f32_16x16x32_bf16 v[64:67], v[204:207], a[224:227], v[64:67]
  v_mfma_f32_16x16x32_bf16 v[68:71], v[204:207], a[228:231], v[68:71]
  v_mfma_f32_16x16x32_bf16 v[64:67], v[204:207], a[240:243], v[64:67]
  v_mfma_f32_16x16x32_bf16 v[68:71], v[204:207], a[244:247], v[68:71]
  s_nop 7
  v_permlane16_swap_b32 v64, v68
  v_permlane16_swap_b32 v65, v69
  v_permlane16_swap_b32 v66, v70
  v_permlane16_swap_b32 v67, v71
  v_lshlrev_b32 v40, 16, v216
  v_and_b32 v41, 0xffff0000, v216
  v_pk_fma_f32 v[40:41], v[128:129], v[64:65], v[40:41]
  v_cvt_pk_bf16_f32 v216, v40, v41
  v_lshlrev_b32 v40, 16, v217
  v_and_b32 v41, 0xffff0000, v217
  v_pk_fma_f32 v[40:41], v[130:131], v[66:67], v[40:41]
  v_cvt_pk_bf16_f32 v217, v40, v41
  v_lshlrev_b32 v40, 16, v218
  v_and_b32 v41, 0xffff0000, v218
  v_pk_fma_f32 v[40:41], v[132:133], v[68:69], v[40:41]
  v_cvt_pk_bf16_f32 v218, v40, v41
  v_lshlrev_b32 v40, 16, v219
  v_and_b32 v41, 0xffff0000, v219
  v_pk_fma_f32 v[40:41], v[134:135], v[70:71], v[40:41]
  v_cvt_pk_bf16_f32 v219, v40, v41
  v_lshlrev_b32 v64, 16, v216
  v_and_b32 v65, 0xffff0000, v216
  v_lshlrev_b32 v66, 16, v217
  v_and_b32 v67, 0xffff0000, v217
  v_lshlrev_b32 v68, 16, v218
  v_and_b32 v69, 0xffff0000, v218
  v_lshlrev_b32 v70, 16, v219
  v_and_b32 v71, 0xffff0000, v219
  v_pk_mul_f32 v[46:47], v[64:65], v[64:65]
  v_mov_b64 v[44:45], v[64:65]
  v_pk_fma_f32 v[46:47], v[66:67], v[66:67], v[46:47]
  v_pk_add_f32 v[44:45], v[44:45], v[66:67]
  v_pk_fma_f32 v[46:47], v[68:69], v[68:69], v[46:47]
  v_pk_add_f32 v[44:45], v[44:45], v[68:69]
  v_pk_fma_f32 v[46:47], v[70:71], v[70:71], v[46:47]
  v_pk_add_f32 v[44:45], v[44:45], v[70:71]
  v_permlane16_swap_b32 v72, v76
  v_permlane16_swap_b32 v73, v77
  v_permlane16_swap_b32 v74, v78
  v_permlane16_swap_b32 v75, v79
  v_lshlrev_b32 v40, 16, v220
  v_and_b32 v41, 0xffff0000, v220
  v_pk_fma_f32 v[40:41], v[136:137], v[72:73], v[40:41]
  v_cvt_pk_bf16_f32 v220, v40, v41
  v_lshlrev_b32 v40, 16, v221
  v_and_b32 v41, 0xffff0000, v221
  v_pk_fma_f32 v[40:41], v[138:139], v[74:75], v[40:41]
  v_cvt_pk_bf16_f32 v221, v40, v41
  v_lshlrev_b32 v40, 16, v222
  v_and_b32 v41, 0xffff0000, v222
  v_pk_fma_f32 v[40:41], v[140:141], v[76:77], v[40:41]
  v_cvt_pk_bf16_f32 v222, v40, v41
  v_lshlrev_b32 v40, 16, v223
  v_and_b32 v41, 0xffff0000, v223
  v_pk_fma_f32 v[40:41], v[142:143], v[78:79], v[40:41]
  v_cvt_pk_bf16_f32 v223, v40, v41
  v_lshlrev_b32 v72, 16, v220
  v_and_b32 v73, 0xffff0000, v220
  v_lshlrev_b32 v74, 16, v221
  v_and_b32 v75, 0xffff0000, v221
  v_lshlrev_b32 v76, 16, v222
  v_and_b32 v77, 0xffff0000, v222
  v_lshlrev_b32 v78, 16, v223
  v_and_b32 v79, 0xffff0000, v223
  v_pk_fma_f32 v[46:47], v[72:73], v[72:73], v[46:47]
  v_pk_add_f32 v[44:45], v[44:45], v[72:73]
  v_pk_fma_f32 v[46:47], v[74:75], v[74:75], v[46:47]
  v_pk_add_f32 v[44:45], v[44:45], v[74:75]
  v_pk_fma_f32 v[46:47], v[76:77], v[76:77], v[46:47]
  v_pk_add_f32 v[44:45], v[44:45], v[76:77]
  v_pk_fma_f32 v[46:47], v[78:79], v[78:79], v[46:47]
  v_pk_add_f32 v[44:45], v[44:45], v[78:79]
  v_mov_b32 v52, s59
  v_lshlrev_b32 v53, 2, v1
  v_add_u32 v53, 155648, v53
  ds_write_b32 v53, v52 offset:512
  v_add_f32 v40, v44, v45
  v_add_f32 v41, v46, v47
  s_nop 0
  v_add_f32_dpp v40, v40, v40 row_ror:8 row_mask:0xf bank_mask:0xf
  v_add_f32_dpp v41, v41, v41 row_ror:8 row_mask:0xf bank_mask:0xf
  v_mov_b32 v42, v40
  v_mov_b32 v43, v41
  s_nop 0
  v_permlane16_swap_b32 v40, v42
  v_permlane16_swap_b32 v41, v43
  v_pk_add_f32 v[40:41], v[40:41], v[42:43]
  v_mov_b32 v42, v40
  v_mov_b32 v43, v41
  s_nop 0
  v_permlane32_swap_b32 v40, v42
  v_permlane32_swap_b32 v41, v43
  v_pk_add_f32 v[40:41], v[40:41], v[42:43]
  ds_write_b64 v38, v[40:41]
  s_waitcnt lgkmcnt(0)
  s_barrier
  v_mov_b32 v52, 155648
  ds_read_b128 v[52:55], v52 offset:512
  ds_read_b64 v[40:41], v39 offset:0
  ds_read_b64 v[42:43], v39 offset:64
  ds_read_b64 v[44:45], v39 offset:128
  ds_read_b64 v[46:47], v39 offset:192
  s_waitcnt lgkmcnt(4)
  v_or3_b32 v52, v52, v53, v54
  v_or_b32 v52, v52, v55
  s_nop 0
  v_readfirstlane_b32 s31, v52
  s_nop 0
  s_cmp_lg_u32 s31, 0
  s_cbranch_scc1 L_fail
  s_waitcnt lgkmcnt(2)
  v_pk_add_f32 v[40:41], v[40:41], v[42:43]
  s_waitcnt lgkmcnt(0)
  v_pk_add_f32 v[44:45], v[44:45], v[46:47]
  v_pk_add_f32 v[40:41], v[40:41], v[44:45]
  v_mul_f32 v40, 0xbb124925, v40
  v_mul_f32 v42, 0x3b124925, v41
  v_fma_f32 v42, -v40, v40, v42
  v_max_f32 v42, 0, v42
  v_add_f32 v42, 0x3727c5ac, v42
  v_rsq_f32 v42, v42
  v_mov_b32 v41, v40
  v_mov_b32 v43, v42
  v_pk_add_f32 v[64:65], v[64:65], v[40:41]
  v_pk_mul_f32 v[84:85], v[84:85], v[42:43]
  v_pk_fma_f32 v[64:65], v[64:65], v[84:85], v[144:145]
  v_cvt_pk_bf16_f32 v128, v64, v65
  v_pk_add_f32 v[66:67], v[66:67], v[40:41]
  v_pk_mul_f32 v[86:87], v[86:87], v[42:43]
  v_pk_fma_f32 v[66:67], v[66:67], v[86:87], v[146:147]
  v_cvt_pk_bf16_f32 v129, v66, v67
  v_pk_add_f32 v[68:69], v[68:69], v[40:41]
  v_pk_mul_f32 v[88:89], v[88:89], v[42:43]
  v_pk_fma_f32 v[68:69], v[68:69], v[88:89], v[148:149]
  v_cvt_pk_bf16_f32 v130, v68, v69
  v_pk_add_f32 v[70:71], v[70:71], v[40:41]
  v_pk_mul_f32 v[90:91], v[90:91], v[42:43]
  v_pk_fma_f32 v[70:71], v[70:71], v[90:91], v[150:151]
  v_cvt_pk_bf16_f32 v131, v70, v71
  buffer_store_dwordx4 v[128:131], v32, s[24:27], s55 offen sc1
  v_pk_add_f32 v[72:73], v[72:73], v[40:41]
  v_pk_mul_f32 v[56:57], v[56:57], v[42:43]
  v_pk_fma_f32 v[72:73], v[72:73], v[56:57], v[152:153]
  v_cvt_pk_bf16_f32 v136, v72, v73
  v_pk_add_f32 v[74:75], v[74:75], v[40:41]
  v_pk_mul_f32 v[58:59], v[58:59], v[42:43]
  v_pk_fma_f32 v[74:75], v[74:75], v[58:59], v[154:155]
  v_cvt_pk_bf16_f32 v137, v74, v75
  v_pk_add_f32 v[76:77], v[76:77], v[40:41]
  v_pk_mul_f32 v[60:61], v[60:61], v[42:43]
  v_pk_fma_f32 v[76:77], v[76:77], v[60:61], v[156:157]
  v_cvt_pk_bf16_f32 v138, v76, v77
  v_pk_add_f32 v[78:79], v[78:79], v[40:41]
  v_pk_mul_f32 v[62:63], v[62:63], v[42:43]
  v_pk_fma_f32 v[78:79], v[78:79], v[62:63], v[158:159]
  v_cvt_pk_bf16_f32 v139, v78, v79
  buffer_store_dwordx4 v[136:139], v33, s[24:27], s55 offen sc1
  s_add_u32 m0, s36, 0
  s_mov_b32 s42, 1376256
  buffer_load_dwordx4 v8, s[8:11], s42 offen offset:0 lds
  buffer_load_dwordx4 v9, s[8:11], s42 offen offset:1024 lds
  buffer_load_dwordx4 v10, s[8:11], s42 offen offset:2048 lds
  buffer_load_dwordx4 v11, s[8:11], s42 offen offset:3072 lds
  s_add_u32 m0, s36, 4096
  s_mov_b32 s42, 256
  buffer_load_dwordx4 v8, s[8:11], s42 offen offset:0 lds
  buffer_load_dwordx4 v9, s[8:11], s42 offen offset:1024 lds
  buffer_load_dwordx4 v10, s[8:11], s42 offen offset:2048 lds
  buffer_load_dwordx4 v11, s[8:11], s42 offen offset:3072 lds
  s_mov_b32 s30, 4000
  s_cmp_lg_u32 s89, 0
  s_cbranch_scc1 L_recB
  s_lshl_b32 s3, s34, 3
  s_add_u32 s3, s3, s33
  s_lshl_b32 s3, s3, 7
  s_add_u32 s3, s3, 2179072
  v_mov_b32 v51, 2
  s_waitcnt vmcnt(8)
  s_barrier
  s_mov_b64 exec, s[92:93]
  buffer_store_dword v48, off, s[24:27], s51 sc1
  s_mov_b64 exec, -1
  s_mov_b32 s94, 0
  s_cmp_eq_u32 s33, 7
  s_cbranch_scc1 L_idle
  s_cmp_lg_u32 s94, -1
  s_cbranch_scc1 L_fh
L_C:
  v_mov_b32 v92, s59
  v_lshlrev_b32 v93, 2, v1
  v_add_u32 v93, 155648, v93
  ds_write_b32 v93, v92 offset:528
  s_add_u32 s41, s35, 0
  s_add_u32 m0, s37, 0
  s_nop 0
  buffer_load_dwordx4 v25, s[24:27], s41 offen offset:0 sc1 lds
  buffer_load_dwordx4 v25, s[24:27], s41 offen offset:1024 sc1 lds
  s_add_u32 s41, s35, 2048
  s_add_u32 m0, s37, 2048
  s_nop 0
  buffer_load_dwordx4 v25, s[24:27], s41 offen offset:0 sc1 lds
  buffer_load_dwordx4 v25, s[24:27], s41 offen offset:1024 sc1 lds
  s_add_u32 s41, s35, 4096
  s_add_u32 m0, s37, 4096
  s_nop 0
  buffer_load_dwordx4 v25, s[24:27], s41 offen offset:0 sc1 lds
  buffer_load_dwordx4 v25, s[24:27], s41 offen offset:1024 sc1 lds
  s_add_u32 s41, s35, 6144
  s_add_u32 m0, s37, 6144
  s_nop 0
  buffer_load_dwordx4 v25, s[24:27], s41 offen offset:0 sc1 lds
  buffer_load_dwordx4 v25, s[24:27], s41 offen offset:1024 sc1 lds
  s_add_u32 s41, s35, 8192
  s_add_u32 m0, s37, 8192
  s_nop 0
  buffer_load_dwordx4 v25, s[24:27], s41 offen offset:0 sc1 lds
  buffer_load_dwordx4 v25, s[24:27], s41 offen offset:1024 sc1 lds
  s_add_u32 s41, s35, 10240
  s_add_u32 m0, s37, 10240
  s_nop 0
  buffer_load_dwordx4 v25, s[24:27], s41 offen offset:0 sc1 lds
  buffer_load_dwordx4 v25, s[24:27], s41 offen offset:1024 sc1 lds
  s_add_u32 s41, s35, 12288
  s_add_u32 m0, s37, 12288
  s_nop 0
  buffer_load_dwordx4 v25, s[24:27], s41 offen offset:0 sc1 lds
  buffer_load_dwordx4 v25, s[24:27], s41 offen offset:1024 sc1 lds
  s_waitcnt vmcnt(14)
  ds_read_b64_tr_b16 v[224:225], v20 offset:0
  ds_read_b64_tr_b16 v[226:227], v20 offset:256
  ds_read_b64_tr_b16 v[228:229], v20 offset:1024
  ds_read_b64_tr_b16 v[230:231], v20 offset:1280
  ds_read_b64_tr_b16 v[232:233], v20 offset:2048
  ds_read_b64_tr_b16 v[234:235], v20 offset:2304
  ds_read_b64_tr_b16 v[236:237], v20 offset:3072
  ds_read_b64_tr_b16 v[238:239], v20 offset:3328
  ds_read_b64_tr_b16 v[240:241], v20 offset:4096
  ds_read_b64_tr_b16 v[242:243], v20 offset:4352
  ds_read_b64_tr_b16 v[244:245], v20 offset:5120
  ds_read_b64_tr_b16 v[246:247], v20 offset:5376
  ds_read_b64_tr_b16 v[248:249], v20 offset:6144
  ds_read_b64_tr_b16 v[250:251], v20 offset:6400
  ds_read_b64_tr_b16 v[252:253], v20 offset:7168
  ds_read_b64_tr_b16 v[254:255], v20 offset:7424
  s_waitcnt vmcnt(12) lgkmcnt(15)
  s_barrier
  v_mov_b32 v92, 155648
  ds_read_b128 v[92:95], v92 offset:528
  ds_read_b128 a[0:3], v26 offset:0
  ds_read_b128 a[4:7], v26 offset:28672
  ds_read_b128 a[8:11], v26 offset:512
  ds_read_b128 a[12:15], v26 offset:29184
  ds_read_b128 a[16:19], v26 offset:1024
  ds_read_b128 a[20:23], v26 offset:29696
  ds_read_b128 a[24:27], v26 offset:1536
  ds_read_b128 a[28:31], v26 offset:30208
  s_waitcnt lgkmcnt(8)
  v_or3_b32 v92, v92, v93, v94
  v_or_b32 v92, v92, v95
  s_nop 0
  v_readfirstlane_b32 s31, v92
  s_nop 0
  s_cmp_lg_u32 s31, 0
  s_cbranch_scc1 L_fail
  s_waitcnt lgkmcnt(7)
  v_mfma_f32_32x32x16_bf16 v[64:79], a[96:99], a[0:3], 0
  s_waitcnt vmcnt(10)
  s_barrier
  ds_read_b128 a[32:35], v26 offset:2048
  ds_read_b128 a[36:39], v26 offset:30720
  s_waitcnt lgkmcnt(8)
  v_mfma_f32_32x32x16_bf16 v[80:95], a[96:99], a[4:7], 0
  ds_read_b128 a[40:43], v26 offset:2560
  ds_read_b128 a[44:47], v26 offset:31232
  s_waitcnt lgkmcnt(9)
  v_mfma_f32_32x32x16_bf16 v[64:79], a[100:103], a[8:11], v[64:79]
  ds_read_b128 a[48:51], v26 offset:3072
  ds_read_b128 a[52:55], v26 offset:31744
  s_waitcnt lgkmcnt(10)
  v_mfma_f32_32x32x16_bf16 v[80:95], a[100:103], a[12:15], v[80:95]
  ds_read_b128 a[56:59], v26 offset:3584
  ds_read_b128 a[60:63], v26 offset:32256
  s_waitcnt lgkmcnt(11)
  v_mfma_f32_32x32x16_bf16 v[64:79], a[104:107], a[16:19], v[64:79]
  s_waitcnt lgkmcnt(10)
  v_mfma_f32_32x32x16_bf16 v[80:95], a[104:107], a[20:23], v[80:95]
  s_waitcnt lgkmcnt(9)
  v_mfma_f32_32x32x16_bf16 v[64:79], a[108:111], a[24:27], v[64:79]
  s_add_u32 m0, s36, 8192
  s_mov_b32 s42, 229632
  buffer_load_dwordx4 v8, s[8:11], s42 offen offset:0 lds
  s_waitcnt lgkmcnt(8)
  v_mfma_f32_32x32x16_bf16 v[80:95], a[108:111], a[28:31], v[80:95]
  s_waitcnt lgkmcnt(7)
  v_mfma_f32_32x32x16_bf16 v[64:79], a[112:115], a[32:35], v[64:79]
  s_waitcnt vmcnt(7)
  s_barrier
  buffer_load_dwordx4 v9, s[8:11], s42 offen offset:1024 lds
  ds_read_b128 a[64:67], v26 offset:4096
  ds_read_b128 a[68:71], v26 offset:32768
  s_waitcnt lgkmcnt(8)
  v_mfma_f32_32x32x16_bf16 v[80:95], a[112:115], a[36:39], v[80:95]
  ds_read_b128 a[72:75], v26 offset:4608
  ds_read_b128 a[76:79], v26 offset:33280
  s_waitcnt lgkmcnt(9)
  v_mfma_f32_32x32x16_bf16 v[64:79], a[116:119], a[40:43], v[64:79]
  buffer_load_dwordx4 v10, s[8:11], s42 offen offset:2048 lds
  ds_read_b128 a[80:83], v26 offset:5120
  ds_read_b128 a[84:87], v26 offset:33792
  s_waitcnt lgkmcnt(10)
  v_mfma_f32_32x32x16_bf16 v[80:95], a[116:119], a[44:47], v[80:95]
  ds_read_b128 a[88:91], v26 offset:5632
  ds_read_b128 a[92:95], v26 offset:34304
  s_waitcnt lgkmcnt(11)
  v_mfma_f32_32x32x16_bf16 v[64:79], a[120:123], a[48:51], v[64:79]
  buffer_load_dwordx4 v11, s[8:11], s42 offen offset:3072 lds
  s_waitcnt lgkmcnt(10)
  v_mfma_f32_32x32x16_bf16 v[80:95], a[120:123], a[52:55], v[80:95]
  s_waitcnt lgkmcnt(9)
  v_mfma_f32_32x32x16_bf16 v[64:79], a[124:127], a[56:59], v[64:79]
  s_add_u32 m0, s36, 12288
  s_mov_b32 s42, 459008
  buffer_load_dwordx4 v8, s[8:11], s42 offen offset:0 lds
  s_waitcnt lgkmcnt(8)
  v_mfma_f32_32x32x16_bf16 v[80:95], a[124:127], a[60:63], v[80:95]
  s_waitcnt lgkmcnt(7)
  v_mfma_f32_32x32x16_bf16 v[64:79], v[96:99], a[64:67], v[64:79]
  buffer_load_dwordx4 v9, s[8:11], s42 offen offset:1024 lds
  ds_read_b128 a[96:99], v26 offset:6144
  ds_read_b128 a[100:103], v26 offset:34816
  s_waitcnt lgkmcnt(8)
  v_mfma_f32_32x32x16_bf16 v[80:95], v[96:99], a[68:71], v[80:95]
  ds_read_b128 a[104:107], v26 offset:6656
  ds_read_b128 a[108:111], v26 offset:35328
  s_waitcnt lgkmcnt(9)
  v_mfma_f32_32x32x16_bf16 v[64:79], v[100:103], a[72:75], v[64:79]
  buffer_load_dwordx4 v10, s[8:11], s42 offen offset:2048 lds
  ds_read_b128 a[112:115], v26 offset:7168
  ds_read_b128 a[116:119], v26 offset:35840
  s_waitcnt lgkmcnt(10)
  v_mfma_f32_32x32x16_bf16 v[80:95], v[100:103], a[76:79], v[80:95]
  ds_read_b128 a[120:123], v26 offset:7680
  ds_read_b128 a[124:127], v26 offset:36352
  s_waitcnt lgkmcnt(11)
  v_mfma_f32_32x32x16_bf16 v[64:79], v[104:107], a[80:83], v[64:79]
  buffer_load_dwordx4 v11, s[8:11], s42 offen offset:3072 lds
  s_waitcnt lgkmcnt(10)
  v_mfma_f32_32x32x16_bf16 v[80:95], v[104:107], a[84:87], v[80:95]
  s_waitcnt lgkmcnt(9)
  v_mfma_f32_32x32x16_bf16 v[64:79], v[108:111], a[88:91], v[64:79]
  s_add_u32 m0, s36, 16384
  s_mov_b32 s42, 688384
  buffer_load_dwordx4 v8, s[8:11], s42 offen offset:0 lds
  s_waitcnt lgkmcnt(8)
  v_mfma_f32_32x32x16_bf16 v[80:95], v[108:111], a[92:95], v[80:95]
  s_waitcnt lgkmcnt(7)
  v_mfma_f32_32x32x16_bf16 v[64:79], v[112:115], a[96:99], v[64:79]
  s_waitcnt vmcnt(9)
  s_barrier
  buffer_load_dwordx4 v9, s[8:11], s42 offen offset:1024 lds
  ds_read_b128 a[128:131], v26 offset:8192
  ds_read_b128 a[132:135], v26 offset:36864
  s_waitcnt lgkmcnt(8)
  v_mfma_f32_32x32x16_bf16 v[80:95], v[112:115], a[100:103], v[80:95]
  ds_read_b128 a[136:139], v26 offset:8704
  ds_read_b128 a[140:143], v26 offset:37376
  s_waitcnt lgkmcnt(9)
  v_mfma_f32_32x32x16_bf16 v[64:79], v[116:119], a[104:107], v[64:79]
  buffer_load_dwordx4 v10, s[8:11], s42 offen offset:2048 lds
  ds_read_b128 a[144:147], v26 offset:9216
  ds_read_b128 a[148:151], v26 offset:37888
  s_waitcnt lgkmcnt(10)
  v_mfma_f32_32x32x16_bf16 v[80:95], v[116:119], a[108:111], v[80:95]
  ds_read_b128 a[152:155], v26 offset:9728
  ds_read_b128 a[156:159], v26 offset:38400
  s_waitcnt lgkmcnt(11)
  v_mfma_f32_32x32x16_bf16 v[64:79], v[120:123], a[112:115], v[64:79]
  buffer_load_dwordx4 v11, s[8:11], s42 offen offset:3072 lds
  s_waitcnt lgkmcnt(10)
  v_mfma_f32_32x32x16_bf16 v[80:95], v[120:123], a[116:119], v[80:95]
  s_waitcnt lgkmcnt(9)
  v_mfma_f32_32x32x16_bf16 v[64:79], v[124:127], a[120:123], v[64:79]
  s_add_u32 m0, s36, 20480
  s_mov_b32 s42, 917760
  buffer_load_dwordx4 v8, s[8:11], s42 offen offset:0 lds
  s_waitcnt lgkmcnt(8)
  v_mfma_f32_32x32x16_bf16 v[80:95], v[124:127], a[124:127], v[80:95]
  s_waitcnt lgkmcnt(7)
  v_mfma_f32_32x32x16_bf16 v[64:79], v[160:163], a[128:131], v[64:79]
  buffer_load_dwordx4 v9, s[8:11], s42 offen offset:1024 lds
  ds_read_b128 a[160:163], v26 offset:10240
  ds_read_b128 a[164:167], v26 offset:38912
  s_waitcnt lgkmcnt(8)
  v_mfma_f32_32x32x16_bf16 v[80:95], v[160:163], a[132:135], v[80:95]
  ds_read_b128 a[168:171], v26 offset:10752
  ds_read_b128 a[172:175], v26 offset:39424
  s_waitcnt lgkmcnt(9)
  v_mfma_f32_32x32x16_bf16 v[64:79], v[164:167], a[136:139], v[64:79]
  buffer_load_dwordx4 v10, s[8:11], s42 offen offset:2048 lds
  ds_read_b128 a[176:179], v26 offset:11264
  ds_read_b128 a[180:183], v26 offset:39936
  s_waitcnt lgkmcnt(10)
  v_mfma_f32_32x32x16_bf16 v[80:95], v[164:167], a[140:143], v[80:95]
  ds_read_b128 a[184:187], v26 offset:11776
  ds_read_b128 a[188:191], v26 offset:40448
  s_waitcnt lgkmcnt(11)
  v_mfma_f32_32x32x16_bf16 v[64:79], v[168:171], a[144:147], v[64:79]
  s_waitcnt vmcnt(11)
  buffer_load_dwordx4 v11, s[8:11], s42 offen offset:3072 lds
  ds_read_b64_tr_b16 a[224:225], v20 offset:8192
  ds_read_b64_tr_b16 a[226:227], v20 offset:8448
  s_waitcnt lgkmcnt(12)
  v_mfma_f32_32x32x16_bf16 v[80:95], v[168:171], a[148:151], v[80:95]
  ds_read_b64_tr_b16 a[228:229], v20 offset:9216
  ds_read_b64_tr_b16 a[230:231], v20 offset:9472
  s_waitcnt lgkmcnt(13)
  v_mfma_f32_32x32x16_bf16 v[64:79], v[172:175], a[152:155], v[64:79]
  s_add_u32 m0, s36, 0
  s_mov_b32 s42, 1147136
  buffer_load_dwordx4 v8, s[8:11], s42 offen offset:0 lds
  ds_read_b64_tr_b16 a[232:233], v20 offset:10240
  s_waitcnt lgkmcnt(13)
  v_mfma_f32_32x32x16_bf16 v[80:95], v[172:175], a[156:159], v[80:95]
  ds_read_b64_tr_b16 a[234:235], v20 offset:10496
  ds_read_b64_tr_b16 a[236:237], v20 offset:11264
  s_waitcnt lgkmcnt(14)
  v_mfma_f32_32x32x16_bf16 v[64:79], v[176:179], a[160:163], v[64:79]
  buffer_load_dwordx4 v9, s[8:11], s42 offen offset:1024 lds
  ds_read_b64_tr_b16 a[238:239], v20 offset:11520
  ds_read_b128 a[192:195], v26 offset:12288
  ds_read_b128 a[196:199], v26 offset:40960
  s_waitcnt lgkmcnt(15)
  v_mfma_f32_32x32x16_bf16 v[80:95], v[176:179], a[164:167], v[80:95]
  ds_read_b128 a[200:203], v26 offset:12800
  ds_read_b128 a[204:207], v26 offset:41472
  v_mfma_f32_32x32x16_bf16 v[64:79], v[180:183], a[168:171], v[64:79]
  buffer_load_dwordx4 v10, s[8:11], s42 offen offset:2048 lds
  ds_read_b128 a[208:211], v26 offset:13312
  ds_read_b128 a[212:215], v26 offset:41984
  s_waitcnt lgkmcnt(15)
  v_mfma_f32_32x32x16_bf16 v[80:95], v[180:183], a[172:175], v[80:95]
  ds_read_b128 a[216:219], v26 offset:13824
  ds_read_b128 a[220:223], v26 offset:42496
  v_mfma_f32_32x32x16_bf16 v[64:79], v[184:187], a[176:179], v[64:79]
  s_waitcnt vmcnt(11)
  buffer_load_dwordx4 v11, s[8:11], s42 offen offset:3072 lds
  ds_read_b64_tr_b16 a[240:241], v20 offset:12288
  ds_read_b64_tr_b16 a[242:243], v20 offset:12544
  v_mfma_f32_32x32x16_bf16 v[80:95], v[184:187], a[180:183], v[80:95]
  ds_read_b64_tr_b16 a[244:245], v20 offset:13312
  ds_read_b64_tr_b16 a[246:247], v20 offset:13568
  v_mfma_f32_32x32x16_bf16 v[64:79], v[188:191], a[184:187], v[64:79]
  s_add_u32 m0, s36, 4096
  s_mov_b32 s42, 1376512
  buffer_load_dwordx4 v8, s[8:11], s42 offen offset:0 lds
  ds_read_b64_tr_b16 a[248:249], v20 offset:14336
  s_waitcnt lgkmcnt(15)
  v_mfma_f32_32x32x16_bf16 v[80:95], v[188:191], a[188:191], v[80:95]
  ds_read_b64_tr_b16 a[250:251], v20 offset:14592
  ds_read_b64_tr_b16 a[252:253], v20 offset:15360
  s_waitcnt lgkmcnt(14)
  v_mfma_f32_32x32x16_bf16 v[64:79], v[224:227], a[192:195], v[64:79]
  buffer_load_dwordx4 v9, s[8:11], s42 offen offset:1024 lds
  ds_read_b64_tr_b16 a[254:255], v20 offset:15616
  s_waitcnt lgkmcnt(14)
  v_mfma_f32_32x32x16_bf16 v[80:95], v[224:227], a[196:199], v[80:95]
  s_waitcnt lgkmcnt(13)
  v_mfma_f32_32x32x16_bf16 v[64:79], v[228:231], a[200:203], v[64:79]
  buffer_load_dwordx4 v10, s[8:11], s42 offen offset:2048 lds
  s_waitcnt lgkmcnt(12)
  v_mfma_f32_32x32x16_bf16 v[80:95], v[228:231], a[204:207], v[80:95]
  s_waitcnt lgkmcnt(11)
  v_mfma_f32_32x32x16_bf16 v[64:79], v[232:235], a[208:211], v[64:79]
  s_waitcnt vmcnt(11)
  buffer_load_dwordx4 v11, s[8:11], s42 offen offset:3072 lds
  ds_read_b64_tr_b16 v[32:33], v20 offset:16384
  ds_read_b64_tr_b16 v[34:35], v20 offset:16640
  s_waitcnt lgkmcnt(12)
  v_mfma_f32_32x32x16_bf16 v[80:95], v[232:235], a[212:215], v[80:95]
  ds_read_b64_tr_b16 v[36:37], v20 offset:17408
  ds_read_b64_tr_b16 v[38:39], v20 offset:17664
  s_waitcnt lgkmcnt(13)
  v_mfma_f32_32x32x16_bf16 v[64:79], v[236:239], a[216:219], v[64:79]
  s_add_u32 m0, s36, 8192
  s_mov_b32 s42, 0
  buffer_load_dwordx4 v8, s[12:15], s42 offen offset:0 lds
  ds_read_b64_tr_b16 v[40:41], v20 offset:18432
  s_waitcnt lgkmcnt(13)
  v_mfma_f32_32x32x16_bf16 v[80:95], v[236:239], a[220:223], v[80:95]
  ds_read_b64_tr_b16 v[42:43], v20 offset:18688
  ds_read_b64_tr_b16 v[44:45], v20 offset:19456
  v_mfma_f32_32x32x16_bf16 v[128:143], v[240:243], a[0:3], 0
  s_barrier
  buffer_load_dwordx4 v9, s[12:15], s42 offen offset:1024 lds
  ds_read_b64_tr_b16 v[46:47], v20 offset:19712
  v_mfma_f32_32x32x16_bf16 v[144:159], v[240:243], a[4:7], 0
  v_mul_f32 v2, v64, v64
  v_mul_f32 v3, v65, v65
  v_mul_f32 v4, v66, v66
  v_mul_f32 v5, v67, v67
  v_fma_f32 v2, v2, v30, v31
  v_fma_f32 v3, v3, v30, v31
  v_mfma_f32_32x32x16_bf16 v[128:143], v[244:247], a[8:11], v[128:143]
  buffer_load_dwordx4 v10, s[12:15], s42 offen offset:2048 lds
  v_fma_f32 v4, v4, v30, v31
  v_fma_f32 v5, v5, v30, v31
  v_mul_f32 v2, v2, v64
  v_mul_f32 v3, v3, v65
  v_mfma_f32_32x32x16_bf16 v[144:159], v[244:247], a[12:15], v[144:159]
  v_mul_f32 v4, v4, v66
  v_mul_f32 v5, v5, v67
  v_exp_f32 v2, v2
  v_exp_f32 v3, v3
  v_mfma_f32_32x32x16_bf16 v[128:143], v[248:251], a[16:19], v[128:143]
  s_waitcnt vmcnt(11)
  buffer_load_dwordx4 v11, s[12:15], s42 offen offset:3072 lds
  ds_read_b64_tr_b16 v[48:49], v20 offset:20480
  ds_read_b64_tr_b16 v[50:51], v20 offset:20736
  v_mfma_f32_32x32x16_bf16 v[144:159], v[248:251], a[20:23], v[144:159]
  ds_read_b64_tr_b16 v[52:53], v20 offset:21504
  ds_read_b64_tr_b16 v[54:55], v20 offset:21760
  v_exp_f32 v4, v4
  v_exp_f32 v5, v5
  v_mfma_f32_32x32x16_bf16 v[128:143], v[252:255], a[24:27], v[128:143]
  s_waitcnt lgkmcnt(12)
  s_add_u32 m0, s36, 12288
  s_mov_b32 s42, 229376
  buffer_load_dwordx4 v8, s[12:15], s42 offen offset:0 lds
  ds_read_b64_tr_b16 v[56:57], v20 offset:22528
  v_mfma_f32_32x32x16_bf16 v[144:159], v[252:255], a[28:31], v[144:159]
  ds_read_b64_tr_b16 v[58:59], v20 offset:22784
  ds_read_b64_tr_b16 v[60:61], v20 offset:23552
  v_add_f32 v2, 1.0, v2
  v_add_f32 v3, 1.0, v3
  v_add_f32 v4, 1.0, v4
  v_add_f32 v5, 1.0, v5
  v_mfma_f32_32x32x16_bf16 v[128:143], a[224:227], a[32:35], v[128:143]
  buffer_load_dwordx4 v9, s[12:15], s42 offen offset:1024 lds
  ds_read_b64_tr_b16 v[62:63], v20 offset:23808
  v_rcp_f32 v2, v2
  v_mfma_f32_32x32x16_bf16 v[144:159], a[224:227], a[36:39], v[144:159]
  s_mov_b32 s57, 2107392
  v_rcp_f32 v3, v3
  v_rcp_f32 v4, v4
  v_mfma_f32_32x32x16_bf16 v[128:143], a[228:231], a[40:43], v[128:143]
  buffer_load_dwordx4 v10, s[12:15], s42 offen offset:2048 lds
  v_rcp_f32 v5, v5
  v_mul_f32 v64, v64, v2
  v_mul_f32 v65, v65, v3
  v_mfma_f32_32x32x16_bf16 v[144:159], a[228:231], a[44:47], v[144:159]
  v_mul_f32 v66, v66, v4
  v_mul_f32 v67, v67, v5
  v_mul_f32 v2, v68, v68
  v_mul_f32 v3, v69, v69
  v_mul_f32 v4, v70, v70
  v_mul_f32 v5, v71, v71
  v_mfma_f32_32x32x16_bf16 v[128:143], a[232:235], a[48:51], v[128:143]
  s_waitcnt vmcnt(11)
  buffer_load_dwordx4 v11, s[12:15], s42 offen offset:3072 lds
  ds_read_b64_tr_b16 v[224:225], v20 offset:0
  ds_read_b64_tr_b16 v[226:227], v20 offset:256
  v_fma_f32 v2, v2, v30, v31
  v_mfma_f32_32x32x16_bf16 v[144:159], a[232:235], a[52:55], v[144:159]
  ds_read_b64_tr_b16 v[228:229], v20 offset:1024
  ds_read_b64_tr_b16 v[230:231], v20 offset:1280
  v_fma_f32 v3, v3, v30, v31
  v_fma_f32 v4, v4, v30, v31
  v_fma_f32 v5, v5, v30, v31
  v_mul_f32 v2, v2, v68
  v_mfma_f32_32x32x16_bf16 v[128:143], a[236:239], a[56:59], v[128:143]
  s_waitcnt lgkmcnt(12)
  s_add_u32 m0, s36, 16384
  s_mov_b32 s42, 458752
  buffer_load_dwordx4 v8, s[12:15], s42 offen offset:0 lds
  ds_read_b64_tr_b16 v[232:233], v20 offset:2048
  v_mfma_f32_32x32x16_bf16 v[144:159], a[236:239], a[60:63], v[144:159]
  ds_read_b64_tr_b16 v[234:235], v20 offset:2304
  ds_read_b64_tr_b16 v[236:237], v20 offset:3072
  v_mul_f32 v3, v3, v69
  v_mul_f32 v4, v4, v70
  v_mul_f32 v5, v5, v71
  v_mfma_f32_32x32x16_bf16 v[128:143], a[240:243], a[64:67], v[128:143]
  buffer_load_dwordx4 v9, s[12:15], s42 offen offset:1024 lds
  ds_read_b64_tr_b16 v[238:239], v20 offset:3328
  v_exp_f32 v2, v2
  v_mfma_f32_32x32x16_bf16 v[144:159], a[240:243], a[68:71], v[144:159]
  v_exp_f32 v3, v3
  v_exp_f32 v4, v4
  v_exp_f32 v5, v5
  v_mfma_f32_32x32x16_bf16 v[128:143], a[244:247], a[72:75], v[128:143]
  buffer_load_dwordx4 v10, s[12:15], s42 offen offset:2048 lds
  buffer_load_dwordx4 v[192:195], v6, s[24:27], s57 offen offset:0
  v_add_f32 v2, 1.0, v2
  v_add_f32 v3, 1.0, v3
  v_mfma_f32_32x32x16_bf16 v[144:159], a[244:247], a[76:79], v[144:159]
  v_add_f32 v4, 1.0, v4
  v_add_f32 v5, 1.0, v5
  v_rcp_f32 v2, v2
  v_rcp_f32 v3, v3
  v_mfma_f32_32x32x16_bf16 v[128:143], a[248:251], a[80:83], v[128:143]
  s_waitcnt vmcnt(12)
  buffer_load_dwordx4 v11, s[12:15], s42 offen offset:3072 lds
  ds_read_b64_tr_b16 v[240:241], v20 offset:4096
  ds_read_b64_tr_b16 v[242:243], v20 offset:4352
  v_mfma_f32_32x32x16_bf16 v[144:159], a[248:251], a[84:87], v[144:159]
  ds_read_b64_tr_b16 v[244:245], v20 offset:5120
  ds_read_b64_tr_b16 v[246:247], v20 offset:5376
  v_rcp_f32 v4, v4
  v_rcp_f32 v5, v5
  v_mfma_f32_32x32x16_bf16 v[128:143], a[252:255], a[88:91], v[128:143]
  s_waitcnt lgkmcnt(12)
  s_add_u32 m0, s36, 20480
  s_mov_b32 s42, 688128
  buffer_load_dwordx4 v8, s[12:15], s42 offen offset:0 lds
  ds_read_b64_tr_b16 v[248:249], v20 offset:6144
  v_mfma_f32_32x32x16_bf16 v[144:159], a[252:255], a[92:95], v[144:159]
  ds_read_b64_tr_b16 v[250:251], v20 offset:6400
  ds_read_b64_tr_b16 v[252:253], v20 offset:7168
  v_mul_f32 v68, v68, v2
  v_mul_f32 v69, v69, v3
  v_mul_f32 v70, v70, v4
  v_mul_f32 v71, v71, v5
  v_mfma_f32_32x32x16_bf16 v[128:143], v[32:35], a[96:99], v[128:143]
  buffer_load_dwordx4 v9, s[12:15], s42 offen offset:1024 lds
  ds_read_b64_tr_b16 v[254:255], v20 offset:7424
  v_mul_f32 v2, v72, v72
  v_mul_f32 v3, v73, v73
  v_mul_f32 v4, v74, v74
  v_mfma_f32_32x32x16_bf16 v[144:159], v[32:35], a[100:103], v[144:159]
  v_mul_f32 v5, v75, v75
  v_fma_f32 v2, v2, v30, v31
  v_fma_f32 v3, v3, v30, v31
  v_fma_f32 v4, v4, v30, v31
  v_fma_f32 v5, v5, v30, v31
  v_mul_f32 v2, v2, v72
  v_mfma_f32_32x32x16_bf16 v[128:143], v[36:39], a[104:107], v[128:143]
  buffer_load_dwordx4 v10, s[12:15], s42 offen offset:2048 lds
  v_mul_f32 v3, v3, v73
  v_mul_f32 v4, v4, v74
  v_mul_f32 v5, v5, v75
  v_mfma_f32_32x32x16_bf16 v[144:159], v[36:39], a[108:111], v[144:159]
  buffer_load_dwordx4 v[196:199], v6, s[24:27], s57 offen offset:16
  v_exp_f32 v2, v2
  v_exp_f32 v3, v3
  v_mfma_f32_32x32x16_bf16 v[128:143], v[40:43], a[112:115], v[128:143]
  s_waitcnt vmcnt(13)
  buffer_load_dwordx4 v11, s[12:15], s42 offen offset:3072 lds
  ds_read_b64_tr_b16 a[224:225], v20 offset:8192
  ds_read_b64_tr_b16 a[226:227], v20 offset:8448
  v_mfma_f32_32x32x16_bf16 v[144:159], v[40:43], a[116:119], v[144:159]
  ds_read_b64_tr_b16 a[228:229], v20 offset:9216
  ds_read_b64_tr_b16 a[230:231], v20 offset:9472
  v_exp_f32 v4, v4
  v_exp_f32 v5, v5
  v_mfma_f32_32x32x16_bf16 v[128:143], v[44:47], a[120:123], v[128:143]
  s_waitcnt lgkmcnt(12)
  s_add_u32 m0, s36, 0
  s_mov_b32 s42, 917504
  buffer_load_dwordx4 v8, s[12:15], s42 offen offset:0 lds
  ds_read_b64_tr_b16 a[232:233], v20 offset:10240
  v_mfma_f32_32x32x16_bf16 v[144:159], v[44:47], a[124:127], v[144:159]
  ds_read_b64_tr_b16 a[234:235], v20 offset:10496
  ds_read_b64_tr_b16 a[236:237], v20 offset:11264
  v_add_f32 v2, 1.0, v2
  v_add_f32 v3, 1.0, v3
  v_add_f32 v4, 1.0, v4
  v_add_f32 v5, 1.0, v5
  v_mfma_f32_32x32x16_bf16 v[128:143], v[48:51], a[128:131], v[128:143]
  buffer_load_dwordx4 v9, s[12:15], s42 offen offset:1024 lds
  ds_read_b64_tr_b16 a[238:239], v20 offset:11520
  v_rcp_f32 v2, v2
  v_mfma_f32_32x32x16_bf16 v[144:159], v[48:51], a[132:135], v[144:159]
  v_rcp_f32 v3, v3
  v_rcp_f32 v4, v4
  v_rcp_f32 v5, v5
  v_mfma_f32_32x32x16_bf16 v[128:143], v[52:55], a[136:139], v[128:143]
  buffer_load_dwordx4 v10, s[12:15], s42 offen offset:2048 lds
  v_mul_f32 v72, v72, v2
  v_mul_f32 v73, v73, v3
  v_mul_f32 v74, v74, v4
  v_mul_f32 v75, v75, v5
  v_mfma_f32_32x32x16_bf16 v[144:159], v[52:55], a[140:143], v[144:159]
  v_mul_f32 v2, v76, v76
  v_mul_f32 v3, v77, v77
  v_mul_f32 v4, v78, v78
  v_mul_f32 v5, v79, v79
  v_fma_f32 v2, v2, v30, v31
  v_fma_f32 v3, v3, v30, v31
  v_mfma_f32_32x32x16_bf16 v[128:143], v[56:59], a[144:147], v[128:143]
  s_waitcnt vmcnt(13)
  buffer_load_dwordx4 v11, s[12:15], s42 offen offset:3072 lds
  ds_read_b64_tr_b16 a[240:241], v20 offset:12288
  ds_read_b64_tr_b16 a[242:243], v20 offset:12544
  v_fma_f32 v4, v4, v30, v31
  v_mfma_f32_32x32x16_bf16 v[144:159], v[56:59], a[148:151], v[144:159]
  ds_read_b64_tr_b16 a[244:245], v20 offset:13312
  ds_read_b64_tr_b16 a[246:247], v20 offset:13568
  buffer_load_dwordx4 v[208:211], v7, s[24:27], s57 offen offset:0
  v_fma_f32 v5, v5, v30, v31
  v_mul_f32 v2, v2, v76
  v_mfma_f32_32x32x16_bf16 v[128:143], v[60:63], a[152:155], v[128:143]
  s_waitcnt lgkmcnt(12)
  s_add_u32 m0, s36, 4096
  s_mov_b32 s42, 1146880
  buffer_load_dwordx4 v8, s[12:15], s42 offen offset:0 lds
  ds_read_b64_tr_b16 a[248:249], v20 offset:14336
  v_mfma_f32_32x32x16_bf16 v[144:159], v[60:63], a[156:159], v[144:159]
  ds_read_b64_tr_b16 a[250:251], v20 offset:14592
  ds_read_b64_tr_b16 a[252:253], v20 offset:15360
  v_mul_f32 v3, v3, v77
  v_mul_f32 v4, v4, v78
  v_mul_f32 v5, v5, v79
  v_mfma_f32_32x32x16_bf16 v[128:143], v[224:227], a[160:163], v[128:143]
  buffer_load_dwordx4 v9, s[12:15], s42 offen offset:1024 lds
  ds_read_b64_tr_b16 a[254:255], v20 offset:15616
  v_exp_f32 v2, v2
  v_mfma_f32_32x32x16_bf16 v[144:159], v[224:227], a[164:167], v[144:159]
  v_exp_f32 v3, v3
  v_exp_f32 v4, v4
  v_exp_f32 v5, v5
  v_mfma_f32_32x32x16_bf16 v[128:143], v[228:231], a[168:171], v[128:143]
  buffer_load_dwordx4 v10, s[12:15], s42 offen offset:2048 lds
  v_add_f32 v2, 1.0, v2
  v_add_f32 v3, 1.0, v3
  v_add_f32 v4, 1.0, v4
  v_add_f32 v5, 1.0, v5
  v_mfma_f32_32x32x16_bf16 v[144:159], v[228:231], a[172:175], v[144:159]
  v_rcp_f32 v2, v2
  v_rcp_f32 v3, v3
  v_rcp_f32 v4, v4
  v_mfma_f32_32x32x16_bf16 v[128:143], v[232:235], a[176:179], v[128:143]
  s_waitcnt vmcnt(13)
  buffer_load_dwordx4 v11, s[12:15], s42 offen offset:3072 lds
  ds_read_b64_tr_b16 v[32:33], v20 offset:16384
  ds_read_b64_tr_b16 v[34:35], v20 offset:16640
  v_mfma_f32_32x32x16_bf16 v[144:159], v[232:235], a[180:183], v[144:159]
  ds_read_b64_tr_b16 v[36:37], v20 offset:17408
  ds_read_b64_tr_b16 v[38:39], v20 offset:17664
  v_rcp_f32 v5, v5
  v_mul_f32 v76, v76, v2
  v_mul_f32 v77, v77, v3
  v_mfma_f32_32x32x16_bf16 v[128:143], v[236:239], a[184:187], v[128:143]
  s_waitcnt lgkmcnt(12)
  s_add_u32 m0, s36, 8192
  s_mov_b32 s42, 1376256
  buffer_load_dwordx4 v8, s[12:15], s42 offen offset:0 lds
  ds_read_b64_tr_b16 v[40:41], v20 offset:18432
  v_mfma_f32_32x32x16_bf16 v[144:159], v[236:239], a[188:191], v[144:159]
  ds_read_b64_tr_b16 v[42:43], v20 offset:18688
  ds_read_b64_tr_b16 v[44:45], v20 offset:19456
  buffer_load_dwordx4 v[212:215], v7, s[24:27], s57 offen offset:16
  v_mul_f32 v78, v78, v4
  v_mul_f32 v79, v79, v5
  v_mfma_f32_32x32x16_bf16 v[128:143], v[240:243], a[192:195], v[128:143]
  buffer_load_dwordx4 v9, s[12:15], s42 offen offset:1024 lds
  ds_read_b64_tr_b16 v[46:47], v20 offset:19712
  v_mul_f32 v2, v80, v80
  v_mul_f32 v3, v81, v81
  v_mul_f32 v4, v82, v82
  v_mfma_f32_32x32x16_bf16 v[144:159], v[240:243], a[196:199], v[144:159]
  v_mul_f32 v5, v83, v83
  v_fma_f32 v2, v2, v30, v31
  v_fma_f32 v3, v3, v30, v31
  v_fma_f32 v4, v4, v30, v31
  v_fma_f32 v5, v5, v30, v31
  v_mul_f32 v2, v2, v80
  v_mfma_f32_32x32x16_bf16 v[128:143], v[244:247], a[200:203], v[128:143]
  buffer_load_dwordx4 v10, s[12:15], s42 offen offset:2048 lds
  v_mul_f32 v3, v3, v81
  v_mul_f32 v4, v4, v82
  v_mul_f32 v5, v5, v83
  v_mfma_f32_32x32x16_bf16 v[144:159], v[244:247], a[204:207], v[144:159]
  v_exp_f32 v2, v2
  v_exp_f32 v3, v3
  v_exp_f32 v4, v4
  v_mfma_f32_32x32x16_bf16 v[128:143], v[248:251], a[208:211], v[128:143]
  s_waitcnt vmcnt(13)
  buffer_load_dwordx4 v11, s[12:15], s42 offen offset:3072 lds
  ds_read_b64_tr_b16 v[48:49], v20 offset:20480
  ds_read_b64_tr_b16 v[50:51], v20 offset:20736
  v_mfma_f32_32x32x16_bf16 v[144:159], v[248:251], a[212:215], v[144:159]
  ds_read_b64_tr_b16 v[52:53], v20 offset:21504
  ds_read_b64_tr_b16 v[54:55], v20 offset:21760
  v_exp_f32 v5, v5
  v_add_f32 v2, 1.0, v2
  v_add_f32 v3, 1.0, v3
  v_mfma_f32_32x32x16_bf16 v[128:143], v[252:255], a[216:219], v[128:143]
  s_waitcnt lgkmcnt(12)
  s_add_u32 m0, s36, 12288
  s_mov_b32 s42, 256
  buffer_load_dwordx4 v8, s[12:15], s42 offen offset:0 lds
  ds_read_b64_tr_b16 v[56:57], v20 offset:22528
  v_mfma_f32_32x32x16_bf16 v[144:159], v[252:255], a[220:223], v[144:159]
  ds_read_b64_tr_b16 v[58:59], v20 offset:22784
  ds_read_b64_tr_b16 v[60:61], v20 offset:23552
  v_add_f32 v4, 1.0, v4
  v_add_f32 v5, 1.0, v5
  v_rcp_f32 v2, v2
  v_mfma_f32_32x32x16_bf16 v[96:111], a[224:227], a[0:3], 0
  buffer_load_dwordx4 v9, s[12:15], s42 offen offset:1024 lds
  ds_read_b64_tr_b16 v[62:63], v20 offset:23808
  v_rcp_f32 v3, v3
  v_mfma_f32_32x32x16_bf16 v[112:127], a[224:227], a[4:7], 0
  v_rcp_f32 v4, v4
  v_rcp_f32 v5, v5
  v_mul_f32 v80, v80, v2
  v_mul_f32 v81, v81, v3
  v_mfma_f32_32x32x16_bf16 v[96:111], a[228:231], a[8:11], v[96:111]
  buffer_load_dwordx4 v10, s[12:15], s42 offen offset:2048 lds
  v_mul_f32 v82, v82, v4
  v_mul_f32 v83, v83, v5
  v_mul_f32 v2, v84, v84
  v_mul_f32 v3, v85, v85
  v_mfma_f32_32x32x16_bf16 v[112:127], a[228:231], a[12:15], v[112:127]
  v_mul_f32 v4, v86, v86
  v_mul_f32 v5, v87, v87
  v_fma_f32 v2, v2, v30, v31
  v_fma_f32 v3, v3, v30, v31
  v_fma_f32 v4, v4, v30, v31
  v_fma_f32 v5, v5, v30, v31
  v_mfma_f32_32x32x16_bf16 v[96:111], a[232:235], a[16:19], v[96:111]
  s_waitcnt vmcnt(13)
  buffer_load_dwordx4 v11, s[12:15], s42 offen offset:3072 lds
  ds_read_b64_tr_b16 v[224:225], v20 offset:0
  ds_read_b64_tr_b16 v[226:227], v20 offset:256
  v_mul_f32 v2, v2, v84
  v_mfma_f32_32x32x16_bf16 v[112:127], a[232:235], a[20:23], v[112:127]
  ds_read_b64_tr_b16 v[228:229], v20 offset:1024
  ds_read_b64_tr_b16 v[230:231], v20 offset:1280
  v_mul_f32 v3, v3, v85
  v_mul_f32 v4, v4, v86
  v_mul_f32 v5, v5, v87
  v_mfma_f32_32x32x16_bf16 v[96:111], a[236:239], a[24:27], v[96:111]
  s_waitcnt lgkmcnt(12)
  s_add_u32 m0, s36, 16384
  s_mov_b32 s42, 229632
  buffer_load_dwordx4 v8, s[12:15], s42 offen offset:0 lds
  ds_read_b64_tr_b16 v[232:233], v20 offset:2048
  v_mfma_f32_32x32x16_bf16 v[112:127], a[236:239], a[28:31], v[112:127]
  ds_read_b64_tr_b16 v[234:235], v20 offset:2304
  ds_read_b64_tr_b16 v[236:237], v20 offset:3072
  v_exp_f32 v2, v2
  v_exp_f32 v3, v3
  v_mfma_f32_32x32x16_bf16 v[96:111], a[240:243], a[32:35], v[96:111]
  buffer_load_dwordx4 v9, s[12:15], s42 offen offset:1024 lds
  ds_read_b64_tr_b16 v[238:239], v20 offset:3328
  v_exp_f32 v4, v4
  v_mfma_f32_32x32x16_bf16 v[112:127], a[240:243], a[36:39], v[112:127]
  v_exp_f32 v5, v5
  v_add_f32 v2, 1.0, v2
  v_add_f32 v3, 1.0, v3
  v_add_f32 v4, 1.0, v4
  v_add_f32 v5, 1.0, v5
  v_mfma_f32_32x32x16_bf16 v[96:111], a[244:247], a[40:43], v[96:111]
  buffer_load_dwordx4 v10, s[12:15], s42 offen offset:2048 lds
  v_rcp_f32 v2, v2
  v_rcp_f32 v3, v3
  v_mfma_f32_32x32x16_bf16 v[112:127], a[244:247], a[44:47], v[112:127]
  v_rcp_f32 v4, v4
  v_rcp_f32 v5, v5
  v_mul_f32 v84, v84, v2
  v_mul_f32 v85, v85, v3
  v_mfma_f32_32x32x16_bf16 v[96:111], a[248:251], a[48:51], v[96:111]
  s_waitcnt vmcnt(12)
  buffer_load_dwordx4 v11, s[12:15], s42 offen offset:3072 lds
  ds_read_b64_tr_b16 v[240:241], v20 offset:4096
  ds_read_b64_tr_b16 v[242:243], v20 offset:4352
  v_mul_f32 v86, v86, v4
  v_mfma_f32_32x32x16_bf16 v[112:127], a[248:251], a[52:55], v[112:127]
  ds_read_b64_tr_b16 v[244:245], v20 offset:5120
  ds_read_b64_tr_b16 v[246:247], v20 offset:5376
  v_mul_f32 v87, v87, v5
  v_mul_f32 v2, v88, v88
  v_mul_f32 v3, v89, v89
  v_mul_f32 v4, v90, v90
  v_mfma_f32_32x32x16_bf16 v[96:111], a[252:255], a[56:59], v[96:111]
  s_waitcnt lgkmcnt(12)
  s_add_u32 m0, s36, 20480
  s_mov_b32 s42, 459008
  buffer_load_dwordx4 v8, s[12:15], s42 offen offset:0 lds
  ds_read_b64_tr_b16 v[248:249], v20 offset:6144
  v_mfma_f32_32x32x16_bf16 v[112:127], a[252:255], a[60:63], v[112:127]
  ds_read_b64_tr_b16 v[250:251], v20 offset:6400
  ds_read_b64_tr_b16 v[252:253], v20 offset:7168
  v_mul_f32 v5, v91, v91
  v_fma_f32 v2, v2, v30, v31
  v_fma_f32 v3, v3, v30, v31
  v_fma_f32 v4, v4, v30, v31
  v_mfma_f32_32x32x16_bf16 v[96:111], v[32:35], a[64:67], v[96:111]
  buffer_load_dwordx4 v9, s[12:15], s42 offen offset:1024 lds
  ds_read_b64_tr_b16 v[254:255], v20 offset:7424
  v_fma_f32 v5, v5, v30, v31
  v_mul_f32 v2, v2, v88
  v_mul_f32 v3, v3, v89
  v_mfma_f32_32x32x16_bf16 v[112:127], v[32:35], a[68:71], v[112:127]
  v_mul_f32 v4, v4, v90
  v_mul_f32 v5, v5, v91
  v_exp_f32 v2, v2
  v_exp_f32 v3, v3
  v_mfma_f32_32x32x16_bf16 v[96:111], v[36:39], a[72:75], v[96:111]
  buffer_load_dwordx4 v10, s[12:15], s42 offen offset:2048 lds
  v_exp_f32 v4, v4
  v_exp_f32 v5, v5
  v_mfma_f32_32x32x16_bf16 v[112:127], v[36:39], a[76:79], v[112:127]
  v_add_f32 v2, 1.0, v2
  v_add_f32 v3, 1.0, v3
  v_add_f32 v4, 1.0, v4
  v_add_f32 v5, 1.0, v5
  v_rcp_f32 v2, v2
  v_mfma_f32_32x32x16_bf16 v[96:111], v[40:43], a[80:83], v[96:111]
  s_waitcnt vmcnt(11)
  buffer_load_dwordx4 v11, s[12:15], s42 offen offset:3072 lds
  ds_read_b64_tr_b16 a[224:225], v20 offset:8192
  ds_read_b64_tr_b16 a[226:227], v20 offset:8448
  v_mfma_f32_32x32x16_bf16 v[112:127], v[40:43], a[84:87], v[112:127]
  ds_read_b64_tr_b16 a[228:229], v20 offset:9216
  ds_read_b64_tr_b16 a[230:231], v20 offset:9472
  v_rcp_f32 v3, v3
  v_rcp_f32 v4, v4
  v_mfma_f32_32x32x16_bf16 v[96:111], v[44:47], a[88:91], v[96:111]
  s_waitcnt lgkmcnt(12)
  s_add_u32 m0, s36, 0
  s_mov_b32 s42, 688384
  buffer_load_dwordx4 v8, s[12:15], s42 offen offset:0 lds
  ds_read_b64_tr_b16 a[232:233], v20 offset:10240
  v_mfma_f32_32x32x16_bf16 v[112:127], v[44:47], a[92:95], v[112:127]
  ds_read_b64_tr_b16 a[234:235], v20 offset:10496
  ds_read_b64_tr_b16 a[236:237], v20 offset:11264
  v_rcp_f32 v5, v5
  v_mul_f32 v88, v88, v2
  v_mul_f32 v89, v89, v3
  v_mfma_f32_32x32x16_bf16 v[96:111], v[48:51], a[96:99], v[96:111]
  buffer_load_dwordx4 v9, s[12:15], s42 offen offset:1024 lds
  ds_read_b64_tr_b16 a[238:239], v20 offset:11520
  v_mul_f32 v90, v90, v4
  v_mul_f32 v91, v91, v5
  v_mul_f32 v2, v92, v92
  v_mfma_f32_32x32x16_bf16 v[112:127], v[48:51], a[100:103], v[112:127]
  v_mul_f32 v3, v93, v93
  v_mul_f32 v4, v94, v94
  v_mul_f32 v5, v95, v95
  v_fma_f32 v2, v2, v30, v31
  v_fma_f32 v3, v3, v30, v31
  v_fma_f32 v4, v4, v30, v31
  v_mfma_f32_32x32x16_bf16 v[96:111], v[52:55], a[104:107], v[96:111]
  buffer_load_dwordx4 v10, s[12:15], s42 offen offset:2048 lds
  v_fma_f32 v5, v5, v30, v31
  v_mul_f32 v2, v2, v92
  v_mul_f32 v3, v3, v93
  v_mul_f32 v4, v4, v94
  v_mfma_f32_32x32x16_bf16 v[112:127], v[52:55], a[108:111], v[112:127]
  v_mul_f32 v5, v5, v95
  v_exp_f32 v2, v2
  v_exp_f32 v3, v3
  v_mfma_f32_32x32x16_bf16 v[96:111], v[56:59], a[112:115], v[96:111]
  s_waitcnt vmcnt(11)
  buffer_load_dwordx4 v11, s[12:15], s42 offen offset:3072 lds
  ds_read_b64_tr_b16 a[240:241], v20 offset:12288
  ds_read_b64_tr_b16 a[242:243], v20 offset:12544
  v_mfma_f32_32x32x16_bf16 v[112:127], v[56:59], a[116:119], v[112:127]
  ds_read_b64_tr_b16 a[244:245], v20 offset:13312
  ds_read_b64_tr_b16 a[246:247], v20 offset:13568
  v_exp_f32 v4, v4
  v_exp_f32 v5, v5
  v_mfma_f32_32x32x16_bf16 v[96:111], v[60:63], a[120:123], v[96:111]
  s_waitcnt lgkmcnt(12)
  s_add_u32 m0, s36, 4096
  s_mov_b32 s42, 917760
  buffer_load_dwordx4 v8, s[12:15], s42 offen offset:0 lds
  ds_read_b64_tr_b16 a[248:249], v20 offset:14336
  v_mfma_f32_32x32x16_bf16 v[112:127], v[60:63], a[124:127], v[112:127]
  ds_read_b64_tr_b16 a[250:251], v20 offset:14592
  ds_read_b64_tr_b16 a[252:253], v20 offset:15360
  v_add_f32 v2, 1.0, v2
  v_add_f32 v3, 1.0, v3
  v_add_f32 v4, 1.0, v4
  v_add_f32 v5, 1.0, v5
  v_mfma_f32_32x32x16_bf16 v[96:111], v[224:227], a[128:131], v[96:111]
  buffer_load_dwordx4 v9, s[12:15], s42 offen offset:1024 lds
  ds_read_b64_tr_b16 a[254:255], v20 offset:15616
  v_rcp_f32 v2, v2
  v_mfma_f32_32x32x16_bf16 v[112:127], v[224:227], a[132:135], v[112:127]
  v_rcp_f32 v3, v3
  v_rcp_f32 v4, v4
  v_rcp_f32 v5, v5
  v_mfma_f32_32x32x16_bf16 v[96:111], v[228:231], a[136:139], v[96:111]
  buffer_load_dwordx4 v10, s[12:15], s42 offen offset:2048 lds
  v_mul_f32 v92, v92, v2
  v_mul_f32 v93, v93, v3
  v_mul_f32 v94, v94, v4
  v_mul_f32 v95, v95, v5
  v_mfma_f32_32x32x16_bf16 v[112:127], v[228:231], a[140:143], v[112:127]
  v_mul_f32 v2, v128, v128
  v_mul_f32 v3, v129, v129
  v_mul_f32 v4, v130, v130
  v_mul_f32 v5, v131, v131
  v_fma_f32 v2, v2, v30, v31
  v_fma_f32 v3, v3, v30, v31
  v_mfma_f32_32x32x16_bf16 v[96:111], v[232:235], a[144:147], v[96:111]
  s_waitcnt vmcnt(11)
  buffer_load_dwordx4 v11, s[12:15], s42 offen offset:3072 lds
  ds_read_b64_tr_b16 v[32:33], v20 offset:16384
  ds_read_b64_tr_b16 v[34:35], v20 offset:16640
  v_fma_f32 v4, v4, v30, v31
  v_mfma_f32_32x32x16_bf16 v[112:127], v[232:235], a[148:151], v[112:127]
  ds_read_b64_tr_b16 v[36:37], v20 offset:17408
  ds_read_b64_tr_b16 v[38:39], v20 offset:17664
  v_fma_f32 v5, v5, v30, v31
  v_mul_f32 v2, v2, v128
  v_mul_f32 v3, v3, v129
  v_mul_f32 v4, v4, v130
  v_mfma_f32_32x32x16_bf16 v[96:111], v[236:239], a[152:155], v[96:111]
  s_waitcnt lgkmcnt(12)
  s_add_u32 m0, s36, 8192
  s_mov_b32 s42, 1147136
  buffer_load_dwordx4 v8, s[12:15], s42 offen offset:0 lds
  ds_read_b64_tr_b16 v[40:41], v20 offset:18432
  v_mfma_f32_32x32x16_bf16 v[112:127], v[236:239], a[156:159], v[112:127]
  ds_read_b64_tr_b16 v[42:43], v20 offset:18688
  ds_read_b64_tr_b16 v[44:45], v20 offset:19456
  v_mul_f32 v5, v5, v131
  v_exp_f32 v2, v2
  v_mfma_f32_32x32x16_bf16 v[96:111], v[240:243], a[160:163], v[96:111]
  buffer_load_dwordx4 v9, s[12:15], s42 offen offset:1024 lds
  ds_read_b64_tr_b16 v[46:47], v20 offset:19712
  v_exp_f32 v3, v3
  v_mfma_f32_32x32x16_bf16 v[112:127], v[240:243], a[164:167], v[112:127]
  v_exp_f32 v4, v4
  v_exp_f32 v5, v5
  v_add_f32 v2, 1.0, v2
  v_add_f32 v3, 1.0, v3
  v_mfma_f32_32x32x16_bf16 v[96:111], v[244:247], a[168:171], v[96:111]
  buffer_load_dwordx4 v10, s[12:15], s42 offen offset:2048 lds
  v_add_f32 v4, 1.0, v4
  v_add_f32 v5, 1.0, v5
  v_rcp_f32 v2, v2
  v_mfma_f32_32x32x16_bf16 v[112:127], v[244:247], a[172:175], v[112:127]
  v_rcp_f32 v3, v3
  v_rcp_f32 v4, v4
  v_rcp_f32 v5, v5
  v_mfma_f32_32x32x16_bf16 v[96:111], v[248:251], a[176:179], v[96:111]
  s_waitcnt vmcnt(11)
  buffer_load_dwordx4 v11, s[12:15], s42 offen offset:3072 lds
  ds_read_b64_tr_b16 v[48:49], v20 offset:20480
  ds_read_b64_tr_b16 v[50:51], v20 offset:20736
  v_mul_f32 v128, v128, v2
  v_mfma_f32_32x32x16_bf16 v[112:127], v[248:251], a[180:183], v[112:127]
  ds_read_b64_tr_b16 v[52:53], v20 offset:21504
  ds_read_b64_tr_b16 v[54:55], v20 offset:21760
  v_mul_f32 v129, v129, v3
  v_mul_f32 v130, v130, v4
  v_mul_f32 v131, v131, v5
  v_mul_f32 v2, v132, v132
  v_mfma_f32_32x32x16_bf16 v[96:111], v[252:255], a[184:187], v[96:111]
  s_waitcnt lgkmcnt(12)
  s_add_u32 m0, s36, 12288
  s_mov_b32 s42, 1376512
  buffer_load_dwordx4 v8, s[12:15], s42 offen offset:0 lds
  ds_read_b64_tr_b16 v[56:57], v20 offset:22528
  v_mfma_f32_32x32x16_bf16 v[112:127], v[252:255], a[188:191], v[112:127]
  ds_read_b64_tr_b16 v[58:59], v20 offset:22784
  ds_read_b64_tr_b16 v[60:61], v20 offset:23552
  v_mul_f32 v3, v133, v133
  v_mul_f32 v4, v134, v134
  v_mul_f32 v5, v135, v135
  v_fma_f32 v2, v2, v30, v31
  v_mfma_f32_32x32x16_bf16 v[96:111], a[224:227], a[192:195], v[96:111]
  buffer_load_dwordx4 v9, s[12:15], s42 offen offset:1024 lds
  ds_read_b64_tr_b16 v[62:63], v20 offset:23808
  v_fma_f32 v3, v3, v30, v31
  v_fma_f32 v4, v4, v30, v31
  v_fma_f32 v5, v5, v30, v31
  v_mfma_f32_32x32x16_bf16 v[112:127], a[224:227], a[196:199], v[112:127]
  v_mul_f32 v2, v2, v132
  v_mul_f32 v3, v3, v133
  v_mul_f32 v4, v4, v134
  v_mul_f32 v5, v5, v135
  v_exp_f32 v2, v2
  v_mfma_f32_32x32x16_bf16 v[96:111], a[228:231], a[200:203], v[96:111]
  buffer_load_dwordx4 v10, s[12:15], s42 offen offset:2048 lds
  v_exp_f32 v3, v3
  v_exp_f32 v4, v4
  v_mfma_f32_32x32x16_bf16 v[112:127], a[228:231], a[204:207], v[112:127]
  v_exp_f32 v5, v5
  v_add_f32 v2, 1.0, v2
  v_add_f32 v3, 1.0, v3
  v_add_f32 v4, 1.0, v4
  v_add_f32 v5, 1.0, v5
  v_mfma_f32_32x32x16_bf16 v[96:111], a[232:235], a[208:211], v[96:111]
  s_waitcnt vmcnt(11)
  buffer_load_dwordx4 v11, s[12:15], s42 offen offset:3072 lds
  ds_read_b64_tr_b16 v[224:225], v20 offset:0
  ds_read_b64_tr_b16 v[226:227], v20 offset:256
  v_mfma_f32_32x32x16_bf16 v[112:127], a[232:235], a[212:215], v[112:127]
  ds_read_b64_tr_b16 v[228:229], v20 offset:1024
  ds_read_b64_tr_b16 v[230:231], v20 offset:1280
  v_rcp_f32 v2, v2
  v_rcp_f32 v3, v3
  v_mfma_f32_32x32x16_bf16 v[96:111], a[236:239], a[216:219], v[96:111]
  s_waitcnt lgkmcnt(12)
  s_add_u32 m0, s36, 16384
  s_mov_b32 s42, 0
  buffer_load_dwordx4 v12, s[16:19], s42 offen offset:0 lds
  ds_read_b64_tr_b16 v[232:233], v20 offset:2048
  v_mfma_f32_32x32x16_bf16 v[112:127], a[236:239], a[220:223], v[112:127]
  ds_read_b64_tr_b16 v[234:235], v20 offset:2304
  ds_read_b64_tr_b16 v[236:237], v20 offset:3072
  v_rcp_f32 v4, v4
  v_rcp_f32 v5, v5
  v_mfma_f32_32x32x16_bf16 v[160:175], a[240:243], a[0:3], 0
  buffer_load_dwordx4 v13, s[16:19], s42 offen offset:1024 lds
  ds_read_b64_tr_b16 v[238:239], v20 offset:3328
  v_mul_f32 v132, v132, v2
  v_mul_f32 v133, v133, v3
  v_mul_f32 v134, v134, v4
  v_mfma_f32_32x32x16_bf16 v[176:191], a[240:243], a[4:7], 0
  v_mul_f32 v135, v135, v5
  v_mul_f32 v2, v136, v136
  v_mul_f32 v3, v137, v137
  v_mul_f32 v4, v138, v138
  v_mul_f32 v5, v139, v139
  v_fma_f32 v2, v2, v30, v31
  v_mfma_f32_32x32x16_bf16 v[160:175], a[244:247], a[8:11], v[160:175]
  buffer_load_dwordx4 v14, s[16:19], s42 offen offset:2048 lds
  v_mul_f32 v96, v64, v96
  v_mul_f32 v97, v65, v97
  v_fma_f32 v3, v3, v30, v31
  v_fma_f32 v4, v4, v30, v31
  v_mfma_f32_32x32x16_bf16 v[176:191], a[244:247], a[12:15], v[176:191]
  v_mul_f32 v98, v66, v98
  v_mul_f32 v99, v67, v99
  v_fma_f32 v5, v5, v30, v31
  v_mul_f32 v2, v2, v136
  v_mul_f32 v3, v3, v137
  v_mul_f32 v4, v4, v138
  v_mfma_f32_32x32x16_bf16 v[160:175], a[248:251], a[16:19], v[160:175]
  s_waitcnt vmcnt(11)
  buffer_load_dwordx4 v15, s[16:19], s42 offen offset:3072 lds
  ds_read_b64_tr_b16 v[240:241], v20 offset:4096
  ds_read_b64_tr_b16 v[242:243], v20 offset:4352
  v_cvt_pk_bf16_f32 v64, v96, v97
  v_mfma_f32_32x32x16_bf16 v[176:191], a[248:251], a[20:23], v[176:191]
  ds_read_b64_tr_b16 v[244:245], v20 offset:5120
  ds_read_b64_tr_b16 v[246:247], v20 offset:5376
  v_cvt_pk_bf16_f32 v65, v98, v99
  v_mul_f32 v100, v68, v100
  v_mul_f32 v5, v5, v139
  v_mfma_f32_32x32x16_bf16 v[160:175], a[252:255], a[24:27], v[160:175]
  s_waitcnt lgkmcnt(12)
  s_add_u32 m0, s36, 20480
  s_mov_b32 s42, 57344
  buffer_load_dwordx4 v12, s[16:19], s42 offen offset:0 lds
  ds_read_b64_tr_b16 v[248:249], v20 offset:6144
  v_mfma_f32_32x32x16_bf16 v[176:191], a[252:255], a[28:31], v[176:191]
  ds_read_b64_tr_b16 v[250:251], v20 offset:6400
  ds_read_b64_tr_b16 v[252:253], v20 offset:7168
  v_mul_f32 v101, v69, v101
  v_mul_f32 v102, v70, v102
  v_mul_f32 v103, v71, v103
  v_cvt_pk_bf16_f32 v66, v100, v101
  v_mfma_f32_32x32x16_bf16 v[160:175], v[32:35], a[32:35], v[160:175]
  buffer_load_dwordx4 v13, s[16:19], s42 offen offset:1024 lds
  v_exp_f32 v2, v2
  v_exp_f32 v3, v3
  v_exp_f32 v4, v4
  v_mfma_f32_32x32x16_bf16 v[176:191], v[32:35], a[36:39], v[176:191]
  ds_read_b64_tr_b16 v[254:255], v20 offset:7424
  v_cvt_pk_bf16_f32 v67, v102, v103
  v_mul_f32 v104, v72, v104
  v_exp_f32 v5, v5
  v_add_f32 v2, 1.0, v2
  v_mfma_f32_32x32x16_bf16 v[160:175], v[36:39], a[40:43], v[160:175]
  buffer_load_dwordx4 v14, s[16:19], s42 offen offset:2048 lds
  v_mul_f32 v105, v73, v105
  v_add_f32 v3, 1.0, v3
  v_add_f32 v4, 1.0, v4
  v_add_f32 v5, 1.0, v5
  v_mfma_f32_32x32x16_bf16 v[176:191], v[36:39], a[44:47], v[176:191]
  v_mul_f32 v106, v74, v106
  v_mul_f32 v107, v75, v107
  v_rcp_f32 v2, v2
  v_rcp_f32 v3, v3
  v_rcp_f32 v4, v4
  v_mfma_f32_32x32x16_bf16 v[160:175], v[40:43], a[48:51], v[160:175]
  s_waitcnt vmcnt(11)
  buffer_load_dwordx4 v15, s[16:19], s42 offen offset:3072 lds
  v_cvt_pk_bf16_f32 v68, v104, v105
  v_cvt_pk_bf16_f32 v69, v106, v107
  v_rcp_f32 v5, v5
  v_mul_f32 v136, v136, v2
  v_mfma_f32_32x32x16_bf16 v[176:191], v[40:43], a[52:55], v[176:191]
  ds_read_b64_tr_b16 a[224:225], v20 offset:8192
  ds_read_b64_tr_b16 a[226:227], v20 offset:8448
  v_mul_f32 v108, v76, v108
  v_mul_f32 v109, v77, v109
  v_mul_f32 v137, v137, v3
  v_mul_f32 v138, v138, v4
  v_mul_f32 v139, v139, v5
  v_mfma_f32_32x32x16_bf16 v[160:175], v[44:47], a[56:59], v[160:175]
  ds_read_b64_tr_b16 a[228:229], v20 offset:9216
  ds_read_b64_tr_b16 a[230:231], v20 offset:9472
  s_waitcnt lgkmcnt(12)
  s_add_u32 m0, s36, 0
  s_mov_b32 s42, 256
  buffer_load_dwordx4 v12, s[16:19], s42 offen offset:0 lds
  v_mul_f32 v110, v78, v110
  v_mul_f32 v2, v140, v140
  v_mul_f32 v3, v141, v141
  v_mfma_f32_32x32x16_bf16 v[176:191], v[44:47], a[60:63], v[176:191]
  ds_read_b64_tr_b16 a[232:233], v20 offset:10240
  v_mul_f32 v111, v79, v111
  v_cvt_pk_bf16_f32 v70, v108, v109
  v_mul_f32 v4, v142, v142
  v_mul_f32 v5, v143, v143
  v_fma_f32 v2, v2, v30, v31
  v_mfma_f32_32x32x16_bf16 v[160:175], v[48:51], a[64:67], v[160:175]
  ds_read_b64_tr_b16 a[234:235], v20 offset:10496
  ds_read_b64_tr_b16 a[236:237], v20 offset:11264
  buffer_load_dwordx4 v13, s[16:19], s42 offen offset:1024 lds
  v_cvt_pk_bf16_f32 v71, v110, v111
  v_mul_f32 v112, v80, v112
  v_fma_f32 v3, v3, v30, v31
  v_fma_f32 v4, v4, v30, v31
  v_mfma_f32_32x32x16_bf16 v[176:191], v[48:51], a[68:71], v[176:191]
  ds_read_b64_tr_b16 a[238:239], v20 offset:11520
  v_mul_f32 v113, v81, v113
  v_mul_f32 v114, v82, v114
  v_fma_f32 v5, v5, v30, v31
  v_mul_f32 v2, v2, v140
  v_mul_f32 v3, v3, v141
  v_mfma_f32_32x32x16_bf16 v[160:175], v[52:55], a[72:75], v[160:175]
  buffer_load_dwordx4 v14, s[16:19], s42 offen offset:2048 lds
  v_mul_f32 v115, v83, v115
  v_mul_f32 v4, v4, v142
  v_mul_f32 v5, v5, v143
  v_cvt_pk_bf16_f32 v80, v112, v113
  v_mfma_f32_32x32x16_bf16 v[176:191], v[52:55], a[76:79], v[176:191]
  v_cvt_pk_bf16_f32 v81, v114, v115
  v_exp_f32 v2, v2
  v_exp_f32 v3, v3
  v_exp_f32 v4, v4
  v_mfma_f32_32x32x16_bf16 v[160:175], v[56:59], a[80:83], v[160:175]
  s_waitcnt vmcnt(11)
  buffer_load_dwordx4 v15, s[16:19], s42 offen offset:3072 lds
  v_mul_f32 v116, v84, v116
  v_mul_f32 v117, v85, v117
  v_exp_f32 v5, v5
  v_add_f32 v2, 1.0, v2
  v_add_f32 v3, 1.0, v3
  v_mfma_f32_32x32x16_bf16 v[176:191], v[56:59], a[84:87], v[176:191]
  ds_read_b64_tr_b16 a[240:241], v20 offset:12288
  ds_read_b64_tr_b16 a[242:243], v20 offset:12544
  v_mul_f32 v118, v86, v118
  v_mul_f32 v119, v87, v119
  v_add_f32 v4, 1.0, v4
  v_add_f32 v5, 1.0, v5
  v_mfma_f32_32x32x16_bf16 v[160:175], v[60:63], a[88:91], v[160:175]
  ds_read_b64_tr_b16 a[244:245], v20 offset:13312
  ds_read_b64_tr_b16 a[246:247], v20 offset:13568
  s_waitcnt lgkmcnt(12)
  s_add_u32 m0, s36, 4096
  s_mov_b32 s42, 57600
  buffer_load_dwordx4 v12, s[16:19], s42 offen offset:0 lds
  v_cvt_pk_bf16_f32 v82, v116, v117
  v_rcp_f32 v2, v2
  v_rcp_f32 v3, v3
  v_rcp_f32 v4, v4
  v_mfma_f32_32x32x16_bf16 v[176:191], v[60:63], a[92:95], v[176:191]
  ds_read_b64_tr_b16 a[248:249], v20 offset:14336
  v_cvt_pk_bf16_f32 v83, v118, v119
  v_mul_f32 v120, v88, v120
  v_rcp_f32 v5, v5
  v_mul_f32 v140, v140, v2
  v_mfma_f32_32x32x16_bf16 v[160:175], v[224:227], a[96:99], v[160:175]
  ds_read_b64_tr_b16 a[250:251], v20 offset:14592
  ds_read_b64_tr_b16 a[252:253], v20 offset:15360
  buffer_load_dwordx4 v13, s[16:19], s42 offen offset:1024 lds
  v_mul_f32 v121, v89, v121
  v_mul_f32 v122, v90, v122
  v_mul_f32 v141, v141, v3
  v_mul_f32 v142, v142, v4
  v_mul_f32 v143, v143, v5
  v_mfma_f32_32x32x16_bf16 v[176:191], v[224:227], a[100:103], v[176:191]
  ds_read_b64_tr_b16 a[254:255], v20 offset:15616
  v_mul_f32 v123, v91, v123
  v_cvt_pk_bf16_f32 v84, v120, v121
  v_mul_f32 v2, v144, v144
  v_mul_f32 v3, v145, v145
  v_cvt_pk_bf16_f32 v85, v122, v123
  v_mfma_f32_32x32x16_bf16 v[160:175], v[228:231], a[104:107], v[160:175]
  buffer_load_dwordx4 v14, s[16:19], s42 offen offset:2048 lds
  v_mul_f32 v4, v146, v146
  v_mul_f32 v5, v147, v147
  v_fma_f32 v2, v2, v30, v31
  v_mul_f32 v124, v92, v124
  v_mfma_f32_32x32x16_bf16 v[176:191], v[228:231], a[108:111], v[176:191]
  v_mul_f32 v125, v93, v125
  v_fma_f32 v3, v3, v30, v31
  v_fma_f32 v4, v4, v30, v31
  v_fma_f32 v5, v5, v30, v31
  v_mul_f32 v126, v94, v126
  v_mul_f32 v127, v95, v127
  v_mfma_f32_32x32x16_bf16 v[160:175], v[232:235], a[112:115], v[160:175]
  s_waitcnt vmcnt(11)
  buffer_load_dwordx4 v15, s[16:19], s42 offen offset:3072 lds
  ds_read_b64_tr_b16 v[32:33], v21 offset:16384
  v_mul_f32 v2, v2, v144
  v_mul_f32 v3, v3, v145
  v_mfma_f32_32x32x16_bf16 v[176:191], v[232:235], a[116:119], v[176:191]
  ds_read_b64_tr_b16 v[34:35], v21 offset:16896
  v_cvt_pk_bf16_f32 v86, v124, v125
  v_cvt_pk_bf16_f32 v87, v126, v127
  v_mul_f32 v4, v4, v146
  v_mul_f32 v5, v5, v147
  v_exp_f32 v2, v2
  v_mfma_f32_32x32x16_bf16 v[160:175], v[236:239], a[120:123], v[160:175]
  ds_read_b64_tr_b16 v[36:37], v21 offset:17408
  ds_read_b64_tr_b16 v[38:39], v21 offset:17920
  ds_write_b128 v27, v[64:67] offset:0
  ds_write_b128 v27, v[68:71] offset:1024
  ds_write_b128 v27, v[80:83] offset:2048
  ds_write_b128 v27, v[84:87] offset:3072
  v_exp_f32 v3, v3
  v_exp_f32 v4, v4
  v_mfma_f32_32x32x16_bf16 v[176:191], v[236:239], a[124:127], v[176:191]
  ds_read_b64_tr_b16 v[40:41], v21 offset:18432
  s_waitcnt lgkmcnt(15)
  s_add_u32 m0, s36, 8192
  s_mov_b32 s42, 114688
  buffer_load_dwordx4 v12, s[16:19], s42 offen offset:0 lds
  v_exp_f32 v5, v5
  v_add_f32 v2, 1.0, v2
  v_add_f32 v3, 1.0, v3
  v_mfma_f32_32x32x16_bf16 v[160:175], v[240:243], a[128:131], v[160:175]
  ds_read_b64_tr_b16 v[42:43], v21 offset:18944
  ds_read_b64_tr_b16 v[44:45], v21 offset:19456
  ds_read_b64_tr_b16 v[46:47], v21 offset:19968
  v_add_f32 v4, 1.0, v4
  v_add_f32 v5, 1.0, v5
  v_mfma_f32_32x32x16_bf16 v[176:191], v[240:243], a[132:135], v[176:191]
  buffer_load_dwordx4 v13, s[16:19], s42 offen offset:1024 lds
  v_rcp_f32 v2, v2
  v_rcp_f32 v3, v3
  v_rcp_f32 v4, v4
  v_mfma_f32_32x32x16_bf16 v[160:175], v[244:247], a[136:139], v[160:175]
  s_waitcnt lgkmcnt(4)
  s_barrier
  v_rcp_f32 v5, v5
  v_mul_f32 v144, v144, v2
  v_mul_f32 v145, v145, v3
  v_mfma_f32_32x32x16_bf16 v[176:191], v[244:247], a[140:143], v[176:191]
  buffer_load_dwordx4 v14, s[16:19], s42 offen offset:2048 lds
  ds_read_b128 a[0:3], v22 offset:0
  ds_read_b128 a[8:11], v22 offset:1024
  v_mul_f32 v146, v146, v4
  v_mul_f32 v147, v147, v5
  v_mfma_f32_32x32x16_bf16 v[160:175], v[248:251], a[144:147], v[160:175]
  s_waitcnt vmcnt(11)
  ds_read_b64_tr_b16 v[48:49], v21 offset:20480
  ds_read_b64_tr_b16 v[50:51], v21 offset:20992
  v_mul_f32 v2, v148, v148
  v_mul_f32 v3, v149, v149
  v_mul_f32 v4, v150, v150
  v_mfma_f32_32x32x16_bf16 v[176:191], v[248:251], a[148:151], v[176:191]
  buffer_load_dwordx4 v15, s[16:19], s42 offen offset:3072 lds
  ds_read_b128 a[16:19], v22 offset:4096
  ds_read_b64_tr_b16 v[52:53], v21 offset:21504
  v_mul_f32 v5, v151, v151
  v_fma_f32 v2, v2, v30, v31
  v_mfma_f32_32x32x16_bf16 v[160:175], v[252:255], a[152:155], v[160:175]
  ds_read_b64_tr_b16 v[54:55], v21 offset:22016
  ds_read_b128 a[24:27], v22 offset:5120
  ds_read_b64_tr_b16 v[56:57], v21 offset:22528
  v_fma_f32 v3, v3, v30, v31
  v_fma_f32 v4, v4, v30, v31
  v_fma_f32 v5, v5, v30, v31
  v_mfma_f32_32x32x16_bf16 v[176:191], v[252:255], a[156:159], v[176:191]
  s_add_u32 m0, s36, 12288
  s_mov_b32 s42, 172032
  buffer_load_dwordx4 v12, s[16:19], s42 offen offset:0 lds
  ds_read_b128 a[32:35], v22 offset:8192
  v_mul_f32 v2, v2, v148
  v_mul_f32 v3, v3, v149
  v_mfma_f32_32x32x16_bf16 v[160:175], a[224:227], a[160:163], v[160:175]
  ds_read_b64_tr_b16 v[58:59], v21 offset:23040
  ds_read_b64_tr_b16 v[60:61], v21 offset:23552
  ds_read_b128 a[40:43], v22 offset:9216
  v_mul_f32 v4, v4, v150
  v_mul_f32 v5, v5, v151
  v_exp_f32 v2, v2
  v_mfma_f32_32x32x16_bf16 v[176:191], a[224:227], a[164:167], v[176:191]
  ds_read_b64_tr_b16 v[62:63], v21 offset:24064
  buffer_load_dwordx4 v13, s[16:19], s42 offen offset:1024 lds
  ds_read_b128 a[48:51], v22 offset:12288
  v_exp_f32 v3, v3
  v_exp_f32 v4, v4
  v_mfma_f32_32x32x16_bf16 v[160:175], a[228:231], a[168:171], v[160:175]
  ds_read_b128 a[56:59], v22 offset:13312
  ds_read_b128 a[4:7], v23 offset:0
  v_exp_f32 v5, v5
  v_add_f32 v2, 1.0, v2
  v_add_f32 v3, 1.0, v3
  v_mfma_f32_32x32x16_bf16 v[176:191], a[228:231], a[172:175], v[176:191]
  buffer_load_dwordx4 v14, s[16:19], s42 offen offset:2048 lds
  ds_read_b128 a[12:15], v23 offset:1024
  v_add_f32 v4, 1.0, v4
  v_add_f32 v5, 1.0, v5
  v_mfma_f32_32x32x16_bf16 v[160:175], a[232:235], a[176:179], v[160:175]
  s_waitcnt vmcnt(11)
  v_rcp_f32 v2, v2
  v_rcp_f32 v3, v3
  v_rcp_f32 v4, v4
  v_mfma_f32_32x32x16_bf16 v[176:191], a[232:235], a[180:183], v[176:191]
  ds_read_b64_tr_b16 v[224:225], v21 offset:0
  ds_read_b64_tr_b16 v[226:227], v21 offset:512
  buffer_load_dwordx4 v15, s[16:19], s42 offen offset:3072 lds
  ds_read_b128 a[20:23], v23 offset:4096
  v_rcp_f32 v5, v5
  v_mul_f32 v148, v148, v2
  v_mul_f32 v149, v149, v3
  v_mfma_f32_32x32x16_bf16 v[160:175], a[236:239], a[184:187], v[160:175]
  ds_read_b64_tr_b16 v[228:229], v21 offset:1024
  ds_read_b64_tr_b16 v[230:231], v21 offset:1536
  ds_read_b128 a[28:31], v23 offset:5120
  ds_read_b64_tr_b16 v[232:233], v21 offset:2048
  v_mul_f32 v150, v150, v4
  v_mul_f32 v151, v151, v5
  v_mfma_f32_32x32x16_bf16 v[176:191], a[236:239], a[188:191], v[176:191]
  s_waitcnt lgkmcnt(15)
  s_add_u32 m0, s36, 16384
  s_mov_b32 s42, 114944
  buffer_load_dwordx4 v12, s[16:19], s42 offen offset:0 lds
  ds_read_b128 a[36:39], v23 offset:8192
  v_mul_f32 v2, v152, v152
  v_mul_f32 v3, v153, v153
  v_mul_f32 v4, v154, v154
  v_mfma_f32_32x32x16_bf16 v[160:175], a[240:243], a[192:195], v[160:175]
  ds_read_b64_tr_b16 v[234:235], v21 offset:2560
  ds_read_b64_tr_b16 v[236:237], v21 offset:3072
  ds_read_b128 a[44:47], v23 offset:9216
  ds_read_b64_tr_b16 v[238:239], v21 offset:3584
  v_mul_f32 v5, v155, v155
  v_fma_f32 v2, v2, v30, v31
  v_mfma_f32_32x32x16_bf16 v[176:191], a[240:243], a[196:199], v[176:191]
  buffer_load_dwordx4 v13, s[16:19], s42 offen offset:1024 lds
  ds_read_b128 a[52:55], v23 offset:12288
  v_fma_f32 v3, v3, v30, v31
  v_fma_f32 v4, v4, v30, v31
  v_fma_f32 v5, v5, v30, v31
  v_mfma_f32_32x32x16_bf16 v[160:175], a[244:247], a[200:203], v[160:175]
  ds_read_b128 a[60:63], v23 offset:13312
  v_mul_f32 v2, v2, v152
  v_mul_f32 v3, v3, v153
  v_mul_f32 v4, v4, v154
  v_mul_f32 v5, v5, v155
  v_mfma_f32_32x32x16_bf16 v[176:191], a[244:247], a[204:207], v[176:191]
  buffer_load_dwordx4 v14, s[16:19], s42 offen offset:2048 lds
  v_exp_f32 v2, v2
  v_exp_f32 v3, v3
  v_mfma_f32_32x32x16_bf16 v[160:175], a[248:251], a[208:211], v[160:175]
  s_waitcnt vmcnt(11)
  ds_read_b64_tr_b16 v[240:241], v21 offset:4096
  v_exp_f32 v4, v4
  v_exp_f32 v5, v5
  v_mfma_f32_32x32x16_bf16 v[176:191], a[248:251], a[212:215], v[176:191]
  ds_read_b64_tr_b16 v[242:243], v21 offset:4608
  buffer_load_dwordx4 v15, s[16:19], s42 offen offset:3072 lds
  ds_read_b64_tr_b16 v[244:245], v21 offset:5120
  v_add_f32 v2, 1.0, v2
  v_add_f32 v3, 1.0, v3
  v_mfma_f32_32x32x16_bf16 v[160:175], a[252:255], a[216:219], v[160:175]
  ds_read_b64_tr_b16 v[246:247], v21 offset:5632
  ds_read_b64_tr_b16 v[248:249], v21 offset:6144
  v_add_f32 v4, 1.0, v4
  v_add_f32 v5, 1.0, v5
  v_rcp_f32 v2, v2
  v_mfma_f32_32x32x16_bf16 v[176:191], a[252:255], a[220:223], v[176:191]
  s_waitcnt lgkmcnt(15)
  s_add_u32 m0, s36, 20480
  s_mov_b32 s42, 172288
  buffer_load_dwordx4 v12, s[16:19], s42 offen offset:0 lds
  v_rcp_f32 v3, v3
  v_rcp_f32 v4, v4
  v_mfma_f32_32x32x16_bf16 v[64:79], v[32:35], a[0:3], 0
  ds_read_b64_tr_b16 v[250:251], v21 offset:6656
  ds_read_b64_tr_b16 v[252:253], v21 offset:7168
  v_rcp_f32 v5, v5
  v_mul_f32 v152, v152, v2
  v_mul_f32 v153, v153, v3
  v_mfma_f32_32x32x16_bf16 v[64:79], v[36:39], a[8:11], v[64:79]
  ds_read_b64_tr_b16 v[254:255], v21 offset:7680
  buffer_load_dwordx4 v13, s[16:19], s42 offen offset:1024 lds
  v_mul_f32 v154, v154, v4
  v_mul_f32 v155, v155, v5
  v_mul_f32 v2, v156, v156
  v_mfma_f32_32x32x16_bf16 v[64:79], v[40:43], a[16:19], v[64:79]
  v_mul_f32 v3, v157, v157
  v_mul_f32 v4, v158, v158
  v_mul_f32 v5, v159, v159
  v_fma_f32 v2, v2, v30, v31
  v_fma_f32 v3, v3, v30, v31
  v_fma_f32 v4, v4, v30, v31
  v_mfma_f32_32x32x16_bf16 v[64:79], v[44:47], a[24:27], v[64:79]
  buffer_load_dwordx4 v14, s[16:19], s42 offen offset:2048 lds
  v_fma_f32 v5, v5, v30, v31
  v_mul_f32 v2, v2, v156
  v_mul_f32 v3, v3, v157
  v_mul_f32 v4, v4, v158
  v_mfma_f32_32x32x16_bf16 v[64:79], v[48:51], a[32:35], v[64:79]
  v_mul_f32 v5, v5, v159
  v_exp_f32 v2, v2
  v_exp_f32 v3, v3
  v_mfma_f32_32x32x16_bf16 v[64:79], v[52:55], a[40:43], v[64:79]
  s_waitcnt vmcnt(11)
  buffer_load_dwordx4 v15, s[16:19], s42 offen offset:3072 lds
  ds_read_b64_tr_b16 a[224:225], v21 offset:8192
  ds_read_b64_tr_b16 a[226:227], v21 offset:8704
  v_mfma_f32_32x32x16_bf16 v[64:79], v[56:59], a[48:51], v[64:79]
  ds_read_b64_tr_b16 a[228:229], v21 offset:9216
  ds_read_b64_tr_b16 a[230:231], v21 offset:9728
  v_exp_f32 v4, v4
  v_exp_f32 v5, v5
  v_mfma_f32_32x32x16_bf16 v[64:79], v[60:63], a[56:59], v[64:79]
  s_waitcnt lgkmcnt(14)
  s_add_u32 m0, s36, 0
  s_mov_b32 s42, 512
  buffer_load_dwordx4 v12, s[16:19], s42 offen offset:0 lds
  ds_read_b64_tr_b16 a[232:233], v21 offset:10240
  v_mfma_f32_32x32x16_bf16 v[80:95], v[32:35], a[4:7], 0
  ds_read_b64_tr_b16 a[234:235], v21 offset:10752
  ds_read_b64_tr_b16 a[236:237], v21 offset:11264
  v_add_f32 v2, 1.0, v2
  v_add_f32 v3, 1.0, v3
  v_add_f32 v4, 1.0, v4
  v_add_f32 v5, 1.0, v5
  v_mfma_f32_32x32x16_bf16 v[80:95], v[36:39], a[12:15], v[80:95]
  buffer_load_dwordx4 v13, s[16:19], s42 offen offset:1024 lds
  ds_read_b64_tr_b16 a[238:239], v21 offset:11776
  v_rcp_f32 v2, v2
  v_mfma_f32_32x32x16_bf16 v[80:95], v[40:43], a[20:23], v[80:95]
  v_rcp_f32 v3, v3
  v_rcp_f32 v4, v4
  v_rcp_f32 v5, v5
  v_mfma_f32_32x32x16_bf16 v[80:95], v[44:47], a[28:31], v[80:95]
  buffer_load_dwordx4 v14, s[16:19], s42 offen offset:2048 lds
  v_mul_f32 v156, v156, v2
  v_mul_f32 v157, v157, v3
  v_mul_f32 v158, v158, v4
  v_mul_f32 v159, v159, v5
  v_mul_f32 v160, v128, v160
  v_mul_f32 v161, v129, v161
  v_mul_f32 v162, v130, v162
  v_mul_f32 v163, v131, v163
  v_cvt_pk_bf16_f32 v128, v160, v161
  v_cvt_pk_bf16_f32 v129, v162, v163
  v_mul_f32 v164, v132, v164
  v_mul_f32 v165, v133, v165
  v_mul_f32 v166, v134, v166
  v_mul_f32 v167, v135, v167
  v_cvt_pk_bf16_f32 v130, v164, v165
  v_mfma_f32_32x32x16_bf16 v[80:95], v[48:51], a[36:39], v[80:95]
  v_cvt_pk_bf16_f32 v131, v166, v167
  v_mul_f32 v168, v136, v168
  v_mul_f32 v169, v137, v169
  v_mul_f32 v170, v138, v170
  v_mul_f32 v171, v139, v171
  v_cvt_pk_bf16_f32 v132, v168, v169
  v_mfma_f32_32x32x16_bf16 v[80:95], v[52:55], a[44:47], v[80:95]
  s_waitcnt vmcnt(11)
  buffer_load_dwordx4 v15, s[16:19], s42 offen offset:3072 lds
  ds_read_b64_tr_b16 a[240:241], v21 offset:12288
  ds_read_b64_tr_b16 a[242:243], v21 offset:12800
  v_cvt_pk_bf16_f32 v133, v170, v171
  s_waitcnt lgkmcnt(15)
  v_mfma_f32_32x32x16_bf16 v[80:95], v[56:59], a[52:55], v[80:95]
  ds_read_b64_tr_b16 a[244:245], v21 offset:13312
  ds_read_b64_tr_b16 a[246:247], v21 offset:13824
  v_mul_f32 v172, v140, v172
  v_mul_f32 v173, v141, v173
  v_mul_f32 v174, v142, v174
  v_mul_f32 v175, v143, v175
  v_mfma_f32_32x32x16_bf16 v[80:95], v[60:63], a[60:63], v[80:95]
  s_waitcnt lgkmcnt(12)
  s_add_u32 m0, s36, 4096
  s_mov_b32 s42, 57856
  buffer_load_dwordx4 v12, s[16:19], s42 offen offset:0 lds
  v_cvt_pk_bf16_f32 v134, v172, v173
  v_cvt_pk_bf16_f32 v135, v174, v175
  v_mul_f32 v176, v144, v176
  v_mfma_f32_32x32x16_bf16 v[96:111], v[224:227], a[0:3], 0
  ds_read_b64_tr_b16 a[248:249], v21 offset:14336
  ds_read_b64_tr_b16 a[250:251], v21 offset:14848
  ds_read_b64_tr_b16 a[252:253], v21 offset:15360
  v_mul_f32 v177, v145, v177
  v_mul_f32 v178, v146, v178
  v_mul_f32 v179, v147, v179
  v_mfma_f32_32x32x16_bf16 v[96:111], v[228:231], a[8:11], v[96:111]
  buffer_load_dwordx4 v13, s[16:19], s42 offen offset:1024 lds
  v_cvt_pk_bf16_f32 v144, v176, v177
  v_cvt_pk_bf16_f32 v145, v178, v179
  v_mul_f32 v180, v148, v180
  v_mul_f32 v181, v149, v181
  v_mfma_f32_32x32x16_bf16 v[96:111], v[232:235], a[16:19], v[96:111]
  ds_read_b64_tr_b16 a[254:255], v21 offset:15872
  v_mul_f32 v182, v150, v182
  v_mul_f32 v183, v151, v183
  v_cvt_pk_bf16_f32 v146, v180, v181
  v_cvt_pk_bf16_f32 v147, v182, v183
  v_mul_f32 v184, v152, v184
  v_mfma_f32_32x32x16_bf16 v[96:111], v[236:239], a[24:27], v[96:111]
  buffer_load_dwordx4 v14, s[16:19], s42 offen offset:2048 lds
  v_mul_f32 v185, v153, v185
  v_mul_f32 v186, v154, v186
  v_mul_f32 v187, v155, v187
  v_cvt_pk_bf16_f32 v148, v184, v185
  v_mfma_f32_32x32x16_bf16 v[96:111], v[240:243], a[32:35], v[96:111]
  v_cvt_pk_bf16_f32 v149, v186, v187
  v_mul_f32 v188, v156, v188
  v_mul_f32 v189, v157, v189
  v_mul_f32 v190, v158, v190
  v_mul_f32 v191, v159, v191
  v_mfma_f32_32x32x16_bf16 v[96:111], v[244:247], a[40:43], v[96:111]
  s_waitcnt vmcnt(11)
  buffer_load_dwordx4 v15, s[16:19], s42 offen offset:3072 lds
  ds_read_b64_tr_b16 v[32:33], v21 offset:16384
  ds_read_b64_tr_b16 v[34:35], v21 offset:16896
  v_cvt_pk_bf16_f32 v150, v188, v189
  v_mfma_f32_32x32x16_bf16 v[96:111], v[248:251], a[48:51], v[96:111]
  v_cvt_pk_bf16_f32 v151, v190, v191
  ds_write_b128 v27, v[128:131] offset:16384
  ds_write_b128 v27, v[132:135] offset:17408
  ds_write_b128 v27, v[144:147] offset:18432
  ds_write_b128 v27, v[148:151] offset:19456
  v_mfma_f32_32x32x16_bf16 v[96:111], v[252:255], a[56:59], v[96:111]
  ds_read_b64_tr_b16 v[36:37], v21 offset:17408
  ds_read_b64_tr_b16 v[38:39], v21 offset:17920
  s_waitcnt lgkmcnt(15)
  s_add_u32 m0, s36, 8192
  s_mov_b32 s42, 115200
  buffer_load_dwordx4 v12, s[16:19], s42 offen offset:0 lds
  v_mfma_f32_32x32x16_bf16 v[112:127], v[224:227], a[4:7], 0
  ds_read_b64_tr_b16 v[40:41], v21 offset:18432
  ds_read_b64_tr_b16 v[42:43], v21 offset:18944
  ds_read_b64_tr_b16 v[44:45], v21 offset:19456
  v_mfma_f32_32x32x16_bf16 v[112:127], v[228:231], a[12:15], v[112:127]
  buffer_load_dwordx4 v13, s[16:19], s42 offen offset:1024 lds
  s_waitcnt lgkmcnt(5)
  s_barrier
  ds_read_b128 a[64:67], v22 offset:16384
  ds_read_b128 a[72:75], v22 offset:17408
  ds_read_b128 a[80:83], v22 offset:20480
  v_mfma_f32_32x32x16_bf16 v[112:127], v[232:235], a[20:23], v[112:127]
  ds_read_b64_tr_b16 v[46:47], v21 offset:19968
  ds_read_b128 a[88:91], v22 offset:21504
  ds_read_b128 a[96:99], v22 offset:24576
  ds_read_b128 a[104:107], v22 offset:25600
  v_mfma_f32_32x32x16_bf16 v[112:127], v[236:239], a[28:31], v[112:127]
  buffer_load_dwordx4 v14, s[16:19], s42 offen offset:2048 lds
  ds_read_b128 a[112:115], v22 offset:28672
  ds_read_b128 a[120:123], v22 offset:29696
  v_mfma_f32_32x32x16_bf16 v[112:127], v[240:243], a[36:39], v[112:127]
  ds_read_b128 a[68:71], v23 offset:16384
  ds_read_b128 a[76:79], v23 offset:17408
  ds_read_b128 a[84:87], v23 offset:20480
  v_mfma_f32_32x32x16_bf16 v[112:127], v[244:247], a[44:47], v[112:127]
  s_waitcnt vmcnt(11)
  buffer_load_dwordx4 v15, s[16:19], s42 offen offset:3072 lds
  ds_read_b128 a[92:95], v23 offset:21504
  ds_read_b128 a[100:103], v23 offset:24576
  ds_read_b128 a[108:111], v23 offset:25600
  v_mfma_f32_32x32x16_bf16 v[112:127], v[248:251], a[52:55], v[112:127]
  ds_read_b64_tr_b16 v[48:49], v21 offset:20480
  ds_read_b64_tr_b16 v[50:51], v21 offset:20992
  ds_read_b128 a[116:119], v23 offset:28672
  ds_read_b128 a[124:127], v23 offset:29696
  ds_read_b64_tr_b16 v[52:53], v21 offset:21504
  ds_read_b64_tr_b16 v[54:55], v21 offset:22016
  v_mfma_f32_32x32x16_bf16 v[112:127], v[252:255], a[60:63], v[112:127]
  s_add_u32 m0, s36, 12288
  s_mov_b32 s42, 172544
  buffer_load_dwordx4 v12, s[16:19], s42 offen offset:0 lds
  ds_read_b64_tr_b16 v[56:57], v21 offset:22528
  s_waitcnt lgkmcnt(15)
  v_mfma_f32_32x32x16_bf16 v[64:79], a[224:227], a[64:67], v[64:79]
  ds_read_b64_tr_b16 v[58:59], v21 offset:23040
  ds_read_b64_tr_b16 v[60:61], v21 offset:23552
  s_mul_i32 s54, s95, 50176
  v_mfma_f32_32x32x16_bf16 v[64:79], a[228:231], a[72:75], v[64:79]
  buffer_load_dwordx4 v13, s[16:19], s42 offen offset:1024 lds
  ds_read_b64_tr_b16 v[62:63], v21 offset:24064
  v_mfma_f32_32x32x16_bf16 v[64:79], a[232:235], a[80:83], v[64:79]
  s_add_u32 s54, s54, s97
  v_mfma_f32_32x32x16_bf16 v[64:79], a[236:239], a[88:91], v[64:79]
  buffer_load_dwordx4 v14, s[16:19], s42 offen offset:2048 lds
  v_mfma_f32_32x32x16_bf16 v[64:79], a[240:243], a[96:99], v[64:79]
  s_add_u32 s52, s54, 14336
  v_mfma_f32_32x32x16_bf16 v[64:79], a[244:247], a[104:107], v[64:79]
  s_waitcnt vmcnt(11)
  buffer_load_dwordx4 v15, s[16:19], s42 offen offset:3072 lds
  ds_read_b64_tr_b16 v[224:225], v21 offset:0
  ds_read_b64_tr_b16 v[226:227], v21 offset:512
  s_waitcnt lgkmcnt(15)
  v_mfma_f32_32x32x16_bf16 v[64:79], a[248:251], a[112:115], v[64:79]
  ds_read_b64_tr_b16 v[228:229], v21 offset:1024
  ds_read_b64_tr_b16 v[230:231], v21 offset:1536
  s_add_u32 s53, s54, 28672
  v_mfma_f32_32x32x16_bf16 v[64:79], a[252:255], a[120:123], v[64:79]
  s_add_u32 m0, s36, 16384
  s_mov_b32 s42, 0
  buffer_load_dwordx4 v16, s[16:19], s42 offen offset:0 lds
  ds_read_b64_tr_b16 v[232:233], v21 offset:2048
  v_mfma_f32_32x32x16_bf16 v[80:95], a[224:227], a[68:71], v[80:95]
  ds_read_b64_tr_b16 v[234:235], v21 offset:2560
  ds_read_b64_tr_b16 v[236:237], v21 offset:3072
  v_mfma_f32_32x32x16_bf16 v[80:95], a[228:231], a[76:79], v[80:95]
  buffer_load_dwordx4 v17, s[16:19], s42 offen offset:1024 lds
  ds_read_b64_tr_b16 v[238:239], v21 offset:3584
  s_nop 1
  v_cvt_pk_bf16_f32 v64, v64, v65
  v_cvt_pk_bf16_f32 v65, v66, v67
  v_cvt_pk_bf16_f32 v66, v68, v69
  v_mfma_f32_32x32x16_bf16 v[80:95], a[232:235], a[84:87], v[80:95]
  v_cvt_pk_bf16_f32 v67, v70, v71
  s_add_u32 s55, s54, 43008
  s_waitcnt lgkmcnt(15)
  v_mfma_f32_32x32x16_bf16 v[80:95], a[236:239], a[92:95], v[80:95]
  buffer_load_dwordx4 v18, s[16:19], s42 offen offset:2048 lds
  buffer_store_dwordx4 v[64:67], v28, s[24:27], s44 offen offset:0 sc1
  v_cvt_pk_bf16_f32 v72, v72, v73
  v_cvt_pk_bf16_f32 v73, v74, v75
  v_mfma_f32_32x32x16_bf16 v[80:95], a[240:243], a[100:103], v[80:95]
  v_cvt_pk_bf16_f32 v74, v76, v77
  v_cvt_pk_bf16_f32 v75, v78, v79
  s_lshr_b32 s63, s95, 3
  v_mfma_f32_32x32x16_bf16 v[80:95], a[244:247], a[108:111], v[80:95]
  s_waitcnt vmcnt(12)
  buffer_load_dwordx4 v19, s[16:19], s42 offen offset:3072 lds
  buffer_store_dwordx4 v[72:75], v28, s[24:27], s44 offen offset:256 sc1
  ds_read_b64_tr_b16 v[240:241], v21 offset:4096
  v_mfma_f32_32x32x16_bf16 v[80:95], a[248:251], a[116:119], v[80:95]
  ds_read_b64_tr_b16 v[242:243], v21 offset:4608
  ds_read_b64_tr_b16 v[244:245], v21 offset:5120
  ds_read_b64_tr_b16 v[246:247], v21 offset:5632
  s_lshl_b32 s63, s63, 10
  s_waitcnt lgkmcnt(15)
  v_mfma_f32_32x32x16_bf16 v[80:95], a[252:255], a[124:127], v[80:95]
  s_waitcnt lgkmcnt(12)
  s_add_u32 m0, s36, 20480
  s_mov_b32 s42, 57344
  buffer_load_dwordx4 v16, s[16:19], s42 offen offset:0 lds
  ds_read_b64_tr_b16 v[248:249], v21 offset:6144
  v_mfma_f32_32x32x16_bf16 v[96:111], v[32:35], a[64:67], v[96:111]
  ds_read_b64_tr_b16 v[250:251], v21 offset:6656
  ds_read_b64_tr_b16 v[252:253], v21 offset:7168
  s_add_u32 s63, s63, 2179072
  v_mfma_f32_32x32x16_bf16 v[96:111], v[36:39], a[72:75], v[96:111]
  buffer_load_dwordx4 v17, s[16:19], s42 offen offset:1024 lds
  ds_read_b64_tr_b16 v[254:255], v21 offset:7680
  v_cvt_pk_bf16_f32 v80, v80, v81
  v_cvt_pk_bf16_f32 v81, v82, v83
  v_cvt_pk_bf16_f32 v82, v84, v85
  v_mfma_f32_32x32x16_bf16 v[96:111], v[40:43], a[80:83], v[96:111]
  v_cvt_pk_bf16_f32 v83, v86, v87
  v_lshl_add_u32 v4, v0, 7, s63
  v_mfma_f32_32x32x16_bf16 v[96:111], v[44:47], a[88:91], v[96:111]
  buffer_load_dwordx4 v18, s[16:19], s42 offen offset:2048 lds
  buffer_store_dwordx4 v[80:83], v28, s[24:27], s45 offen offset:0 sc1
  v_cvt_pk_bf16_f32 v88, v88, v89
  v_cvt_pk_bf16_f32 v89, v90, v91
  v_mfma_f32_32x32x16_bf16 v[96:111], v[48:51], a[96:99], v[96:111]
  v_cvt_pk_bf16_f32 v90, v92, v93
  v_cvt_pk_bf16_f32 v91, v94, v95
  v_bfrev_b32 v5, 1
  v_mfma_f32_32x32x16_bf16 v[96:111], v[52:55], a[104:107], v[96:111]
  s_waitcnt vmcnt(14)
  buffer_load_dwordx4 v19, s[16:19], s42 offen offset:3072 lds
  buffer_store_dwordx4 v[88:91], v28, s[24:27], s45 offen offset:256 sc1
  ds_read_b64_tr_b16 a[224:225], v21 offset:8192
  v_mfma_f32_32x32x16_bf16 v[96:111], v[56:59], a[112:115], v[96:111]
  ds_read_b64_tr_b16 a[226:227], v21 offset:8704
  ds_read_b64_tr_b16 a[228:229], v21 offset:9216
  ds_read_b64_tr_b16 a[230:231], v21 offset:9728
  s_mov_b64 s[38:39], 0x7f
  v_mfma_f32_32x32x16_bf16 v[96:111], v[60:63], a[120:123], v[96:111]
  s_waitcnt lgkmcnt(12)
  s_add_u32 m0, s36, 0
  s_mov_b32 s42, 114688
  buffer_load_dwordx4 v16, s[16:19], s42 offen offset:0 lds
  ds_read_b64_tr_b16 a[232:233], v21 offset:10240
  v_mfma_f32_32x32x16_bf16 v[112:127], v[32:35], a[68:71], v[112:127]
  ds_read_b64_tr_b16 a[234:235], v21 offset:10752
  ds_read_b64_tr_b16 a[236:237], v21 offset:11264
  v_mfma_f32_32x32x16_bf16 v[112:127], v[36:39], a[76:79], v[112:127]
  buffer_load_dwordx4 v17, s[16:19], s42 offen offset:1024 lds
  ds_read_b64_tr_b16 a[238:239], v21 offset:11776
  s_nop 0
  v_cvt_pk_bf16_f32 v96, v96, v97
  v_cvt_pk_bf16_f32 v97, v98, v99
  v_cvt_pk_bf16_f32 v98, v100, v101
  v_mfma_f32_32x32x16_bf16 v[112:127], v[40:43], a[84:87], v[112:127]
  v_cvt_pk_bf16_f32 v99, v102, v103
  v_cndmask_b32 v4, v5, v4, s[38:39]
  v_mfma_f32_32x32x16_bf16 v[112:127], v[44:47], a[92:95], v[112:127]
  buffer_load_dwordx4 v18, s[16:19], s42 offen offset:2048 lds
  buffer_store_dwordx4 v[96:99], v28, s[24:27], s44 offen offset:2048 sc1
  v_cvt_pk_bf16_f32 v104, v104, v105
  v_cvt_pk_bf16_f32 v105, v106, v107
  v_mfma_f32_32x32x16_bf16 v[112:127], v[48:51], a[100:103], v[112:127]
  v_cvt_pk_bf16_f32 v106, v108, v109
  v_cvt_pk_bf16_f32 v107, v110, v111
  v_lshlrev_b32 v5, 26, v0
  v_mfma_f32_32x32x16_bf16 v[112:127], v[52:55], a[108:111], v[112:127]
  s_waitcnt vmcnt(16)
  buffer_load_dwordx4 v19, s[16:19], s42 offen offset:3072 lds
  buffer_store_dwordx4 v[104:107], v28, s[24:27], s44 offen offset:2304 sc1
  ds_read_b64_tr_b16 a[240:241], v21 offset:12288
  v_mfma_f32_32x32x16_bf16 v[112:127], v[56:59], a[116:119], v[112:127]
  ds_read_b64_tr_b16 a[242:243], v21 offset:12800
  ds_read_b64_tr_b16 a[244:245], v21 offset:13312
  ds_read_b64_tr_b16 a[246:247], v21 offset:13824
  v_and_b32 v5, 0x80000000, v5
  v_mfma_f32_32x32x16_bf16 v[112:127], v[60:63], a[124:127], v[112:127]
  s_waitcnt lgkmcnt(12)
  s_add_u32 m0, s36, 4096
  s_mov_b32 s42, 172032
  buffer_load_dwordx4 v16, s[16:19], s42 offen offset:0 lds
  ds_read_b64_tr_b16 a[248:249], v21 offset:14336
  v_mfma_f32_32x32x16_bf16 v[128:143], v[224:227], a[0:3], 0
  ds_read_b64_tr_b16 a[250:251], v21 offset:14848
  ds_read_b64_tr_b16 a[252:253], v21 offset:15360
  v_mfma_f32_32x32x16_bf16 v[128:143], v[228:231], a[8:11], v[128:143]
  buffer_load_dwordx4 v17, s[16:19], s42 offen offset:1024 lds
  ds_read_b64_tr_b16 a[254:255], v21 offset:15872
  s_nop 0
  v_cvt_pk_bf16_f32 v112, v112, v113
  v_cvt_pk_bf16_f32 v113, v114, v115
  v_cvt_pk_bf16_f32 v114, v116, v117
  v_mfma_f32_32x32x16_bf16 v[128:143], v[232:235], a[16:19], v[128:143]
  v_cvt_pk_bf16_f32 v115, v118, v119
  v_mfma_f32_32x32x16_bf16 v[128:143], v[236:239], a[24:27], v[128:143]
  buffer_load_dwordx4 v18, s[16:19], s42 offen offset:2048 lds
  buffer_store_dwordx4 v[112:115], v28, s[24:27], s45 offen offset:2048 sc1
  v_cvt_pk_bf16_f32 v120, v120, v121
  v_cvt_pk_bf16_f32 v121, v122, v123
  v_mfma_f32_32x32x16_bf16 v[128:143], v[240:243], a[32:35], v[128:143]
  v_cvt_pk_bf16_f32 v122, v124, v125
  v_cvt_pk_bf16_f32 v123, v126, v127
  v_mfma_f32_32x32x16_bf16 v[128:143], v[244:247], a[40:43], v[128:143]
  s_waitcnt vmcnt(17)
  buffer_load_dwordx4 v19, s[16:19], s42 offen offset:3072 lds
  buffer_store_dwordx4 v[120:123], v28, s[24:27], s45 offen offset:2304 sc1
  ds_read_b64_tr_b16 v[32:33], v21 offset:16384
  v_mfma_f32_32x32x16_bf16 v[128:143], v[248:251], a[48:51], v[128:143]
  ds_read_b64_tr_b16 v[34:35], v21 offset:16896
  ds_read_b64_tr_b16 v[36:37], v21 offset:17408
  ds_read_b64_tr_b16 v[38:39], v21 offset:17920
  v_or_b32 v112, v200, v5
  v_or_b32 v113, v201, v5
  v_bfrev_b32 v5, 1
  v_mfma_f32_32x32x16_bf16 v[128:143], v[252:255], a[56:59], v[128:143]
  ds_read_b64_tr_b16 v[40:41], v21 offset:18432
  v_cndmask_b32 v5, v5, 0, s[92:93]
  s_mov_b32 s30, 4000
  v_mov_b32 v2, 1
  v_mfma_f32_32x32x16_bf16 v[144:159], v[224:227], a[4:7], 0
  ds_read_b64_tr_b16 v[42:43], v21 offset:18944
  ds_read_b64_tr_b16 v[44:45], v21 offset:19456
  v_mfma_f32_32x32x16_bf16 v[144:159], v[228:231], a[12:15], v[144:159]
  ds_read_b64_tr_b16 v[46:47], v21 offset:19968
  v_mfma_f32_32x32x16_bf16 v[144:159], v[232:235], a[20:23], v[144:159]
  v_mfma_f32_32x32x16_bf16 v[144:159], v[236:239], a[28:31], v[144:159]
  v_mfma_f32_32x32x16_bf16 v[144:159], v[240:243], a[36:39], v[144:159]
  v_mfma_f32_32x32x16_bf16 v[144:159], v[244:247], a[44:47], v[144:159]
  s_waitcnt vmcnt(13)
  ds_read_b64_tr_b16 v[48:49], v21 offset:20480
  ds_read_b64_tr_b16 v[50:51], v21 offset:20992
  v_mfma_f32_32x32x16_bf16 v[144:159], v[248:251], a[52:55], v[144:159]
  ds_read_b64_tr_b16 v[52:53], v21 offset:21504
  ds_read_b64_tr_b16 v[54:55], v21 offset:22016
  v_mfma_f32_32x32x16_bf16 v[144:159], v[252:255], a[60:63], v[144:159]
  ds_read_b64_tr_b16 v[56:57], v21 offset:22528
  s_waitcnt lgkmcnt(15)
  v_mfma_f32_32x32x16_bf16 v[128:143], a[224:227], a[64:67], v[128:143]
  ds_read_b64_tr_b16 v[58:59], v21 offset:23040
  ds_read_b64_tr_b16 v[60:61], v21 offset:23552
  v_mfma_f32_32x32x16_bf16 v[128:143], a[228:231], a[72:75], v[128:143]
  ds_read_b64_tr_b16 v[62:63], v21 offset:24064
  v_mfma_f32_32x32x16_bf16 v[128:143], a[232:235], a[80:83], v[128:143]
  v_mfma_f32_32x32x16_bf16 v[128:143], a[236:239], a[88:91], v[128:143]
  v_mfma_f32_32x32x16_bf16 v[128:143], a[240:243], a[96:99], v[128:143]
  v_mfma_f32_32x32x16_bf16 v[128:143], a[244:247], a[104:107], v[128:143]
  s_waitcnt vmcnt(7)
  ds_read_b64_tr_b16 v[224:225], v21 offset:0
  ds_read_b64_tr_b16 v[226:227], v21 offset:512
  v_mfma_f32_32x32x16_bf16 v[128:143], a[248:251], a[112:115], v[128:143]
  ds_read_b64_tr_b16 v[228:229], v21 offset:1024
  ds_read_b64_tr_b16 v[230:231], v21 offset:1536
  s_waitcnt lgkmcnt(15)
  v_mfma_f32_32x32x16_bf16 v[128:143], a[252:255], a[120:123], v[128:143]
  ds_read_b64_tr_b16 v[232:233], v21 offset:2048
  v_mfma_f32_32x32x16_bf16 v[144:159], a[224:227], a[68:71], v[144:159]
  s_waitcnt vmcnt(0)
  s_barrier
  buffer_store_dword v2, v5, s[24:27], s3 offen sc1
  ds_read_b64_tr_b16 v[234:235], v21 offset:2560
  ds_read_b64_tr_b16 v[236:237], v21 offset:3072
  v_mfma_f32_32x32x16_bf16 v[144:159], a[228:231], a[76:79], v[144:159]
  ds_read_b64_tr_b16 v[238:239], v21 offset:3584
  s_nop 2
  v_cvt_pk_bf16_f32 v128, v128, v129
  v_cvt_pk_bf16_f32 v129, v130, v131
  v_cvt_pk_bf16_f32 v130, v132, v133
  v_mov_b32 v2, 2
  v_mfma_f32_32x32x16_bf16 v[144:159], a[232:235], a[84:87], v[144:159]
  v_cvt_pk_bf16_f32 v131, v134, v135
  v_mfma_f32_32x32x16_bf16 v[144:159], a[236:239], a[92:95], v[144:159]
  buffer_store_dwordx4 v[128:131], v28, s[24:27], s46 offen offset:0 sc1
  v_cvt_pk_bf16_f32 v136, v136, v137
  v_cvt_pk_bf16_f32 v137, v138, v139
  v_cvt_pk_bf16_f32 v138, v140, v141
  v_mfma_f32_32x32x16_bf16 v[144:159], a[240:243], a[100:103], v[144:159]
  v_cvt_pk_bf16_f32 v139, v142, v143
  v_mfma_f32_32x32x16_bf16 v[144:159], a[244:247], a[108:111], v[144:159]
  buffer_store_dwordx4 v[136:139], v28, s[24:27], s46 offen offset:256 sc1
  ds_read_b64_tr_b16 v[240:241], v21 offset:4096
  ds_read_b64_tr_b16 v[242:243], v21 offset:4608
  v_mfma_f32_32x32x16_bf16 v[144:159], a[248:251], a[116:119], v[144:159]
  ds_read_b64_tr_b16 v[244:245], v21 offset:5120
  ds_read_b64_tr_b16 v[246:247], v21 offset:5632
  v_mfma_f32_32x32x16_bf16 v[144:159], a[252:255], a[124:127], v[144:159]
  ds_read_b64_tr_b16 v[248:249], v21 offset:6144
  v_mfma_f32_32x32x16_bf16 v[64:79], v[32:35], a[0:3], 0
  ds_read_b64_tr_b16 v[250:251], v21 offset:6656
  ds_read_b64_tr_b16 v[252:253], v21 offset:7168
  v_mfma_f32_32x32x16_bf16 v[64:79], v[36:39], a[8:11], v[64:79]
  ds_read_b64_tr_b16 v[254:255], v21 offset:7680
  s_nop 5
  v_cvt_pk_bf16_f32 v144, v144, v145
  v_cvt_pk_bf16_f32 v145, v146, v147
  v_cvt_pk_bf16_f32 v146, v148, v149
  s_waitcnt lgkmcnt(15)
  v_mfma_f32_32x32x16_bf16 v[64:79], v[40:43], a[16:19], v[64:79]
  v_cvt_pk_bf16_f32 v147, v150, v151
  v_mfma_f32_32x32x16_bf16 v[64:79], v[44:47], a[24:27], v[64:79]
  buffer_store_dwordx4 v[144:147], v28, s[24:27], s47 offen offset:0 sc1
  v_cvt_pk_bf16_f32 v152, v152, v153
  v_cvt_pk_bf16_f32 v153, v154, v155
  v_cvt_pk_bf16_f32 v154, v156, v157
  v_mfma_f32_32x32x16_bf16 v[64:79], v[48:51], a[32:35], v[64:79]
  v_cvt_pk_bf16_f32 v155, v158, v159
  v_mfma_f32_32x32x16_bf16 v[64:79], v[52:55], a[40:43], v[64:79]
  buffer_store_dwordx4 v[152:155], v28, s[24:27], s47 offen offset:256 sc1
  v_mfma_f32_32x32x16_bf16 v[64:79], v[56:59], a[48:51], v[64:79]
  v_mfma_f32_32x32x16_bf16 v[64:79], v[60:63], a[56:59], v[64:79]
  s_waitcnt lgkmcnt(14)
  v_mfma_f32_32x32x16_bf16 v[64:79], v[224:227], a[64:67], v[64:79]
  s_waitcnt lgkmcnt(12)
  v_mfma_f32_32x32x16_bf16 v[64:79], v[228:231], a[72:75], v[64:79]
  s_waitcnt lgkmcnt(10)
  v_mfma_f32_32x32x16_bf16 v[64:79], v[232:235], a[80:83], v[64:79]
  s_waitcnt lgkmcnt(8)
  v_mfma_f32_32x32x16_bf16 v[64:79], v[236:239], a[88:91], v[64:79]
  s_waitcnt lgkmcnt(6)
  v_mfma_f32_32x32x16_bf16 v[64:79], v[240:243], a[96:99], v[64:79]
  s_waitcnt lgkmcnt(4)
  v_mfma_f32_32x32x16_bf16 v[64:79], v[244:247], a[104:107], v[64:79]
  s_waitcnt lgkmcnt(2)
  v_mfma_f32_32x32x16_bf16 v[64:79], v[248:251], a[112:115], v[64:79]
  s_waitcnt lgkmcnt(0)
  v_mfma_f32_32x32x16_bf16 v[64:79], v[252:255], a[120:123], v[64:79]
  s_nop 11
  v_cvt_pk_bf16_f32 v64, v64, v65
  v_cvt_pk_bf16_f32 v65, v66, v67
  v_cvt_pk_bf16_f32 v66, v68, v69
  v_cvt_pk_bf16_f32 v67, v70, v71
  buffer_store_dwordx4 v[64:67], v29, s[24:27], s44 offen offset:0 sc1
  v_cvt_pk_bf16_f32 v72, v72, v73
  v_cvt_pk_bf16_f32 v73, v74, v75
  v_cvt_pk_bf16_f32 v74, v76, v77
  v_cvt_pk_bf16_f32 v75, v78, v79
  buffer_store_dwordx4 v[72:75], v29, s[24:27], s44 offen offset:256 sc1
  s_cmp_lg_u32 s89, 0
  s_cbranch_scc1 L_next
  s_waitcnt vmcnt(2)
  buffer_load_dword v3, v4, s[24:27], 0 offen sc1
  s_waitcnt vmcnt(1)
  s_barrier
  buffer_store_dword v2, v5, s[24:27], s3 offen sc1
  s_waitcnt vmcnt(1)
  v_cmp_gt_u32 vcc, 1, v3
  s_nop 0
  s_and_b32 s31, vcc_lo, s96
  s_and_b32 s31, s31, 0x7f
  s_cbranch_scc1 L_ds
L_ds_ok:
  buffer_load_dwordx4 v[128:131], v200, s[24:27], s54 offen offset:0 sc1
  buffer_load_dwordx4 v[132:135], v200, s[24:27], s54 offen offset:256 sc1
  buffer_load_dwordx4 v[144:147], v200, s[24:27], s52 offen offset:0 sc1
  buffer_load_dwordx4 v[148:151], v200, s[24:27], s52 offen offset:256 sc1
  buffer_load_dwordx4 v[160:163], v200, s[24:27], s53 offen offset:0 sc1
  buffer_load_dwordx4 v[164:167], v200, s[24:27], s53 offen offset:256 sc1
  buffer_load_dwordx4 v[176:179], v112, s[24:27], s55 offen offset:0 sc1
  buffer_load_dwordx4 v[180:183], v112, s[24:27], s55 offen offset:256 sc1
  buffer_load_dword v3, v4, s[24:27], 0 offen sc1
  s_waitcnt vmcnt(0)
  v_cmp_gt_u32 vcc, 2, v3
  s_nop 0
  s_and_b32 s31, vcc_lo, s96
  s_and_b32 s31, s31, 0x7f
  s_cbranch_scc1 L_dt
L_dt_ok:
  buffer_load_dwordx4 v[136:139], v201, s[24:27], s54 offen offset:0 sc1
  buffer_load_dwordx4 v[140:143], v201, s[24:27], s54 offen offset:256 sc1
  buffer_load_dwordx4 v[152:155], v201, s[24:27], s52 offen offset:0 sc1
  buffer_load_dwordx4 v[156:159], v201, s[24:27], s52 offen offset:256 sc1
  buffer_load_dwordx4 v[168:171], v201, s[24:27], s53 offen offset:0 sc1
  buffer_load_dwordx4 v[172:175], v201, s[24:27], s53 offen offset:256 sc1
  buffer_load_dwordx4 v[184:187], v113, s[24:27], s55 offen offset:0 sc1
  buffer_load_dwordx4 v[188:191], v113, s[24:27], s55 offen offset:256 sc1
  v_mfma_f32_16x16x32_bf16 v[96:99], v[204:207], v[128:131], 0
  v_mfma_f32_16x16x32_bf16 v[100:103], v[204:207], v[132:135], 0
  v_mfma_f32_16x16x32_bf16 v[96:99], v[204:207], v[144:147], v[96:99]
  v_mfma_f32_16x16x32_bf16 v[100:103], v[204:207], v[148:151], v[100:103]
  v_mfma_f32_16x16x32_bf16 v[96:99], v[204:207], v[160:163], v[96:99]
  v_mfma_f32_16x16x32_bf16 v[100:103], v[204:207], v[164:167], v[100:103]
  v_mfma_f32_16x16x32_bf16 v[96:99], v[204:207], v[176:179], v[96:99]
  v_mfma_f32_16x16x32_bf16 v[100:103], v[204:207], v[180:183], v[100:103]
  s_nop 7
  v_permlane16_swap_b32 v96, v100
  v_permlane16_swap_b32 v97, v101
  v_permlane16_swap_b32 v98, v102
  v_permlane16_swap_b32 v99, v103
  v_lshlrev_b32 v124, 16, v216
  v_and_b32 v125, 0xffff0000, v216
  v_pk_fma_f32 v[124:125], v[192:193], v[96:97], v[124:125]
  v_cvt_pk_bf16_f32 v216, v124, v125
  v_lshlrev_b32 v124, 16, v217
  v_and_b32 v125, 0xffff0000, v217
  v_pk_fma_f32 v[124:125], v[194:195], v[98:99], v[124:125]
  v_cvt_pk_bf16_f32 v217, v124, v125
  v_lshlrev_b32 v124, 16, v218
  v_and_b32 v125, 0xffff0000, v218
  v_pk_fma_f32 v[124:125], v[196:197], v[100:101], v[124:125]
  v_cvt_pk_bf16_f32 v218, v124, v125
  v_lshlrev_b32 v124, 16, v219
  v_and_b32 v125, 0xffff0000, v219
  v_pk_fma_f32 v[124:125], v[198:199], v[102:103], v[124:125]
  v_cvt_pk_bf16_f32 v219, v124, v125
  buffer_store_dwordx4 v[216:219], v202, s[20:23], s56 offen sc1
  s_waitcnt vmcnt(8)
  v_mfma_f32_16x16x32_bf16 v[104:107], v[204:207], v[136:139], 0
  s_waitcnt vmcnt(7)
  v_mfma_f32_16x16x32_bf16 v[108:111], v[204:207], v[140:143], 0
  s_waitcnt vmcnt(6)
  v_mfma_f32_16x16x32_bf16 v[104:107], v[204:207], v[152:155], v[104:107]
  s_waitcnt vmcnt(5)
  v_mfma_f32_16x16x32_bf16 v[108:111], v[204:207], v[156:159], v[108:111]
  s_waitcnt vmcnt(4)
  v_mfma_f32_16x16x32_bf16 v[104:107], v[204:207], v[168:171], v[104:107]
  s_waitcnt vmcnt(3)
  v_mfma_f32_16x16x32_bf16 v[108:111], v[204:207], v[172:175], v[108:111]
  s_waitcnt vmcnt(2)
  v_mfma_f32_16x16x32_bf16 v[104:107], v[204:207], v[184:187], v[104:107]
  s_waitcnt vmcnt(1)
  v_mfma_f32_16x16x32_bf16 v[108:111], v[204:207], v[188:191], v[108:111]
  s_nop 7
  v_permlane16_swap_b32 v104, v108
  v_permlane16_swap_b32 v105, v109
  v_permlane16_swap_b32 v106, v110
  v_permlane16_swap_b32 v107, v111
  v_lshlrev_b32 v124, 16, v220
  v_and_b32 v125, 0xffff0000, v220
  v_pk_fma_f32 v[124:125], v[208:209], v[104:105], v[124:125]
  v_cvt_pk_bf16_f32 v220, v124, v125
  v_lshlrev_b32 v124, 16, v221
  v_and_b32 v125, 0xffff0000, v221
  v_pk_fma_f32 v[124:125], v[210:211], v[106:107], v[124:125]
  v_cvt_pk_bf16_f32 v221, v124, v125
  v_lshlrev_b32 v124, 16, v222
  v_and_b32 v125, 0xffff0000, v222
  v_pk_fma_f32 v[124:125], v[212:213], v[108:109], v[124:125]
  v_cvt_pk_bf16_f32 v222, v124, v125
  v_lshlrev_b32 v124, 16, v223
  v_and_b32 v125, 0xffff0000, v223
  v_pk_fma_f32 v[124:125], v[214:215], v[110:111], v[124:125]
  v_cvt_pk_bf16_f32 v223, v124, v125
  buffer_store_dwordx4 v[220:223], v203, s[20:23], s56 offen sc1
L_noout:
  s_cmp_lg_u32 s89, 0
  s_cbranch_scc1 L_next
  v_mov_b32 v120, s59
  v_lshlrev_b32 v121, 2, v1
  v_add_u32 v121, 155648, v121
  ds_write_b32 v121, v120 offset:544
  s_waitcnt lgkmcnt(0)
  s_barrier
  v_mov_b32 v120, 155648
  ds_read_b128 v[120:123], v120 offset:544
  s_waitcnt lgkmcnt(0)
  v_or3_b32 v120, v120, v121, v122
  v_or_b32 v120, v120, v123
  s_nop 0
  v_readfirstlane_b32 s31, v120
  s_nop 0
  s_cmp_lg_u32 s31, 0
  s_cbranch_scc1 L_fail
  s_endpgm
L_D:
  s_load_dwordx4 s[4:7], s[0:1], 48
  s_load_dwordx2 s[28:29], s[0:1], 64
  s_load_dwordx2 s[18:19], s[0:1], 0
  s_waitcnt lgkmcnt(0)
  s_and_b32 s33, s2, 6
  s_lshr_b32 s34, s2, 7
  s_add_u32 s33, s33, s34
  s_bfe_u32 s34, s2, 0x40003
  s_and_b32 s35, s2, 1
  s_lshl_b32 s35, s35, 4
  s_add_u32 s34, s34, s35
  s_and_b32 s36, s2, 6
  s_mul_i32 s36, s36, 14
  s_lshr_b32 s38, s2, 3
  s_add_u32 s36, s36, s38
  s_and_b32 s38, s36, 15
  s_add_u32 s38, s38, s35
  s_lshr_b32 s36, s36, 4
  s_cmp_ge_u32 s2, 224
  s_cselect_b32 s36, 7, s36
  s_cmp_eq_u32 s89, 0
  s_cselect_b32 s33, s36, s33
  s_cselect_b32 s34, s38, s34
  s_and_b32 s95, s88, 7
  s_lshl_b32 s95, s95, 5
  s_lshr_b32 s31, s88, 3
  s_add_u32 s95, s95, s31
  s_mul_i32 s56, s95, 7168
  s_add_u32 s50, s56, 3145728
  s_mul_i32 s54, s95, 114688
  s_add_u32 s54, s54, 8388608
  v_and_b32 v40, 7, v0
  v_lshrrev_b32 v41, 3, v0
  s_lshl_b32 s52, s32, 3
  v_add_u32 v41, s52, v41
  v_mul_u32_u24 v202, 896, v40
  v_lshl_add_u32 v202, v41, 4, v202
  v_lshlrev_b32 v6, 5, v41
  v_lshlrev_b32 v32, 8, v41
  v_lshl_add_u32 v32, v40, 4, v32
  v_and_b32 v42, 15, v0
  s_lshl_b32 s52, s32, 10
  v_lshl_add_u32 v200, v42, 4, s52
  v_bfe_u32 v42, v0, 4, 1
  v_lshl_add_u32 v200, v42, 9, v200
  v_add_u32 v51, 1, v42
  v_lshrrev_b32 v42, 5, v0
  v_mul_u32_u24 v42, 7168, v42
  v_add_u32 v200, v200, v42
  s_cmp_eq_u32 s32, 3
  s_cselect_b32 s52, 0x80000000, 0
  s_add_u32 s53, s52, 4096
  v_add_u32 v201, s53, v200
  s_add_u32 s53, s52, 512
  v_add_u32 v203, s53, v202
  s_add_u32 s53, s52, 1024
  v_add_u32 v7, s53, v6
  s_add_u32 s53, s52, 8192
  v_add_u32 v33, s53, v32
  s_cmp_lg_u32 s90, 0
  s_cselect_b32 s52, 0x80000000, 0
  v_or_b32 v6, s52, v6
  v_or_b32 v7, s52, v7
  s_mov_b64 s[20:21], s[18:19]
  s_mov_b32 s22, 1835008
  s_mov_b32 s23, 0x20000
  s_mov_b32 s57, 2101248
  s_mov_b32 s62, 2103296
  v_bfe_u32 v42, v0, 3, 1
  v_lshl_add_u32 v42, v40, 1, v42
  s_lshr_b32 s51, s95, 4
  s_lshl_b32 s51, s51, 11
  s_add_u32 s51, s51, 2113536
  v_lshl_add_u32 v50, v42, 7, s51
  s_lshl_b32 s35, s34, 2
  s_add_u32 s35, s35, s32
  s_lshl_b32 s51, s35, 8
  s_add_u32 s51, s51, 2146304
  v_and_b32 v42, 1, v0
  v_lshl_add_u32 v42, v42, 7, s51
  s_mov_b32 s52, 0
  s_mov_b32 s53, -1
  v_cndmask_b32 v50, v50, v42, s[52:53]
  v_cndmask_b32 v51, v51, 1, s[52:53]
  s_mov_b32 s63, 0xff00ff
  s_lshl_b32 s51, s95, 7
  s_add_u32 s51, s51, 2146304
  s_mul_i32 s36, s32, 24576
  s_lshl_b32 s43, s32, 6
  v_lshrrev_b32 v42, 2, v0
  v_and_b32 v43, 3, v0
  v_mul_u32_u24 v44, 3584, v42
  v_lshl_add_u32 v44, v43, 4, v44
  v_add_u32 v8, s43, v44
  v_add_u32 v9, 56320, v8
  v_add_u32 v10, 112640, v8
  v_add_u32 v11, 168960, v8
  s_lshl_b32 s38, s33, 9
  s_sub_u32 s39, 1605632, s38
  s_add_u32 s8, s4, s38
  s_addc_u32 s9, s5, 0
  s_mov_b32 s10, s39
  s_mov_b32 s11, 0x20000
  s_add_u32 s12, s6, s38
  s_addc_u32 s13, s7, 0
  s_mov_b32 s14, s39
  s_mov_b32 s15, 0x20000
  s_load_dwordx2 s[20:21], s[0:1], 88
  s_and_b32 s95, s88, 7
  s_lshl_b32 s95, s95, 5
  s_lshr_b32 s31, s88, 3
  s_add_u32 s95, s95, s31
  s_mul_i32 s56, s95, 7168
  s_add_u32 s50, s56, 3145728
  buffer_load_dwordx4 v[216:219], v202, s[24:27], s50 offen sc1
  buffer_load_dwordx4 v[220:223], v203, s[24:27], s50 offen sc1
L_idle:
  s_mul_i32 s54, s95, 50176
  s_add_u32 s54, s54, s97
  s_add_u32 s52, s54, 14336
  s_add_u32 s53, s54, 28672
  s_add_u32 s55, s54, 43008
  s_lshr_b32 s63, s95, 3
  s_lshl_b32 s63, s63, 10
  s_add_u32 s63, s63, 2179072
  v_lshl_add_u32 v4, v0, 7, s63
  v_bfrev_b32 v5, 1
  s_mov_b64 s[38:39], 0x7f
  v_cndmask_b32 v4, v5, v4, s[38:39]
  v_lshlrev_b32 v5, 26, v0
  v_and_b32 v5, 0x80000000, v5
  v_or_b32 v112, v200, v5
  v_or_b32 v113, v201, v5
  v_bfrev_b32 v5, 1
  v_cndmask_b32 v5, v5, 0, s[92:93]
  s_mov_b32 s30, 4000
  s_mov_b32 s57, 2107392
  buffer_load_dwordx4 v[192:195], v6, s[24:27], s57 offen offset:0
  buffer_load_dwordx4 v[196:199], v6, s[24:27], s57 offen offset:16
  buffer_load_dwordx4 v[208:211], v7, s[24:27], s57 offen offset:0
  buffer_load_dwordx4 v[212:215], v7, s[24:27], s57 offen offset:16
  s_waitcnt vmcnt(0) lgkmcnt(0)
  s_branch L_ds
L_B:
  s_load_dwordx4 s[4:7], s[0:1], 48
  s_load_dwordx2 s[28:29], s[0:1], 64
  s_load_dwordx2 s[18:19], s[0:1], 0
  s_waitcnt lgkmcnt(0)
  s_and_b32 s33, s2, 6
  s_lshr_b32 s34, s2, 7
  s_add_u32 s33, s33, s34
  s_bfe_u32 s34, s2, 0x40003
  s_and_b32 s35, s2, 1
  s_lshl_b32 s35, s35, 4
  s_add_u32 s34, s34, s35
  s_and_b32 s36, s2, 6
  s_mul_i32 s36, s36, 14
  s_lshr_b32 s38, s2, 3
  s_add_u32 s36, s36, s38
  s_and_b32 s38, s36, 15
  s_add_u32 s38, s38, s35
  s_lshr_b32 s36, s36, 4
  s_cmp_ge_u32 s2, 224
  s_cselect_b32 s36, 7, s36
  s_cmp_eq_u32 s89, 0
  s_cselect_b32 s33, s36, s33
  s_cselect_b32 s34, s38, s34
  s_and_b32 s95, s88, 7
  s_lshl_b32 s95, s95, 5
  s_lshr_b32 s31, s88, 3
  s_add_u32 s95, s95, s31
  s_mul_i32 s56, s95, 7168
  s_add_u32 s50, s56, 3145728
  s_mul_i32 s54, s95, 114688
  s_add_u32 s54, s54, 8388608
  v_and_b32 v40, 7, v0
  v_lshrrev_b32 v41, 3, v0
  s_lshl_b32 s52, s32, 3
  v_add_u32 v41, s52, v41
  v_mul_u32_u24 v202, 896, v40
  v_lshl_add_u32 v202, v41, 4, v202
  v_lshlrev_b32 v6, 5, v41
  v_lshlrev_b32 v32, 8, v41
  v_lshl_add_u32 v32, v40, 4, v32
  v_and_b32 v42, 15, v0
  s_lshl_b32 s52, s32, 10
  v_lshl_add_u32 v200, v42, 4, s52
  v_bfe_u32 v42, v0, 4, 1
  v_lshl_add_u32 v200, v42, 9, v200
  v_add_u32 v51, 1, v42
  v_lshrrev_b32 v42, 5, v0
  v_mul_u32_u24 v42, 7168, v42
  v_add_u32 v200, v200, v42
  s_cmp_eq_u32 s32, 3
  s_cselect_b32 s52, 0x80000000, 0
  s_add_u32 s53, s52, 4096
  v_add_u32 v201, s53, v200
  s_add_u32 s53, s52, 512
  v_add_u32 v203, s53, v202
  s_add_u32 s53, s52, 1024
  v_add_u32 v7, s53, v6
  s_add_u32 s53, s52, 8192
  v_add_u32 v33, s53, v32
  s_cmp_lg_u32 s90, 0
  s_cselect_b32 s52, 0x80000000, 0
  v_or_b32 v6, s52, v6
  v_or_b32 v7, s52, v7
  s_mov_b64 s[20:21], s[18:19]
  s_mov_b32 s22, 1835008
  s_mov_b32 s23, 0x20000
  s_mov_b32 s57, 2101248
  s_mov_b32 s62, 2103296
  v_bfe_u32 v42, v0, 3, 1
  v_lshl_add_u32 v42, v40, 1, v42
  s_lshr_b32 s51, s95, 4
  s_lshl_b32 s51, s51, 11
  s_add_u32 s51, s51, 2113536
  v_lshl_add_u32 v50, v42, 7, s51
  s_lshl_b32 s35, s34, 2
  s_add_u32 s35, s35, s32
  s_lshl_b32 s51, s35, 8
  s_add_u32 s51, s51, 2146304
  v_and_b32 v42, 1, v0
  v_lshl_add_u32 v42, v42, 7, s51
  s_mov_b32 s52, 0
  s_mov_b32 s53, -1
  v_cndmask_b32 v50, v50, v42, s[52:53]
  v_cndmask_b32 v51, v51, 1, s[52:53]
  s_mov_b32 s63, 0xff00ff
  s_lshl_b32 s51, s95, 7
  s_add_u32 s51, s51, 2146304
  s_mul_i32 s36, s32, 24576
  s_lshl_b32 s43, s32, 6
  v_lshrrev_b32 v42, 2, v0
  v_and_b32 v43, 3, v0
  v_mul_u32_u24 v44, 3584, v42
  v_lshl_add_u32 v44, v43, 4, v44
  v_add_u32 v8, s43, v44
  v_add_u32 v9, 56320, v8
  v_add_u32 v10, 112640, v8
  v_add_u32 v11, 168960, v8
  s_lshl_b32 s38, s33, 9
  s_sub_u32 s39, 1605632, s38
  s_add_u32 s8, s4, s38
  s_addc_u32 s9, s5, 0
  s_mov_b32 s10, s39
  s_mov_b32 s11, 0x20000
  s_add_u32 s12, s6, s38
  s_addc_u32 s13, s7, 0
  s_mov_b32 s14, s39
  s_mov_b32 s15, 0x20000
  v_mov_b32 v51, 0
  s_mov_b32 s30, 4000
  s_waitcnt vmcnt(0)
  s_branch L_r
L_again:
  s_waitcnt vmcnt(4)
  buffer_load_dword v49, v50, s[24:27], 0 offen sc1
  s_sub_u32 s30, s30, 1
  s_waitcnt vmcnt(0)
  v_cmp_le_u32 vcc, v51, v49
  s_nop 0
  s_lshr_b32 s31, vcc_lo, 8
  s_and_b32 s31, s31, vcc_lo
  s_and_b32 s31, s31, s63
  s_xor_b32 s63, s63, s31
  s_mov_b32 s94, vcc_hi
  s_mov_b32 s40, s63
  s_and_b32 s41, s31, 983055
  s_cbranch_scc0 L_sg0
  s_bitcmp1_b32 s31, 16
  s_cbranch_scc0 L_s_0_1
  s_add_u32 s41, s54, 0
  buffer_load_dwordx4 a[136:139], v201, s[24:27], s41 offen offset:0 sc1 nt
  buffer_load_dwordx4 a[140:143], v201, s[24:27], s41 offen offset:256 sc1 nt
L_s_0_1:
  s_bitcmp1_b32 s31, 0
  s_cbranch_scc0 L_s_0_0
  s_add_u32 s41, s54, 0
  buffer_load_dwordx4 a[128:131], v200, s[24:27], s41 offen offset:0 sc1 nt
  buffer_load_dwordx4 a[132:135], v200, s[24:27], s41 offen offset:256 sc1 nt
L_s_0_0:
  s_bitcmp1_b32 s31, 17
  s_cbranch_scc0 L_s_1_1
  s_add_u32 s41, s54, 14336
  buffer_load_dwordx4 a[152:155], v201, s[24:27], s41 offen offset:0 sc1 nt
  buffer_load_dwordx4 a[156:159], v201, s[24:27], s41 offen offset:256 sc1 nt
L_s_1_1:
  s_bitcmp1_b32 s31, 1
  s_cbranch_scc0 L_s_1_0
  s_add_u32 s41, s54, 14336
  buffer_load_dwordx4 a[144:147], v200, s[24:27], s41 offen offset:0 sc1 nt
  buffer_load_dwordx4 a[148:151], v200, s[24:27], s41 offen offset:256 sc1 nt
L_s_1_0:
  s_bitcmp1_b32 s31, 18
  s_cbranch_scc0 L_s_2_1
  s_add_u32 s41, s54, 28672
  buffer_load_dwordx4 a[168:171], v201, s[24:27], s41 offen offset:0 sc1 nt
  buffer_load_dwordx4 a[172:175], v201, s[24:27], s41 offen offset:256 sc1 nt
L_s_2_1:
  s_bitcmp1_b32 s31, 2
  s_cbranch_scc0 L_s_2_0
  s_add_u32 s41, s54, 28672
  buffer_load_dwordx4 a[160:163], v200, s[24:27], s41 offen offset:0 sc1 nt
  buffer_load_dwordx4 a[164:167], v200, s[24:27], s41 offen offset:256 sc1 nt
L_s_2_0:
  s_bitcmp1_b32 s31, 19
  s_cbranch_scc0 L_s_3_1
  s_add_u32 s41, s54, 43008
  buffer_load_dwordx4 a[184:187], v201, s[24:27], s41 offen offset:0 sc1 nt
  buffer_load_dwordx4 a[188:191], v201, s[24:27], s41 offen offset:256 sc1 nt
L_s_3_1:
  s_bitcmp1_b32 s31, 3
  s_cbranch_scc0 L_s_3_0
  s_add_u32 s41, s54, 43008
  buffer_load_dwordx4 a[176:179], v200, s[24:27], s41 offen offset:0 sc1 nt
  buffer_load_dwordx4 a[180:183], v200, s[24:27], s41 offen offset:256 sc1 nt
L_s_3_0:
L_sg0:
  s_and_b32 s41, s31, 15728880
  s_cbranch_scc0 L_sg1
  s_bitcmp1_b32 s31, 20
  s_cbranch_scc0 L_s_4_1
  s_add_u32 s41, s54, 57344
  buffer_load_dwordx4 a[200:203], v201, s[24:27], s41 offen offset:0 sc1 nt
  buffer_load_dwordx4 a[204:207], v201, s[24:27], s41 offen offset:256 sc1 nt
L_s_4_1:
  s_bitcmp1_b32 s31, 4
  s_cbranch_scc0 L_s_4_0
  s_add_u32 s41, s54, 57344
  buffer_load_dwordx4 a[192:195], v200, s[24:27], s41 offen offset:0 sc1 nt
  buffer_load_dwordx4 a[196:199], v200, s[24:27], s41 offen offset:256 sc1 nt
L_s_4_0:
  s_bitcmp1_b32 s31, 21
  s_cbranch_scc0 L_s_5_1
  s_add_u32 s41, s54, 71680
  buffer_load_dwordx4 a[216:219], v201, s[24:27], s41 offen offset:0 sc1 nt
  buffer_load_dwordx4 a[220:223], v201, s[24:27], s41 offen offset:256 sc1 nt
L_s_5_1:
  s_bitcmp1_b32 s31, 5
  s_cbranch_scc0 L_s_5_0
  s_add_u32 s41, s54, 71680
  buffer_load_dwordx4 a[208:211], v200, s[24:27], s41 offen offset:0 sc1 nt
  buffer_load_dwordx4 a[212:215], v200, s[24:27], s41 offen offset:256 sc1 nt
L_s_5_0:
  s_bitcmp1_b32 s31, 22
  s_cbranch_scc0 L_s_6_1
  s_add_u32 s41, s54, 86016
  buffer_load_dwordx4 a[232:235], v201, s[24:27], s41 offen offset:0 sc1 nt
  buffer_load_dwordx4 a[236:239], v201, s[24:27], s41 offen offset:256 sc1 nt
L_s_6_1:
  s_bitcmp1_b32 s31, 6
  s_cbranch_scc0 L_s_6_0
  s_add_u32 s41, s54, 86016
  buffer_load_dwordx4 a[224:227], v200, s[24:27], s41 offen offset:0 sc1 nt
  buffer_load_dwordx4 a[228:231], v200, s[24:27], s41 offen offset:256 sc1 nt
L_s_6_0:
  s_bitcmp1_b32 s31, 23
  s_cbranch_scc0 L_s_7_1
  s_add_u32 s41, s54, 100352
  buffer_load_dwordx4 a[248:251], v201, s[24:27], s41 offen offset:0 sc1 nt
  buffer_load_dwordx4 a[252:255], v201, s[24:27], s41 offen offset:256 sc1 nt
L_s_7_1:
  s_bitcmp1_b32 s31, 7
  s_cbranch_scc0 L_s_7_0
  s_add_u32 s41, s54, 100352
  buffer_load_dwordx4 a[240:243], v200, s[24:27], s41 offen offset:0 sc1 nt
  buffer_load_dwordx4 a[244:247], v200, s[24:27], s41 offen offset:256 sc1 nt
L_s_7_0:
L_sg1:
  s_cmp_eq_u32 s40, 0
  s_cbranch_scc1 L_fin
  s_cmp_gt_i32 s30, 0
  s_cbranch_scc1 L_again
  s_or_b32 s59, s59, 1
  s_mov_b32 s63, 0
  s_branch L_fin
L_fh:
  buffer_load_dword v49, v50, s[24:27], 0 offen sc1
  s_sub_u32 s30, s30, 1
  s_waitcnt vmcnt(0)
  v_cmp_le_u32 vcc, v51, v49
  s_nop 0
  s_cmp_eq_u32 vcc_hi, -1
  s_cbranch_scc1 L_C
  s_cmp_gt_i32 s30, 0
  s_cbranch_scc1 L_fh
  s_or_b32 s59, s59, 1
  s_branch L_C
L_ds:
  buffer_load_dword v3, v4, s[24:27], 0 offen sc1
  s_sub_u32 s30, s30, 1
  s_waitcnt vmcnt(0)
  v_cmp_gt_u32 vcc, 1, v3
  s_nop 0
  s_and_b32 s31, vcc_lo, s96
  s_and_b32 s31, s31, 0x7f
  s_cbranch_scc0 L_ds_ok
  s_cmp_gt_i32 s30, 0
  s_cbranch_scc1 L_ds
  s_or_b32 s59, s59, 1
  s_branch L_noout
L_dt:
  buffer_load_dword v3, v4, s[24:27], 0 offen sc1
  s_sub_u32 s30, s30, 1
  s_waitcnt vmcnt(0)
  v_cmp_gt_u32 vcc, 2, v3
  s_nop 0
  s_and_b32 s31, vcc_lo, s96
  s_and_b32 s31, s31, 0x7f
  s_cbranch_scc0 L_dt_ok
  s_cmp_gt_i32 s30, 0
  s_cbranch_scc1 L_dt
  s_or_b32 s59, s59, 1
  s_branch L_noout
L_recB:
  buffer_store_dwordx4 v[216:219], v202, s[24:27], s50 offen sc1
  buffer_store_dwordx4 v[220:223], v203, s[24:27], s50 offen sc1
  s_waitcnt vmcnt(0)
  s_barrier
  s_branch L_C
L_fail:
L_next:
  s_waitcnt vmcnt(0) lgkmcnt(0)
  s_barrier
  s_mov_b32 s2, s89
  s_add_u32 s89, s89, 1
  s_mov_b32 s37, 0
  s_mov_b32 s59, 0
  s_mov_b32 s90, 0
  v_mbcnt_lo_u32_b32 v0, -1, 0
  v_mbcnt_hi_u32_b32 v0, -1, v0
  s_and_b32 s95, s88, 7
  s_lshl_b32 s95, s95, 5
  s_lshr_b32 s31, s88, 3
  s_add_u32 s95, s95, s31
  s_cmp_gt_u32 s89, 100
  s_cbranch_scc1 L_next2
  s_lshr_b32 s92, s95, 4
  s_lshl_b32 s92, s92, 3
  s_and_b32 s31, s89, 7
  s_add_u32 s92, s92, s31
  s_add_u32 s92, s92, 128
  s_lshl_b32 s31, s32, 6
  v_add_u32 v0, s31, v0
  s_cmp_le_u32 s89, 84
  s_cbranch_scc1 L_k2_restart
  s_sub_u32 s31, s89, 85
  s_and_b32 s2, s95, 0xf0
  s_lshr_b32 s30, s31, 1
  s_add_u32 s2, s2, s30
  s_and_b32 s31, s31, 1
  s_lshl_b32 s31, s31, 3
  s_add_u32 s2, s2, s31
  s_branch L_k2_restart
L_next2:
  v_mov_b32 v1, s32
  s_mov_b32 s3, 2211840
  s_lshr_b32 s30, s95, 3
  s_sub_u32 s97, s88, s30
  s_mul_i32 s97, s97, 401408
  s_add_u32 s97, s97, 67108864
  s_mov_b32 s96, 0
  s_sub_u32 s31, s89, 101
  s_and_b32 s2, s31, 6
  s_and_b32 s31, s31, 1
  s_lshl_b32 s31, s31, 7
  s_add_u32 s2, s2, s31
  s_lshr_b32 s31, s30, 4
  s_add_u32 s2, s2, s31
  s_and_b32 s31, s30, 15
  s_lshl_b32 s31, s31, 3
  s_add_u32 s2, s2, s31
  s_cmp_le_u32 s89, 107
  s_cbranch_scc1 L_B
  s_cmp_eq_u32 s89, 108
  s_cbranch_scc1 L_D
  s_endpgm
L_k2_fallback:
  s_mov_b32 s37, 1
  s_lshl_b32 s56, s32, 6
  v_add_u32 v0, s56, v24
  s_waitcnt vmcnt(0) lgkmcnt(0)
  s_barrier
  s_branch L_k2_restart
L_k2_maxpass:
  ds_read_b128 a[0:3], v21 offset:32768
  ds_read_b128 a[16:19], v21 offset:34816
  ds_read_b128 a[4:7], v21 offset:33792
  ds_read_b128 a[20:23], v21 offset:35840
  ds_read_b128 a[8:11], v22 offset:32768
  ds_read_b128 a[24:27], v22 offset:34816
  ds_read_b128 a[12:15], v22 offset:33792
  ds_read_b128 a[28:31], v22 offset:35840
  ds_read_b128 a[32:35], v21 offset:36864
  ds_read_b128 a[48:51], v21 offset:38912
  ds_read_b128 a[36:39], v21 offset:37888
  ds_read_b128 a[52:55], v21 offset:39936
  ds_read_b128 a[40:43], v22 offset:36864
  ds_read_b128 a[56:59], v22 offset:38912
  ds_read_b128 a[44:47], v22 offset:37888
  ds_read_b128 a[60:63], v22 offset:39936
  ds_read_b128 a[64:67], v21 offset:0
  ds_read_b128 a[80:83], v21 offset:2048
  ds_read_b128 a[68:71], v21 offset:1024
  ds_read_b128 a[84:87], v21 offset:3072
  ds_read_b128 a[72:75], v22 offset:0
  ds_read_b128 a[88:91], v22 offset:2048
  ds_read_b128 a[76:79], v22 offset:1024
  ds_read_b128 a[92:95], v22 offset:3072
  ds_read_b128 a[96:99], v21 offset:4096
  ds_read_b128 a[112:115], v21 offset:6144
  ds_read_b128 a[100:103], v21 offset:5120
  ds_read_b128 a[116:119], v21 offset:7168
  ds_read_b128 a[104:107], v22 offset:4096
  ds_read_b128 a[120:123], v22 offset:6144
  ds_read_b128 a[108:111], v22 offset:5120
  ds_read_b128 a[124:127], v22 offset:7168
  s_mov_b32 s34, 0
  s_mov_b32 s36, 32
  s_waitcnt vmcnt(0) lgkmcnt(0)
L_k2_maxloop:
  s_add_u32 m0, s33, 0
  s_nop 0
  buffer_load_dwordx4 v12, s[12:15], s34 offen offset:0 lds
  buffer_load_dwordx4 v13, s[12:15], s34 offen offset:1024 lds
  buffer_load_dwordx4 v14, s[12:15], s34 offen offset:2048 lds
  buffer_load_dwordx4 v15, s[12:15], s34 offen offset:3072 lds
  s_add_u32 s34, s34, 4096
  s_add_u32 m0, s33, 4096
  s_nop 0
  buffer_load_dwordx4 v12, s[12:15], s34 offen offset:0 lds
  buffer_load_dwordx4 v13, s[12:15], s34 offen offset:1024 lds
  buffer_load_dwordx4 v14, s[12:15], s34 offen offset:2048 lds
  buffer_load_dwordx4 v15, s[12:15], s34 offen offset:3072 lds
  s_add_u32 s34, s34, 28672
  s_waitcnt vmcnt(0)
  s_barrier
  ds_read_b128 v[96:99], v0 offset:0
  ds_read_b128 v[100:103], v1 offset:0
  ds_read_b128 v[104:107], v2 offset:0
  ds_read_b128 v[108:111], v3 offset:0
  ds_read_b128 v[112:115], v0 offset:256
  ds_read_b128 v[116:119], v1 offset:256
  ds_read_b128 v[120:123], v2 offset:256
  ds_read_b128 v[124:127], v3 offset:256
  ds_read_b128 a[192:195], v0 offset:8192
  ds_read_b128 a[196:199], v1 offset:8192
  ds_read_b128 a[200:203], v2 offset:8192
  ds_read_b128 a[204:207], v3 offset:8192
  ds_read_b128 a[208:211], v0 offset:8448
  ds_read_b128 a[212:215], v1 offset:8448
  ds_read_b128 a[216:219], v2 offset:8448
  ds_read_b128 a[220:223], v3 offset:8448
  s_waitcnt lgkmcnt(0)
  s_barrier
  v_mfma_f32_16x16x32_bf16 v[64:67], v[96:99], a[0:3], 0
  v_mfma_f32_16x16x32_bf16 v[64:67], v[100:103], a[16:19], v[64:67]
  v_mfma_f32_16x16x32_bf16 v[68:71], v[96:99], a[4:7], 0
  v_mfma_f32_16x16x32_bf16 v[68:71], v[100:103], a[20:23], v[68:71]
  v_mfma_f32_16x16x32_bf16 v[72:75], v[96:99], a[8:11], 0
  v_mfma_f32_16x16x32_bf16 v[72:75], v[100:103], a[24:27], v[72:75]
  v_mfma_f32_16x16x32_bf16 v[76:79], v[96:99], a[12:15], 0
  v_mfma_f32_16x16x32_bf16 v[76:79], v[100:103], a[28:31], v[76:79]
  v_mfma_f32_16x16x32_bf16 v[64:67], v[104:107], a[32:35], v[64:67]
  v_mfma_f32_16x16x32_bf16 v[64:67], v[108:111], a[48:51], v[64:67]
  v_mfma_f32_16x16x32_bf16 v[68:71], v[104:107], a[36:39], v[68:71]
  v_mfma_f32_16x16x32_bf16 v[68:71], v[108:111], a[52:55], v[68:71]
  v_mfma_f32_16x16x32_bf16 v[72:75], v[104:107], a[40:43], v[72:75]
  v_mfma_f32_16x16x32_bf16 v[72:75], v[108:111], a[56:59], v[72:75]
  v_mfma_f32_16x16x32_bf16 v[76:79], v[104:107], a[44:47], v[76:79]
  v_mfma_f32_16x16x32_bf16 v[76:79], v[108:111], a[60:63], v[76:79]
  v_mfma_f32_16x16x32_bf16 v[64:67], v[112:115], a[64:67], v[64:67]
  v_mfma_f32_16x16x32_bf16 v[64:67], v[116:119], a[80:83], v[64:67]
  v_mfma_f32_16x16x32_bf16 v[68:71], v[112:115], a[68:71], v[68:71]
  v_mfma_f32_16x16x32_bf16 v[68:71], v[116:119], a[84:87], v[68:71]
  v_mfma_f32_16x16x32_bf16 v[72:75], v[112:115], a[72:75], v[72:75]
  v_mfma_f32_16x16x32_bf16 v[72:75], v[116:119], a[88:91], v[72:75]
  v_mfma_f32_16x16x32_bf16 v[76:79], v[112:115], a[76:79], v[76:79]
  v_mfma_f32_16x16x32_bf16 v[76:79], v[116:119], a[92:95], v[76:79]
  v_mfma_f32_16x16x32_bf16 v[64:67], v[120:123], a[96:99], v[64:67]
  v_mfma_f32_16x16x32_bf16 v[64:67], v[124:127], a[112:115], v[64:67]
  v_mfma_f32_16x16x32_bf16 v[68:71], v[120:123], a[100:103], v[68:71]
  v_mfma_f32_16x16x32_bf16 v[68:71], v[124:127], a[116:119], v[68:71]
  v_mfma_f32_16x16x32_bf16 v[72:75], v[120:123], a[104:107], v[72:75]
  v_mfma_f32_16x16x32_bf16 v[72:75], v[124:127], a[120:123], v[72:75]
  v_mfma_f32_16x16x32_bf16 v[76:79], v[120:123], a[108:111], v[76:79]
  v_mfma_f32_16x16x32_bf16 v[76:79], v[124:127], a[124:127], v[76:79]
  v_mfma_f32_16x16x32_bf16 v[240:243], a[192:195], a[0:3], 0
  v_mfma_f32_16x16x32_bf16 v[240:243], a[196:199], a[16:19], v[240:243]
  v_mfma_f32_16x16x32_bf16 v[244:247], a[192:195], a[4:7], 0
  v_mfma_f32_16x16x32_bf16 v[244:247], a[196:199], a[20:23], v[244:247]
  v_mfma_f32_16x16x32_bf16 v[248:251], a[192:195], a[8:11], 0
  v_mfma_f32_16x16x32_bf16 v[248:251], a[196:199], a[24:27], v[248:251]
  v_mfma_f32_16x16x32_bf16 v[252:255], a[192:195], a[12:15], 0
  v_mfma_f32_16x16x32_bf16 v[252:255], a[196:199], a[28:31], v[252:255]
  v_mfma_f32_16x16x32_bf16 v[240:243], a[200:203], a[32:35], v[240:243]
  v_mfma_f32_16x16x32_bf16 v[240:243], a[204:207], a[48:51], v[240:243]
  v_mfma_f32_16x16x32_bf16 v[244:247], a[200:203], a[36:39], v[244:247]
  v_mfma_f32_16x16x32_bf16 v[244:247], a[204:207], a[52:55], v[244:247]
  v_mfma_f32_16x16x32_bf16 v[248:251], a[200:203], a[40:43], v[248:251]
  v_mfma_f32_16x16x32_bf16 v[248:251], a[204:207], a[56:59], v[248:251]
  v_mfma_f32_16x16x32_bf16 v[252:255], a[200:203], a[44:47], v[252:255]
  v_mfma_f32_16x16x32_bf16 v[252:255], a[204:207], a[60:63], v[252:255]
  v_mfma_f32_16x16x32_bf16 v[240:243], a[208:211], a[64:67], v[240:243]
  v_mfma_f32_16x16x32_bf16 v[240:243], a[212:215], a[80:83], v[240:243]
  v_mfma_f32_16x16x32_bf16 v[244:247], a[208:211], a[68:71], v[244:247]
  v_mfma_f32_16x16x32_bf16 v[244:247], a[212:215], a[84:87], v[244:247]
  v_mfma_f32_16x16x32_bf16 v[248:251], a[208:211], a[72:75], v[248:251]
  v_mfma_f32_16x16x32_bf16 v[248:251], a[212:215], a[88:91], v[248:251]
  v_mfma_f32_16x16x32_bf16 v[252:255], a[208:211], a[76:79], v[252:255]
  v_mfma_f32_16x16x32_bf16 v[252:255], a[212:215], a[92:95], v[252:255]
  v_mfma_f32_16x16x32_bf16 v[240:243], a[216:219], a[96:99], v[240:243]
  v_mfma_f32_16x16x32_bf16 v[240:243], a[220:223], a[112:115], v[240:243]
  v_mfma_f32_16x16x32_bf16 v[244:247], a[216:219], a[100:103], v[244:247]
  v_mfma_f32_16x16x32_bf16 v[244:247], a[220:223], a[116:119], v[244:247]
  v_mfma_f32_16x16x32_bf16 v[248:251], a[216:219], a[104:107], v[248:251]
  v_mfma_f32_16x16x32_bf16 v[248:251], a[220:223], a[120:123], v[248:251]
  v_mfma_f32_16x16x32_bf16 v[252:255], a[216:219], a[108:111], v[252:255]
  v_mfma_f32_16x16x32_bf16 v[252:255], a[220:223], a[124:127], v[252:255]
  v_max3_f32 v80, v80, v64, v65
  v_max3_f32 v80, v80, v66, v67
  v_max3_f32 v80, v80, v240, v241
  v_max3_f32 v80, v80, v242, v243
  v_max3_f32 v81, v81, v68, v69
  v_max3_f32 v81, v81, v70, v71
  v_max3_f32 v81, v81, v244, v245
  v_max3_f32 v81, v81, v246, v247
  v_max3_f32 v82, v82, v72, v73
  v_max3_f32 v82, v82, v74, v75
  v_max3_f32 v82, v82, v248, v249
  v_max3_f32 v82, v82, v250, v251
  v_max3_f32 v83, v83, v76, v77
  v_max3_f32 v83, v83, v78, v79
  v_max3_f32 v83, v83, v252, v253
  v_max3_f32 v83, v83, v254, v255
  s_sub_u32 s36, s36, 1
  s_cmp_lg_u32 s36, 0
  s_cbranch_scc1 L_k2_maxloop
  s_mov_b32 s34, 0
  s_add_u32 m0, s33, 0
  s_nop 0
  buffer_load_dwordx4 v12, s[12:15], s34 offen offset:0 lds
  buffer_load_dwordx4 v13, s[12:15], s34 offen offset:1024 lds
  buffer_load_dwordx4 v14, s[12:15], s34 offen offset:2048 lds
  buffer_load_dwordx4 v15, s[12:15], s34 offen offset:3072 lds
  s_add_u32 s34, s34, 4096
  s_add_u32 m0, s33, 4096
  s_nop 0
  buffer_load_dwordx4 v12, s[12:15], s34 offen offset:0 lds
  buffer_load_dwordx4 v13, s[12:15], s34 offen offset:1024 lds
  buffer_load_dwordx4 v14, s[12:15], s34 offen offset:2048 lds
  buffer_load_dwordx4 v15, s[12:15], s34 offen offset:3072 lds
  s_add_u32 s34, s34, 28672
  s_add_u32 m0, s33, 32768
  s_nop 0
  buffer_load_dwordx4 v12, s[12:15], s34 offen offset:0 lds
  buffer_load_dwordx4 v13, s[12:15], s34 offen offset:1024 lds
  buffer_load_dwordx4 v14, s[12:15], s34 offen offset:2048 lds
  buffer_load_dwordx4 v15, s[12:15], s34 offen offset:3072 lds
  s_add_u32 s34, s34, 4096
  s_add_u32 m0, s33, 36864
  s_nop 0
  buffer_load_dwordx4 v12, s[12:15], s34 offen offset:0 lds
  buffer_load_dwordx4 v13, s[12:15], s34 offen offset:1024 lds
  buffer_load_dwordx4 v14, s[12:15], s34 offen offset:2048 lds
  buffer_load_dwordx4 v15, s[12:15], s34 offen offset:3072 lds
  s_add_u32 s34, s34, 28672
  s_waitcnt vmcnt(0)
  s_barrier
  ds_read_b128 v[96:99], v0 offset:0
  ds_read_b128 v[100:103], v1 offset:0
  ds_read_b128 v[104:107], v2 offset:0
  ds_read_b128 v[108:111], v3 offset:0
  ds_read_b128 v[112:115], v0 offset:256
  ds_read_b128 v[116:119], v1 offset:256
  ds_read_b128 v[120:123], v2 offset:256
  ds_read_b128 v[124:127], v3 offset:256
  ds_read_b128 a[192:195], v0 offset:8192
  ds_read_b128 a[196:199], v1 offset:8192
  ds_read_b128 a[200:203], v2 offset:8192
  ds_read_b128 a[204:207], v3 offset:8192
  ds_read_b128 a[208:211], v0 offset:8448
  ds_read_b128 a[212:215], v1 offset:8448
  ds_read_b128 a[216:219], v2 offset:8448
  ds_read_b128 a[220:223], v3 offset:8448
  s_waitcnt lgkmcnt(0)
  s_barrier
  s_branch L_k2_att
L_k2_end:
  s_endpgm
L_text_end:
.section .rodata,"a"
.p2align 6
.amdhsa_kernel k2_kernel
  .amdhsa_next_free_vgpr 512
  .amdhsa_next_free_sgpr 102
  .amdhsa_accum_offset 256
  .amdhsa_group_segment_fixed_size 0
  .amdhsa_kernarg_size 112
  .amdhsa_user_sgpr_count 2
  .amdhsa_user_sgpr_kernarg_segment_ptr 1
  .amdhsa_system_sgpr_workgroup_id_x 1
  .amdhsa_float_denorm_mode_32 3
.end_amdhsa_kernel
```
